```python
import torch

def _softmax(x, axis=-1):
    return torch.softmax(x, dim=axis)
def _gelu(x):
    return torch.nn.functional.gelu(x, approximate="tanh")
def _silu(x):
    return torch.nn.functional.silu(x)
def _sigmoid(x):
    return torch.sigmoid(x)
def _layernorm(x, axis=-1, eps=1e-5):
    m = x.mean(dim=axis, keepdim=True)
    v = x.var(dim=axis, keepdim=True, unbiased=False)
    return (x - m) / torch.sqrt(v + eps)
def _scatter_add(tgt, idx, src, axis=0):
    return tgt.clone().index_add_(axis, idx, src)
def _segment_sum(src, seg, n):
    out = torch.zeros((n,) + src.shape[1:], dtype=src.dtype)
    return out.index_add_(0, seg, src)
def _pad(x, pw):
    flat = tuple(v for pair in reversed(pw) for v in pair)
    return torch.nn.functional.pad(x, flat)

kernel_name = 'concat_heads__gqa_block_cached__mha_block_cached__near_ridge'

def setup_inputs():

    _w = (lambda a: (lambda t: t.to(torch.bfloat16) if t.is_floating_point() else t)(torch.as_tensor(a)))
    def _A_setup():
        B, Sq, D = 16, 80, 512
        Hq, Hkv, Sk, Dh = 32, 8, 1024, 128
        assert Hq % Hkv == 0, (Hq, Hkv)
        return {
            "x": _w((lambda *s: torch.randn(*s, dtype=torch.bfloat16) * 0.8)(B, Sq, D)),
            "k_cache": _w((lambda *s: torch.randn(*s, dtype=torch.bfloat16) * 0.8)(B, Hkv, Sk, Dh)),
            "v_cache": _w((lambda *s: torch.randn(*s, dtype=torch.bfloat16) * 0.05)(B, Hkv, Sk, Dh)),
            "wq": _w((lambda *s: torch.randn(*s, dtype=torch.bfloat16) * 0.8)(D, Hq * Dh) * (D ** -0.5)),
            "wo": _w((lambda *s: torch.randn(*s, dtype=torch.bfloat16) * 0.05)(Hq * Dh, D) * ((Hq * Dh) ** -0.5)),
        }
    _A_in = _A_setup()

    def _B_setup():
        B, Sq, D = 16, 80, 512
        H, Sk, Dh = 32, 1024, 128
        return {
            "x": _w((lambda *s: torch.randn(*s, dtype=torch.bfloat16) * 0.8)(B, Sq, D)),
            "k_cache": _w((lambda *s: torch.randn(*s, dtype=torch.bfloat16) * 0.8)(B, H, Sk, Dh)),
            "v_cache": _w((lambda *s: torch.randn(*s, dtype=torch.bfloat16) * 0.05)(B, H, Sk, Dh)),
            "wq": _w((lambda *s: torch.randn(*s, dtype=torch.bfloat16) * 0.8)(D, H * Dh) * (D ** -0.5)),
            "wo": _w((lambda *s: torch.randn(*s, dtype=torch.bfloat16) * 0.05)(H * Dh, D) * ((H * Dh) ** -0.5)),
        }
    _B_in = _B_setup()

    return {
        "A_x": _A_in["x"],
        "A_k_cache": _A_in["k_cache"],
        "A_v_cache": _A_in["v_cache"],
        "A_wq": _A_in["wq"],
        "A_wo": _A_in["wo"],
        "B_x": _B_in["x"],
        "B_k_cache": _B_in["k_cache"],
        "B_v_cache": _B_in["v_cache"],
        "B_wq": _B_in["wq"],
        "B_wo": _B_in["wo"],
    }

def reference(A_x, A_k_cache, A_v_cache, A_wq, A_wo, B_x, B_k_cache, B_v_cache, B_wq, B_wo):
    def _A_ref(x, k_cache, v_cache, wq, wo):
        B, Sq, D = x.shape
        Hq, Dh = 32, 128
        Hkv = k_cache.shape[1]
        rep = Hq // Hkv
        q = (lambda x, *d: x.permute(*d))((x @ wq).reshape(B, Sq, Hq, Dh), 0, 2, 1, 3)
        k = (lambda x, n, axis: torch.repeat_interleave(x, n, dim=axis))(k_cache, rep, axis=1)
        v = (lambda x, n, axis: torch.repeat_interleave(x, n, dim=axis))(v_cache, rep, axis=1)
        scores = torch.einsum("bhqd,bhkd->bhqk", q, k) * (Dh ** -0.5)
        p = _softmax(scores, axis=-1)
        o = torch.einsum("bhqk,bhkd->bhqd", p, v)
        return (lambda x, *d: x.permute(*d))(o, 0, 2, 1, 3).reshape(B, Sq, Hq * Dh) @ wo

    def _B_ref(x, k_cache, v_cache, wq, wo):
        B, Sq, D = x.shape
        H, Dh = 32, 128
        q = (lambda x, *d: x.permute(*d))((x @ wq).reshape(B, Sq, H, Dh), 0, 2, 1, 3)
        scores = torch.einsum("bhqd,bhkd->bhqk", q, k_cache) * (Dh ** -0.5)
        p = _softmax(scores, axis=-1)
        o = torch.einsum("bhqk,bhkd->bhqd", p, v_cache)
        return (lambda x, *d: x.permute(*d))(o, 0, 2, 1, 3).reshape(B, Sq, H * Dh) @ wo

    a = _A_ref(A_x, A_k_cache, A_v_cache, A_wq, A_wo)
    b = _B_ref(B_x, B_k_cache, B_v_cache, B_wq, B_wo)
    return torch.concatenate([a, b], axis=-1)
```

```asm
; @launch grid=(256,1,1) block=(256,1,1) lds=163840
.amdgcn_target "amdgcn-amd-amdhsa--gfx950"
.text
.globl concat_heads__gqa_block_cached__mha_block_cached__near_ridge_kernel
.p2align 8
.type concat_heads__gqa_block_cached__mha_block_cached__near_ridge_kernel,@function
concat_heads__gqa_block_cached__mha_block_cached__near_ridge_kernel:
s_cmp_ge_u32 s2, 256
s_cbranch_scc1 L_end
s_lshr_b32 s54, s2, 3
s_bfe_u32 s6, s2, 0x10003
s_mul_i32 s55, s6, 40
s_add_u32 s56, s55, 32
s_load_dwordx8 s[36:43], s[0:1], s55
s_load_dwordx2 s[44:45], s[0:1], s56
s_load_dwordx2 s[46:47], s[0:1], 72
s_load_dwordx4 s[48:51], s[0:1], 80
s_load_dwordx2 s[52:53], s[0:1], 96
s_load_dwordx2 s[28:29], s[0:1], 40
s_load_dwordx2 s[30:31], s[0:1], 64
s_getpc_b64 s[100:101]
L_pc:
s_cmp_eq_u32 s6, 0
s_cbranch_scc0 L_nopf
v_lshlrev_b32 v5, 7, v0
v_add_u32 v6, 32768, v5
v_min_u32 v6, L_code_end-L_pc-4, v6
global_load_dword v10, v5, s[100:101]
global_load_dword v11, v6, s[100:101]
L_nopf:
s_and_b32 s5, s2, 7
s_xor_b32 s5, s5, s6
s_lshr_b32 s4, s2, 4
v_lshrrev_b32 v5, 6, v0
v_and_b32 v1, 63, v0
v_readfirstlane_b32 s3, v5
v_lshrrev_b32 v2, 4, v1
v_and_b32 v3, 15, v1
v_lshlrev_b32 v4, 4, v1
v_mov_b32 v9, 0
v_lshrrev_b32 v6, 1, v2
v_lshlrev_b32 v7, 13, v2
v_add_u32 v5, 0, v6
v_lshlrev_b32 v5, 2, v5
v_xor_b32 v5, v5, v3
v_lshl_add_u32 v244, v5, 4, v7
v_add_u32 v5, 2, v6
v_lshlrev_b32 v5, 2, v5
v_xor_b32 v5, v5, v3
v_lshl_add_u32 v245, v5, 4, v7
v_add_u32 v245, 64512, v245
v_add_u32 v5, 0, v6
v_lshlrev_b32 v5, 2, v5
v_xor_b32 v5, v5, v3
v_lshl_add_u32 v246, v5, 4, v7
v_add_u32 v246, 129024, v246
v_add_u32 v5, 2, v6
v_lshlrev_b32 v5, 2, v5
v_xor_b32 v5, v5, v3
v_lshl_add_u32 v247, v5, 4, v7
v_add_u32 v247, 193536, v247
v_add_u32 v5, 0, v6
v_lshlrev_b32 v5, 2, v5
v_xor_b32 v5, v5, v3
v_lshl_add_u32 v248, v5, 4, v7
v_add_u32 v248, 32768, v248
v_add_u32 v5, 2, v6
v_lshlrev_b32 v5, 2, v5
v_xor_b32 v5, v5, v3
v_lshl_add_u32 v249, v5, 4, v7
v_add_u32 v249, 97280, v249
v_add_u32 v5, 0, v6
v_lshlrev_b32 v5, 2, v5
v_xor_b32 v5, v5, v3
v_lshl_add_u32 v250, v5, 4, v7
v_add_u32 v250, 161792, v250
v_add_u32 v5, 2, v6
v_lshlrev_b32 v5, 2, v5
v_xor_b32 v5, v5, v3
v_lshl_add_u32 v251, v5, 4, v7
v_add_u32 v251, 226304, v251
s_mul_i32 s55, s3, 20
v_add_u32 v6, s55, v2
v_add_u32 v5, 0, v6
v_and_b32 v7, 15, v5
v_xor_b32 v7, v7, v3
v_lshlrev_b32 v7, 4, v7
v_lshl_add_u32 v208, v5, 10, v7
v_add_u32 v5, 4, v6
v_and_b32 v7, 15, v5
v_xor_b32 v7, v7, v3
v_lshlrev_b32 v7, 4, v7
v_lshl_add_u32 v209, v5, 10, v7
v_add_u32 v5, 8, v6
v_and_b32 v7, 15, v5
v_xor_b32 v7, v7, v3
v_lshlrev_b32 v7, 4, v7
v_lshl_add_u32 v210, v5, 10, v7
v_add_u32 v5, 12, v6
v_and_b32 v7, 15, v5
v_xor_b32 v7, v7, v3
v_lshlrev_b32 v7, 4, v7
v_lshl_add_u32 v211, v5, 10, v7
v_add_u32 v5, 16, v6
v_and_b32 v7, 15, v5
v_xor_b32 v7, v7, v3
v_lshlrev_b32 v7, 4, v7
v_lshl_add_u32 v212, v5, 10, v7
s_lshl_b32 s93, s3, 14
s_mov_b32 s7, 1023
s_mov_b32 s35, 20480
s_mov_b32 s62, 0x3e0293ee
s_mov_b32 s63, 0x3e0293ee
s_and_b32 s56, s4, 12
s_lshl_b32 s88, s56, 18
s_mov_b32 s90, 0x3fffff
s_lshl_b32 s98, s56, 6
s_mul_i32 s99, s3, 5120
s_add_u32 s99, s99, 81920
s_mul_i32 s100, s4, 81920
s_mov_b32 s89, 0x40000
s_mov_b32 s91, 16
s_lshl_b32 s54, s5, 10
s_lshl_b32 s55, s3, 8
s_add_u32 s54, s54, s55
s_sub_u32 s55, 0x400000, s54
s_waitcnt lgkmcnt(0)
s_add_u32 s20, s36, s100
s_addc_u32 s21, s37, 0
s_mov_b32 s22, 0x14000
s_mov_b32 s23, 0x20000
s_add_u32 s16, s42, s54
s_addc_u32 s17, s43, 0
s_mov_b32 s18, s55
s_mov_b32 s19, 0x20000
v_mov_b32 v12, 0xf00000
global_load_dword v13, v12, s[52:53] sc1
v_lshrrev_b32 v5, 3, v1
v_and_b32 v6, 7, v1
v_lshlrev_b32 v6, 7, v6
v_lshl_add_u32 v14, v5, 13, v6
v_lshlrev_b32 v15, 7, v0
s_cmp_eq_u32 s6, 0
s_cbranch_scc0 L_noA0
s_lshl_b32 s94, s4, 18
s_lshl_b32 s55, s3, 16
s_add_u32 s94, s94, s55
s_xor_b32 s54, s5, 1
s_lshl_b32 s54, s54, 10
s_add_u32 s54, s54, s94
s_mov_b32 s24, s30
s_mov_b32 s25, s31
s_mov_b32 s26, 0x400000
s_mov_b32 s27, 0x20000
buffer_load_dword v11, v14, s[24:27], s54 offen
s_mul_i32 s57, s5, 10240
s_add_u32 s57, s57, s100
s_add_u32 s24, s28, s100
s_addc_u32 s25, s29, 0
s_mov_b32 s26, 0x14000
s_mov_b32 s27, 0x20000
s_lshr_b32 s54, s56, 1
s_add_u32 s54, s54, 2
v_add_u32 v5, 0, v0
v_mul_u32_u24 v6, 10923, v5
v_lshrrev_b32 v6, 16, v6
v_mul_u32_u24 v7, 6, v6
v_sub_u32 v5, v5, v7
v_add_u32 v5, s54, v5
v_and_b32 v5, 7, v5
v_lshlrev_b32 v5, 7, v5
v_lshl_add_u32 v5, v6, 10, v5
buffer_load_dword v11, v5, s[24:27], 0 offen
v_add_u32 v5, 256, v0
v_mul_u32_u24 v6, 10923, v5
v_lshrrev_b32 v6, 16, v6
v_mul_u32_u24 v7, 6, v6
v_sub_u32 v5, v5, v7
v_add_u32 v5, s54, v5
v_and_b32 v5, 7, v5
v_lshlrev_b32 v5, 7, v5
v_lshl_add_u32 v5, v6, 10, v5
buffer_load_dword v11, v5, s[24:27], 0 offen
L_noA0:
s_add_u32 m0, s99, 0
s_nop 0
buffer_load_dwordx4 v208, s[20:23], s98 offen lds
s_add_u32 m0, s99, 1024
s_nop 0
buffer_load_dwordx4 v209, s[20:23], s98 offen lds
s_add_u32 m0, s99, 2048
s_nop 0
buffer_load_dwordx4 v210, s[20:23], s98 offen lds
s_add_u32 m0, s99, 3072
s_nop 0
buffer_load_dwordx4 v211, s[20:23], s98 offen lds
s_add_u32 m0, s99, 4096
s_nop 0
buffer_load_dwordx4 v212, s[20:23], s98 offen lds
s_add_u32 s98, s98, 256
s_and_b32 s98, s98, s7
s_add_u32 s99, s99, s35
s_cmp_gt_i32 s91, 0
s_cselect_b32 s92, s88, 0x7f000000
s_sub_u32 s91, s91, 1
s_add_u32 s88, s88, s89
s_and_b32 s88, s88, s90
s_add_u32 m0, s93, 0
s_nop 0
buffer_load_dwordx4 v244, s[16:19], s92 offen offset:0 lds
buffer_load_dwordx4 v245, s[16:19], s92 offen offset:1024 lds
buffer_load_dwordx4 v246, s[16:19], s92 offen offset:2048 lds
buffer_load_dwordx4 v247, s[16:19], s92 offen offset:3072 lds
s_add_u32 m0, s93, 4096
s_nop 0
buffer_load_dwordx4 v248, s[16:19], s92 offen offset:0 lds
buffer_load_dwordx4 v249, s[16:19], s92 offen offset:1024 lds
buffer_load_dwordx4 v250, s[16:19], s92 offen offset:2048 lds
buffer_load_dwordx4 v251, s[16:19], s92 offen offset:3072 lds
v_add_u32 v5, 0, v2
v_xor_b32 v5, v5, v3
v_lshlrev_b32 v5, 4, v5
v_lshl_add_u32 v16, v3, 8, v5
v_add_u32 v16, 81920, v16
v_add_u32 v5, 4, v2
v_xor_b32 v5, v5, v3
v_lshlrev_b32 v5, 4, v5
v_lshl_add_u32 v17, v3, 8, v5
v_add_u32 v17, 81920, v17
v_add_u32 v5, 8, v2
v_xor_b32 v5, v5, v3
v_lshlrev_b32 v5, 4, v5
v_lshl_add_u32 v18, v3, 8, v5
v_add_u32 v18, 81920, v18
v_add_u32 v5, 12, v2
v_xor_b32 v5, v5, v3
v_lshlrev_b32 v5, 4, v5
v_lshl_add_u32 v19, v3, 8, v5
v_add_u32 v19, 81920, v19
v_lshrrev_b32 v5, 2, v1
v_bfe_u32 v6, v1, 3, 2
v_and_b32 v7, 3, v1
v_lshlrev_b32 v7, 4, v7
v_lshl_add_u32 v7, v5, 8, v7
v_add_u32 v7, s93, v7
v_xor_b32 v8, 0, v6
v_lshl_add_u32 v20, v8, 6, v7
v_xor_b32 v8, 0, v6
v_lshl_add_u32 v21, v8, 6, v7
v_add_u32 v21, 8, v21
v_xor_b32 v8, 1, v6
v_lshl_add_u32 v22, v8, 6, v7
v_xor_b32 v8, 1, v6
v_lshl_add_u32 v23, v8, 6, v7
v_add_u32 v23, 8, v23
v_xor_b32 v8, 2, v6
v_lshl_add_u32 v24, v8, 6, v7
v_xor_b32 v8, 2, v6
v_lshl_add_u32 v25, v8, 6, v7
v_add_u32 v25, 8, v25
v_xor_b32 v8, 3, v6
v_lshl_add_u32 v26, v8, 6, v7
v_xor_b32 v8, 3, v6
v_lshl_add_u32 v27, v8, 6, v7
v_add_u32 v27, 8, v27
s_cmp_gt_i32 s91, 0
s_cselect_b32 s92, s88, 0x7f000000
s_sub_u32 s91, s91, 1
s_add_u32 s88, s88, s89
s_and_b32 s88, s88, s90
s_add_u32 m0, s93, 8192
s_nop 0
buffer_load_dwordx4 v244, s[16:19], s92 offen offset:0 lds
buffer_load_dwordx4 v245, s[16:19], s92 offen offset:1024 lds
buffer_load_dwordx4 v246, s[16:19], s92 offen offset:2048 lds
buffer_load_dwordx4 v247, s[16:19], s92 offen offset:3072 lds
s_add_u32 m0, s93, 12288
s_nop 0
buffer_load_dwordx4 v248, s[16:19], s92 offen offset:0 lds
buffer_load_dwordx4 v249, s[16:19], s92 offen offset:1024 lds
buffer_load_dwordx4 v250, s[16:19], s92 offen offset:2048 lds
buffer_load_dwordx4 v251, s[16:19], s92 offen offset:3072 lds
s_mov_b32 s94, 2
s_cmp_eq_u32 s6, 0
s_cbranch_scc0 L_noA1
s_add_u32 m0, s99, 0
s_nop 0
buffer_load_dwordx4 v208, s[20:23], s98 offen lds
s_add_u32 m0, s99, 1024
s_nop 0
buffer_load_dwordx4 v209, s[20:23], s98 offen lds
s_add_u32 m0, s99, 2048
s_nop 0
buffer_load_dwordx4 v210, s[20:23], s98 offen lds
s_add_u32 m0, s99, 3072
s_nop 0
buffer_load_dwordx4 v211, s[20:23], s98 offen lds
s_add_u32 m0, s99, 4096
s_nop 0
buffer_load_dwordx4 v212, s[20:23], s98 offen lds
s_add_u32 s98, s98, 256
s_and_b32 s98, s98, s7
s_add_u32 s99, s99, s35
s_add_u32 m0, s99, 0
s_nop 0
buffer_load_dwordx4 v208, s[20:23], s98 offen lds
s_add_u32 m0, s99, 1024
s_nop 0
buffer_load_dwordx4 v209, s[20:23], s98 offen lds
s_add_u32 m0, s99, 2048
s_nop 0
buffer_load_dwordx4 v210, s[20:23], s98 offen lds
s_add_u32 m0, s99, 3072
s_nop 0
buffer_load_dwordx4 v211, s[20:23], s98 offen lds
s_add_u32 m0, s99, 4096
s_nop 0
buffer_load_dwordx4 v212, s[20:23], s98 offen lds
s_add_u32 s98, s98, 256
s_and_b32 s98, s98, s7
s_add_u32 s99, s99, s35
s_add_u32 m0, s99, 0
s_nop 0
buffer_load_dwordx4 v208, s[20:23], s98 offen lds
s_add_u32 m0, s99, 1024
s_nop 0
buffer_load_dwordx4 v209, s[20:23], s98 offen lds
s_add_u32 m0, s99, 2048
s_nop 0
buffer_load_dwordx4 v210, s[20:23], s98 offen lds
s_add_u32 m0, s99, 3072
s_nop 0
buffer_load_dwordx4 v211, s[20:23], s98 offen lds
s_add_u32 m0, s99, 4096
s_nop 0
buffer_load_dwordx4 v212, s[20:23], s98 offen lds
s_add_u32 s98, s98, 256
s_and_b32 s98, s98, s7
s_add_u32 s99, s99, s35
s_lshl_b32 s54, s4, 18
s_lshl_b32 s55, s3, 16
s_add_u32 s54, s54, s55
s_lshl_b32 s55, s5, 10
s_add_u32 s54, s54, s55
s_mov_b32 s24, s42
s_mov_b32 s25, s43
s_mov_b32 s26, 0x400000
s_mov_b32 s27, 0x20000
buffer_load_dword v11, v14, s[24:27], s54 offen
s_mov_b32 s98, 0x7f000000
s_mov_b32 s7, -1
s_mov_b32 s35, 0
s_mov_b32 s99, 65536
s_lshl_b32 s54, s4, 3
s_add_u32 s54, s54, s5
s_lshl_b32 s54, s54, 18
s_add_u32 s24, s38, s54
s_addc_u32 s25, s39, 0
s_mov_b32 s26, 0x40000
s_mov_b32 s27, 0x20000
s_mov_b32 s54, 32768
buffer_load_dword v11, v15, s[24:27], s54 offen
s_mov_b32 s54, 65536
buffer_load_dword v11, v15, s[24:27], s54 offen
s_mov_b32 s54, 98304
buffer_load_dword v11, v15, s[24:27], s54 offen
s_mov_b32 s54, 131072
buffer_load_dword v11, v15, s[24:27], s54 offen
s_waitcnt vmcnt(0)
v_readfirstlane_b32 s33, v13
s_nop 0
s_add_u32 s33, s33, 16
s_cmp_eq_u32 s3, 0
s_cbranch_scc0 L_np1
s_lshl_b32 s54, s6, 4
s_add_u32 s54, s54, s4
s_mul_i32 s54, s54, 4352
s_lshl_b32 s55, s5, 2
s_add_u32 s54, s54, s55
s_add_u32 s54, s54, 0x1000800
s_add_u32 s55, s33, 1
v_mov_b32 v5, s55
v_mov_b32 v6, s54
s_mov_b64 exec, 1
global_store_dword v6, v5, s[52:53] sc1
s_mov_b64 exec, -1
L_np1:
s_xor_b32 s5, s5, 1
s_cmp_eq_u32 s3, 0
s_cbranch_scc0 L_wpd2
s_lshl_b32 s54, 1, 4
s_add_u32 s54, s54, s4
s_mul_i32 s54, s54, 4352
s_lshl_b32 s55, s5, 2
s_add_u32 s54, s54, s55
s_add_u32 s54, s54, 0x1000800
v_mov_b32 v6, s54
s_add_u32 s55, s33, 1
s_mov_b32 s32, 65536
L_wp2:
global_load_dword v11, v6, s[52:53] sc1
s_waitcnt vmcnt(0)
v_subrev_u32 v11, s55, v11
v_cmp_lt_u32 vcc, 3, v11
s_nop 1
s_cmp_eq_u64 vcc, 0
s_cbranch_scc1 L_wpd2
s_sleep 16
s_sub_u32 s32, s32, 1
s_cmp_lg_u32 s32, 0
s_cbranch_scc1 L_wp2
L_wpd2:
s_barrier
s_xor_b32 s5, s5, 1
s_branch L_A1c
L_noA1:
s_waitcnt vmcnt(8)
v_readfirstlane_b32 s33, v13
s_nop 0
s_add_u32 s33, s33, 16
s_barrier
L_A1c:
s_cmp_eq_u32 s6, 0
s_cselect_b64 vcc, -1, 0
ds_read_b64_tr_b16 a[152:153], v20 offset:0
ds_read_b64_tr_b16 a[154:155], v20 offset:4096
ds_read_b64_tr_b16 a[156:157], v21 offset:0
ds_read_b64_tr_b16 a[158:159], v21 offset:4096
ds_read_b64_tr_b16 a[160:161], v22 offset:0
ds_read_b64_tr_b16 a[162:163], v22 offset:4096
ds_read_b64_tr_b16 a[164:165], v23 offset:0
ds_read_b64_tr_b16 a[166:167], v23 offset:4096
ds_read_b64_tr_b16 a[168:169], v24 offset:0
ds_read_b64_tr_b16 a[170:171], v24 offset:4096
ds_read_b64_tr_b16 a[172:173], v25 offset:0
ds_read_b64_tr_b16 a[174:175], v25 offset:4096
ds_read_b64_tr_b16 a[176:177], v26 offset:0
ds_read_b64_tr_b16 a[178:179], v26 offset:4096
ds_read_b64_tr_b16 a[180:181], v27 offset:0
ds_read_b64_tr_b16 a[182:183], v27 offset:4096
ds_read_b128 a[216:219], v16 offset:0
ds_read_b128 a[220:223], v16 offset:4096
ds_read_b128 a[224:227], v16 offset:8192
ds_read_b128 a[228:231], v16 offset:12288
ds_read_b128 a[232:235], v16 offset:16384
s_waitcnt lgkmcnt(0)
s_cmp_gt_i32 s91, 0
s_cselect_b32 s92, s88, 0x7f000000
s_sub_u32 s91, s91, 1
s_add_u32 s88, s88, s89
s_and_b32 s88, s88, s90
s_add_u32 m0, s93, 0
s_nop 0
buffer_load_dwordx4 v244, s[16:19], s92 offen offset:0 lds
buffer_load_dwordx4 v245, s[16:19], s92 offen offset:1024 lds
buffer_load_dwordx4 v246, s[16:19], s92 offen offset:2048 lds
buffer_load_dwordx4 v247, s[16:19], s92 offen offset:3072 lds
s_add_u32 m0, s93, 4096
s_nop 0
buffer_load_dwordx4 v248, s[16:19], s92 offen offset:0 lds
buffer_load_dwordx4 v249, s[16:19], s92 offen offset:1024 lds
buffer_load_dwordx4 v250, s[16:19], s92 offen offset:2048 lds
buffer_load_dwordx4 v251, s[16:19], s92 offen offset:3072 lds
s_waitcnt vmcnt(8)
v_mfma_f32_16x16x32_bf16 v[48:51], a[152:155], a[216:219], 0
ds_read_b64_tr_b16 a[184:185], v20 offset:8192
s_add_u32 m0, s99, 0
v_mfma_f32_16x16x32_bf16 v[52:55], a[152:155], a[220:223], 0
ds_read_b64_tr_b16 a[186:187], v20 offset:12288
buffer_load_dwordx4 v208, s[20:23], s98 offen lds
v_mfma_f32_16x16x32_bf16 v[56:59], a[152:155], a[224:227], 0
ds_read_b64_tr_b16 a[188:189], v21 offset:8192
s_add_u32 m0, s99, 1024
v_mfma_f32_16x16x32_bf16 v[60:63], a[152:155], a[228:231], 0
ds_read_b64_tr_b16 a[190:191], v21 offset:12288
buffer_load_dwordx4 v209, s[20:23], s98 offen lds
v_mfma_f32_16x16x32_bf16 v[64:67], a[152:155], a[232:235], 0
ds_read_b64_tr_b16 a[192:193], v22 offset:8192
s_add_u32 m0, s99, 2048
v_mfma_f32_16x16x32_bf16 v[68:71], a[156:159], a[216:219], 0
ds_read_b64_tr_b16 a[194:195], v22 offset:12288
buffer_load_dwordx4 v210, s[20:23], s98 offen lds
v_mfma_f32_16x16x32_bf16 v[72:75], a[156:159], a[220:223], 0
ds_read_b64_tr_b16 a[196:197], v23 offset:8192
s_add_u32 m0, s99, 3072
v_mfma_f32_16x16x32_bf16 v[76:79], a[156:159], a[224:227], 0
ds_read_b64_tr_b16 a[198:199], v23 offset:12288
buffer_load_dwordx4 v211, s[20:23], s98 offen lds
v_mfma_f32_16x16x32_bf16 v[80:83], a[156:159], a[228:231], 0
ds_read_b64_tr_b16 a[200:201], v24 offset:8192
s_add_u32 m0, s99, 4096
v_mfma_f32_16x16x32_bf16 v[84:87], a[156:159], a[232:235], 0
ds_read_b64_tr_b16 a[202:203], v24 offset:12288
buffer_load_dwordx4 v212, s[20:23], s98 offen lds
v_mfma_f32_16x16x32_bf16 v[88:91], a[160:163], a[216:219], 0
ds_read_b64_tr_b16 a[204:205], v25 offset:8192
s_add_u32 s98, s98, 256
s_and_b32 s98, s98, s7
s_add_u32 s99, s99, s35
s_add_u32 m0, s99, 0
v_mfma_f32_16x16x32_bf16 v[92:95], a[160:163], a[220:223], 0
ds_read_b64_tr_b16 a[206:207], v25 offset:12288
buffer_load_dwordx4 v208, s[20:23], s98 offen lds
v_mfma_f32_16x16x32_bf16 v[96:99], a[160:163], a[224:227], 0
ds_read_b64_tr_b16 a[208:209], v26 offset:8192
s_add_u32 m0, s99, 1024
v_mfma_f32_16x16x32_bf16 v[100:103], a[160:163], a[228:231], 0
ds_read_b64_tr_b16 a[210:211], v26 offset:12288
buffer_load_dwordx4 v209, s[20:23], s98 offen lds
v_mfma_f32_16x16x32_bf16 v[104:107], a[160:163], a[232:235], 0
ds_read_b64_tr_b16 a[212:213], v27 offset:8192
s_add_u32 m0, s99, 2048
v_mfma_f32_16x16x32_bf16 v[108:111], a[164:167], a[216:219], 0
ds_read_b64_tr_b16 a[214:215], v27 offset:12288
buffer_load_dwordx4 v210, s[20:23], s98 offen lds
v_mfma_f32_16x16x32_bf16 v[112:115], a[164:167], a[220:223], 0
ds_read_b128 a[236:239], v17 offset:0
s_add_u32 m0, s99, 3072
v_mfma_f32_16x16x32_bf16 v[116:119], a[164:167], a[224:227], 0
ds_read_b128 a[240:243], v17 offset:4096
buffer_load_dwordx4 v211, s[20:23], s98 offen lds
v_mfma_f32_16x16x32_bf16 v[120:123], a[164:167], a[228:231], 0
ds_read_b128 a[244:247], v17 offset:8192
s_add_u32 m0, s99, 4096
v_mfma_f32_16x16x32_bf16 v[124:127], a[164:167], a[232:235], 0
ds_read_b128 a[248:251], v17 offset:12288
buffer_load_dwordx4 v212, s[20:23], s98 offen lds
v_mfma_f32_16x16x32_bf16 v[128:131], a[168:171], a[216:219], 0
ds_read_b128 a[252:255], v17 offset:16384
s_add_u32 s98, s98, 256
s_and_b32 s98, s98, s7
s_add_u32 s99, s99, s35
v_mfma_f32_16x16x32_bf16 v[132:135], a[168:171], a[220:223], 0
s_cmp_gt_i32 s91, 0
s_cselect_b32 s92, s88, 0x7f000000
v_mfma_f32_16x16x32_bf16 v[136:139], a[168:171], a[224:227], 0
s_sub_u32 s91, s91, 1
s_add_u32 s88, s88, s89
v_mfma_f32_16x16x32_bf16 v[140:143], a[168:171], a[228:231], 0
s_and_b32 s88, s88, s90
s_add_u32 m0, s93, 8192
v_mfma_f32_16x16x32_bf16 v[144:147], a[168:171], a[232:235], 0
s_waitcnt lgkmcnt(5)
buffer_load_dwordx4 v244, s[16:19], s92 offen offset:0 lds
v_mfma_f32_16x16x32_bf16 v[148:151], a[172:175], a[216:219], 0
v_mfma_f32_16x16x32_bf16 v[152:155], a[172:175], a[220:223], 0
buffer_load_dwordx4 v245, s[16:19], s92 offen offset:1024 lds
v_mfma_f32_16x16x32_bf16 v[156:159], a[172:175], a[224:227], 0
v_mfma_f32_16x16x32_bf16 v[160:163], a[172:175], a[228:231], 0
buffer_load_dwordx4 v246, s[16:19], s92 offen offset:2048 lds
v_mfma_f32_16x16x32_bf16 v[164:167], a[172:175], a[232:235], 0
v_mfma_f32_16x16x32_bf16 v[168:171], a[176:179], a[216:219], 0
buffer_load_dwordx4 v247, s[16:19], s92 offen offset:3072 lds
v_mfma_f32_16x16x32_bf16 v[172:175], a[176:179], a[220:223], 0
s_add_u32 m0, s93, 12288
v_mfma_f32_16x16x32_bf16 v[176:179], a[176:179], a[224:227], 0
buffer_load_dwordx4 v248, s[16:19], s92 offen offset:0 lds
v_mfma_f32_16x16x32_bf16 v[180:183], a[176:179], a[228:231], 0
v_mfma_f32_16x16x32_bf16 v[184:187], a[176:179], a[232:235], 0
buffer_load_dwordx4 v249, s[16:19], s92 offen offset:1024 lds
v_mfma_f32_16x16x32_bf16 v[188:191], a[180:183], a[216:219], 0
v_mfma_f32_16x16x32_bf16 v[192:195], a[180:183], a[220:223], 0
buffer_load_dwordx4 v250, s[16:19], s92 offen offset:2048 lds
v_mfma_f32_16x16x32_bf16 v[196:199], a[180:183], a[224:227], 0
v_mfma_f32_16x16x32_bf16 v[200:203], a[180:183], a[228:231], 0
v_mfma_f32_16x16x32_bf16 v[204:207], a[180:183], a[232:235], 0
s_waitcnt lgkmcnt(0)
buffer_load_dwordx4 v251, s[16:19], s92 offen offset:3072 lds
s_waitcnt vmcnt(18)
v_mfma_f32_16x16x32_bf16 v[48:51], a[184:187], a[236:239], v[48:51]
ds_read_b64_tr_b16 a[152:153], v20 offset:0
s_add_u32 m0, s99, 0
v_mfma_f32_16x16x32_bf16 v[52:55], a[184:187], a[240:243], v[52:55]
ds_read_b64_tr_b16 a[154:155], v20 offset:4096
buffer_load_dwordx4 v208, s[20:23], s98 offen lds
v_mfma_f32_16x16x32_bf16 v[56:59], a[184:187], a[244:247], v[56:59]
ds_read_b64_tr_b16 a[156:157], v21 offset:0
s_add_u32 m0, s99, 1024
v_mfma_f32_16x16x32_bf16 v[60:63], a[184:187], a[248:251], v[60:63]
ds_read_b64_tr_b16 a[158:159], v21 offset:4096
buffer_load_dwordx4 v209, s[20:23], s98 offen lds
v_mfma_f32_16x16x32_bf16 v[64:67], a[184:187], a[252:255], v[64:67]
ds_read_b64_tr_b16 a[160:161], v22 offset:0
s_add_u32 m0, s99, 2048
v_mfma_f32_16x16x32_bf16 v[68:71], a[188:191], a[236:239], v[68:71]
ds_read_b64_tr_b16 a[162:163], v22 offset:4096
buffer_load_dwordx4 v210, s[20:23], s98 offen lds
v_mfma_f32_16x16x32_bf16 v[72:75], a[188:191], a[240:243], v[72:75]
ds_read_b64_tr_b16 a[164:165], v23 offset:0
s_add_u32 m0, s99, 3072
v_mfma_f32_16x16x32_bf16 v[76:79], a[188:191], a[244:247], v[76:79]
ds_read_b64_tr_b16 a[166:167], v23 offset:4096
buffer_load_dwordx4 v211, s[20:23], s98 offen lds
v_mfma_f32_16x16x32_bf16 v[80:83], a[188:191], a[248:251], v[80:83]
ds_read_b64_tr_b16 a[168:169], v24 offset:0
s_add_u32 m0, s99, 4096
v_mfma_f32_16x16x32_bf16 v[84:87], a[188:191], a[252:255], v[84:87]
ds_read_b64_tr_b16 a[170:171], v24 offset:4096
buffer_load_dwordx4 v212, s[20:23], s98 offen lds
v_mfma_f32_16x16x32_bf16 v[88:91], a[192:195], a[236:239], v[88:91]
ds_read_b64_tr_b16 a[172:173], v25 offset:0
s_add_u32 s98, s98, 256
s_and_b32 s98, s98, s7
s_add_u32 s99, s99, s35
v_mfma_f32_16x16x32_bf16 v[92:95], a[192:195], a[240:243], v[92:95]
ds_read_b64_tr_b16 a[174:175], v25 offset:4096
v_mfma_f32_16x16x32_bf16 v[96:99], a[192:195], a[244:247], v[96:99]
ds_read_b64_tr_b16 a[176:177], v26 offset:0
v_mfma_f32_16x16x32_bf16 v[100:103], a[192:195], a[248:251], v[100:103]
ds_read_b64_tr_b16 a[178:179], v26 offset:4096
v_mfma_f32_16x16x32_bf16 v[104:107], a[192:195], a[252:255], v[104:107]
ds_read_b64_tr_b16 a[180:181], v27 offset:0
v_mfma_f32_16x16x32_bf16 v[108:111], a[196:199], a[236:239], v[108:111]
ds_read_b64_tr_b16 a[182:183], v27 offset:4096
v_mfma_f32_16x16x32_bf16 v[112:115], a[196:199], a[240:243], v[112:115]
ds_read_b128 a[216:219], v18 offset:0
v_mfma_f32_16x16x32_bf16 v[116:119], a[196:199], a[244:247], v[116:119]
ds_read_b128 a[220:223], v18 offset:4096
v_mfma_f32_16x16x32_bf16 v[120:123], a[196:199], a[248:251], v[120:123]
ds_read_b128 a[224:227], v18 offset:8192
v_mfma_f32_16x16x32_bf16 v[124:127], a[196:199], a[252:255], v[124:127]
ds_read_b128 a[228:231], v18 offset:12288
v_mfma_f32_16x16x32_bf16 v[128:131], a[200:203], a[236:239], v[128:131]
ds_read_b128 a[232:235], v18 offset:16384
v_mfma_f32_16x16x32_bf16 v[132:135], a[200:203], a[240:243], v[132:135]
s_cmp_gt_i32 s91, 0
s_cselect_b32 s92, s88, 0x7f000000
v_mfma_f32_16x16x32_bf16 v[136:139], a[200:203], a[244:247], v[136:139]
s_sub_u32 s91, s91, 1
s_add_u32 s88, s88, s89
v_mfma_f32_16x16x32_bf16 v[140:143], a[200:203], a[248:251], v[140:143]
s_and_b32 s88, s88, s90
s_add_u32 m0, s93, 0
v_mfma_f32_16x16x32_bf16 v[144:147], a[200:203], a[252:255], v[144:147]
s_waitcnt lgkmcnt(5)
buffer_load_dwordx4 v244, s[16:19], s92 offen offset:0 lds
v_mfma_f32_16x16x32_bf16 v[148:151], a[204:207], a[236:239], v[148:151]
v_mfma_f32_16x16x32_bf16 v[152:155], a[204:207], a[240:243], v[152:155]
buffer_load_dwordx4 v245, s[16:19], s92 offen offset:1024 lds
v_mfma_f32_16x16x32_bf16 v[156:159], a[204:207], a[244:247], v[156:159]
v_mfma_f32_16x16x32_bf16 v[160:163], a[204:207], a[248:251], v[160:163]
buffer_load_dwordx4 v246, s[16:19], s92 offen offset:2048 lds
v_mfma_f32_16x16x32_bf16 v[164:167], a[204:207], a[252:255], v[164:167]
v_mfma_f32_16x16x32_bf16 v[168:171], a[208:211], a[236:239], v[168:171]
buffer_load_dwordx4 v247, s[16:19], s92 offen offset:3072 lds
v_mfma_f32_16x16x32_bf16 v[172:175], a[208:211], a[240:243], v[172:175]
s_add_u32 m0, s93, 4096
v_mfma_f32_16x16x32_bf16 v[176:179], a[208:211], a[244:247], v[176:179]
buffer_load_dwordx4 v248, s[16:19], s92 offen offset:0 lds
v_mfma_f32_16x16x32_bf16 v[180:183], a[208:211], a[248:251], v[180:183]
v_mfma_f32_16x16x32_bf16 v[184:187], a[208:211], a[252:255], v[184:187]
buffer_load_dwordx4 v249, s[16:19], s92 offen offset:1024 lds
v_mfma_f32_16x16x32_bf16 v[188:191], a[212:215], a[236:239], v[188:191]
v_mfma_f32_16x16x32_bf16 v[192:195], a[212:215], a[240:243], v[192:195]
buffer_load_dwordx4 v250, s[16:19], s92 offen offset:2048 lds
v_mfma_f32_16x16x32_bf16 v[196:199], a[212:215], a[244:247], v[196:199]
v_mfma_f32_16x16x32_bf16 v[200:203], a[212:215], a[248:251], v[200:203]
v_mfma_f32_16x16x32_bf16 v[204:207], a[212:215], a[252:255], v[204:207]
s_waitcnt lgkmcnt(0)
buffer_load_dwordx4 v251, s[16:19], s92 offen offset:3072 lds
s_waitcnt vmcnt(13)
v_mfma_f32_16x16x32_bf16 v[48:51], a[152:155], a[216:219], v[48:51]
ds_read_b64_tr_b16 a[184:185], v20 offset:8192
v_mfma_f32_16x16x32_bf16 v[52:55], a[152:155], a[220:223], v[52:55]
ds_read_b64_tr_b16 a[186:187], v20 offset:12288
v_mfma_f32_16x16x32_bf16 v[56:59], a[152:155], a[224:227], v[56:59]
ds_read_b64_tr_b16 a[188:189], v21 offset:8192
v_mfma_f32_16x16x32_bf16 v[60:63], a[152:155], a[228:231], v[60:63]
ds_read_b64_tr_b16 a[190:191], v21 offset:12288
v_mfma_f32_16x16x32_bf16 v[64:67], a[152:155], a[232:235], v[64:67]
ds_read_b64_tr_b16 a[192:193], v22 offset:8192
v_mfma_f32_16x16x32_bf16 v[68:71], a[156:159], a[216:219], v[68:71]
ds_read_b64_tr_b16 a[194:195], v22 offset:12288
v_mfma_f32_16x16x32_bf16 v[72:75], a[156:159], a[220:223], v[72:75]
ds_read_b64_tr_b16 a[196:197], v23 offset:8192
v_mfma_f32_16x16x32_bf16 v[76:79], a[156:159], a[224:227], v[76:79]
ds_read_b64_tr_b16 a[198:199], v23 offset:12288
v_mfma_f32_16x16x32_bf16 v[80:83], a[156:159], a[228:231], v[80:83]
ds_read_b64_tr_b16 a[200:201], v24 offset:8192
v_mfma_f32_16x16x32_bf16 v[84:87], a[156:159], a[232:235], v[84:87]
ds_read_b64_tr_b16 a[202:203], v24 offset:12288
v_mfma_f32_16x16x32_bf16 v[88:91], a[160:163], a[216:219], v[88:91]
ds_read_b64_tr_b16 a[204:205], v25 offset:8192
v_mfma_f32_16x16x32_bf16 v[92:95], a[160:163], a[220:223], v[92:95]
ds_read_b64_tr_b16 a[206:207], v25 offset:12288
v_mfma_f32_16x16x32_bf16 v[96:99], a[160:163], a[224:227], v[96:99]
ds_read_b64_tr_b16 a[208:209], v26 offset:8192
v_mfma_f32_16x16x32_bf16 v[100:103], a[160:163], a[228:231], v[100:103]
ds_read_b64_tr_b16 a[210:211], v26 offset:12288
v_mfma_f32_16x16x32_bf16 v[104:107], a[160:163], a[232:235], v[104:107]
ds_read_b64_tr_b16 a[212:213], v27 offset:8192
v_mfma_f32_16x16x32_bf16 v[108:111], a[164:167], a[216:219], v[108:111]
ds_read_b64_tr_b16 a[214:215], v27 offset:12288
v_mfma_f32_16x16x32_bf16 v[112:115], a[164:167], a[220:223], v[112:115]
ds_read_b128 a[236:239], v19 offset:0
v_mfma_f32_16x16x32_bf16 v[116:119], a[164:167], a[224:227], v[116:119]
ds_read_b128 a[240:243], v19 offset:4096
v_mfma_f32_16x16x32_bf16 v[120:123], a[164:167], a[228:231], v[120:123]
ds_read_b128 a[244:247], v19 offset:8192
v_mfma_f32_16x16x32_bf16 v[124:127], a[164:167], a[232:235], v[124:127]
ds_read_b128 a[248:251], v19 offset:12288
v_mfma_f32_16x16x32_bf16 v[128:131], a[168:171], a[216:219], v[128:131]
ds_read_b128 a[252:255], v19 offset:16384
v_mfma_f32_16x16x32_bf16 v[132:135], a[168:171], a[220:223], v[132:135]
s_cmp_gt_i32 s91, 0
s_cselect_b32 s92, s88, 0x7f000000
v_mfma_f32_16x16x32_bf16 v[136:139], a[168:171], a[224:227], v[136:139]
s_sub_u32 s91, s91, 1
s_add_u32 s88, s88, s89
v_mfma_f32_16x16x32_bf16 v[140:143], a[168:171], a[228:231], v[140:143]
s_and_b32 s88, s88, s90
s_add_u32 m0, s93, 8192
v_mfma_f32_16x16x32_bf16 v[144:147], a[168:171], a[232:235], v[144:147]
s_waitcnt lgkmcnt(5)
buffer_load_dwordx4 v244, s[16:19], s92 offen offset:0 lds
v_mfma_f32_16x16x32_bf16 v[148:151], a[172:175], a[216:219], v[148:151]
v_mfma_f32_16x16x32_bf16 v[152:155], a[172:175], a[220:223], v[152:155]
buffer_load_dwordx4 v245, s[16:19], s92 offen offset:1024 lds
v_mfma_f32_16x16x32_bf16 v[156:159], a[172:175], a[224:227], v[156:159]
v_mfma_f32_16x16x32_bf16 v[160:163], a[172:175], a[228:231], v[160:163]
buffer_load_dwordx4 v246, s[16:19], s92 offen offset:2048 lds
v_mfma_f32_16x16x32_bf16 v[164:167], a[172:175], a[232:235], v[164:167]
v_mfma_f32_16x16x32_bf16 v[168:171], a[176:179], a[216:219], v[168:171]
buffer_load_dwordx4 v247, s[16:19], s92 offen offset:3072 lds
v_mfma_f32_16x16x32_bf16 v[172:175], a[176:179], a[220:223], v[172:175]
s_add_u32 m0, s93, 12288
v_mfma_f32_16x16x32_bf16 v[176:179], a[176:179], a[224:227], v[176:179]
buffer_load_dwordx4 v248, s[16:19], s92 offen offset:0 lds
v_mfma_f32_16x16x32_bf16 v[180:183], a[176:179], a[228:231], v[180:183]
v_mfma_f32_16x16x32_bf16 v[184:187], a[176:179], a[232:235], v[184:187]
buffer_load_dwordx4 v249, s[16:19], s92 offen offset:1024 lds
v_mfma_f32_16x16x32_bf16 v[188:191], a[180:183], a[216:219], v[188:191]
v_mfma_f32_16x16x32_bf16 v[192:195], a[180:183], a[220:223], v[192:195]
buffer_load_dwordx4 v250, s[16:19], s92 offen offset:2048 lds
v_mfma_f32_16x16x32_bf16 v[196:199], a[180:183], a[224:227], v[196:199]
v_mfma_f32_16x16x32_bf16 v[200:203], a[180:183], a[228:231], v[200:203]
v_mfma_f32_16x16x32_bf16 v[204:207], a[180:183], a[232:235], v[204:207]
s_waitcnt lgkmcnt(0)
buffer_load_dwordx4 v251, s[16:19], s92 offen offset:3072 lds
s_waitcnt vmcnt(8)
s_barrier
v_add_u32 v16, 20480, v16
v_add_u32 v17, 20480, v17
v_add_u32 v18, 20480, v18
v_add_u32 v19, 20480, v19
v_mfma_f32_16x16x32_bf16 v[48:51], a[184:187], a[236:239], v[48:51]
ds_read_b64_tr_b16 a[152:153], v20 offset:0
v_mfma_f32_16x16x32_bf16 v[52:55], a[184:187], a[240:243], v[52:55]
ds_read_b64_tr_b16 a[154:155], v20 offset:4096
v_mfma_f32_16x16x32_bf16 v[56:59], a[184:187], a[244:247], v[56:59]
ds_read_b64_tr_b16 a[156:157], v21 offset:0
v_mfma_f32_16x16x32_bf16 v[60:63], a[184:187], a[248:251], v[60:63]
ds_read_b64_tr_b16 a[158:159], v21 offset:4096
v_mfma_f32_16x16x32_bf16 v[64:67], a[184:187], a[252:255], v[64:67]
ds_read_b64_tr_b16 a[160:161], v22 offset:0
v_mfma_f32_16x16x32_bf16 v[68:71], a[188:191], a[236:239], v[68:71]
ds_read_b64_tr_b16 a[162:163], v22 offset:4096
v_mfma_f32_16x16x32_bf16 v[72:75], a[188:191], a[240:243], v[72:75]
ds_read_b64_tr_b16 a[164:165], v23 offset:0
v_mfma_f32_16x16x32_bf16 v[76:79], a[188:191], a[244:247], v[76:79]
ds_read_b64_tr_b16 a[166:167], v23 offset:4096
v_mfma_f32_16x16x32_bf16 v[80:83], a[188:191], a[248:251], v[80:83]
ds_read_b64_tr_b16 a[168:169], v24 offset:0
v_mfma_f32_16x16x32_bf16 v[84:87], a[188:191], a[252:255], v[84:87]
ds_read_b64_tr_b16 a[170:171], v24 offset:4096
v_mfma_f32_16x16x32_bf16 v[88:91], a[192:195], a[236:239], v[88:91]
ds_read_b64_tr_b16 a[172:173], v25 offset:0
v_mfma_f32_16x16x32_bf16 v[92:95], a[192:195], a[240:243], v[92:95]
ds_read_b64_tr_b16 a[174:175], v25 offset:4096
v_mfma_f32_16x16x32_bf16 v[96:99], a[192:195], a[244:247], v[96:99]
ds_read_b64_tr_b16 a[176:177], v26 offset:0
v_mfma_f32_16x16x32_bf16 v[100:103], a[192:195], a[248:251], v[100:103]
ds_read_b64_tr_b16 a[178:179], v26 offset:4096
v_mfma_f32_16x16x32_bf16 v[104:107], a[192:195], a[252:255], v[104:107]
ds_read_b64_tr_b16 a[180:181], v27 offset:0
v_mfma_f32_16x16x32_bf16 v[108:111], a[196:199], a[236:239], v[108:111]
ds_read_b64_tr_b16 a[182:183], v27 offset:4096
v_mfma_f32_16x16x32_bf16 v[112:115], a[196:199], a[240:243], v[112:115]
ds_read_b128 a[216:219], v16 offset:0
v_mfma_f32_16x16x32_bf16 v[116:119], a[196:199], a[244:247], v[116:119]
ds_read_b128 a[220:223], v16 offset:4096
v_mfma_f32_16x16x32_bf16 v[120:123], a[196:199], a[248:251], v[120:123]
ds_read_b128 a[224:227], v16 offset:8192
v_mfma_f32_16x16x32_bf16 v[124:127], a[196:199], a[252:255], v[124:127]
ds_read_b128 a[228:231], v16 offset:12288
v_mfma_f32_16x16x32_bf16 v[128:131], a[200:203], a[236:239], v[128:131]
ds_read_b128 a[232:235], v16 offset:16384
v_mfma_f32_16x16x32_bf16 v[132:135], a[200:203], a[240:243], v[132:135]
s_cmp_gt_i32 s91, 0
s_cselect_b32 s92, s88, 0x7f000000
v_mfma_f32_16x16x32_bf16 v[136:139], a[200:203], a[244:247], v[136:139]
s_sub_u32 s91, s91, 1
s_add_u32 s88, s88, s89
v_mfma_f32_16x16x32_bf16 v[140:143], a[200:203], a[248:251], v[140:143]
s_and_b32 s88, s88, s90
s_add_u32 m0, s93, 0
v_mfma_f32_16x16x32_bf16 v[144:147], a[200:203], a[252:255], v[144:147]
s_waitcnt lgkmcnt(5)
buffer_load_dwordx4 v244, s[16:19], s92 offen offset:0 lds
v_mfma_f32_16x16x32_bf16 v[148:151], a[204:207], a[236:239], v[148:151]
v_mfma_f32_16x16x32_bf16 v[152:155], a[204:207], a[240:243], v[152:155]
buffer_load_dwordx4 v245, s[16:19], s92 offen offset:1024 lds
v_mfma_f32_16x16x32_bf16 v[156:159], a[204:207], a[244:247], v[156:159]
v_mfma_f32_16x16x32_bf16 v[160:163], a[204:207], a[248:251], v[160:163]
buffer_load_dwordx4 v246, s[16:19], s92 offen offset:2048 lds
v_mfma_f32_16x16x32_bf16 v[164:167], a[204:207], a[252:255], v[164:167]
v_mfma_f32_16x16x32_bf16 v[168:171], a[208:211], a[236:239], v[168:171]
buffer_load_dwordx4 v247, s[16:19], s92 offen offset:3072 lds
v_mfma_f32_16x16x32_bf16 v[172:175], a[208:211], a[240:243], v[172:175]
s_add_u32 m0, s93, 4096
v_mfma_f32_16x16x32_bf16 v[176:179], a[208:211], a[244:247], v[176:179]
buffer_load_dwordx4 v248, s[16:19], s92 offen offset:0 lds
v_mfma_f32_16x16x32_bf16 v[180:183], a[208:211], a[248:251], v[180:183]
v_mfma_f32_16x16x32_bf16 v[184:187], a[208:211], a[252:255], v[184:187]
buffer_load_dwordx4 v249, s[16:19], s92 offen offset:1024 lds
v_mfma_f32_16x16x32_bf16 v[188:191], a[212:215], a[236:239], v[188:191]
v_mfma_f32_16x16x32_bf16 v[192:195], a[212:215], a[240:243], v[192:195]
buffer_load_dwordx4 v250, s[16:19], s92 offen offset:2048 lds
v_mfma_f32_16x16x32_bf16 v[196:199], a[212:215], a[244:247], v[196:199]
v_mfma_f32_16x16x32_bf16 v[200:203], a[212:215], a[248:251], v[200:203]
v_mfma_f32_16x16x32_bf16 v[204:207], a[212:215], a[252:255], v[204:207]
s_waitcnt lgkmcnt(0)
buffer_load_dwordx4 v251, s[16:19], s92 offen offset:3072 lds
s_call_b64 s[60:61], F_gemm
s_cmp_eq_u32 s6, 0
s_cbranch_scc1 L_roleA
s_lshl_b32 s54, s4, 3
s_add_u32 s54, s54, s5
s_lshl_b32 s54, s54, 2
s_add_u32 s54, s54, s3
s_lshl_b32 s54, s54, 18
s_add_u32 s8, s38, s54
s_addc_u32 s9, s39, 0
s_mov_b32 s10, 0x40000
s_mov_b32 s11, 0x20000
s_add_u32 s12, s40, s54
s_addc_u32 s13, s41, 0
s_mov_b32 s14, 0x40000
s_mov_b32 s15, 0x20000
v_add_u32 v5, 0, v2
v_xor_b32 v7, v5, v3
v_lshlrev_b32 v7, 4, v7
v_lshl_add_u32 v28, v2, 8, v7
v_lshlrev_b32 v7, 1, v5
v_xor_b32 v7, v7, v3
v_lshlrev_b32 v7, 4, v7
v_lshl_add_u32 v32, v2, 8, v7
v_add_u32 v5, 4, v2
v_xor_b32 v7, v5, v3
v_lshlrev_b32 v7, 4, v7
v_lshl_add_u32 v29, v2, 8, v7
v_lshlrev_b32 v7, 1, v5
v_xor_b32 v7, v7, v3
v_lshlrev_b32 v7, 4, v7
v_lshl_add_u32 v33, v2, 8, v7
v_add_u32 v5, 8, v2
v_xor_b32 v7, v5, v3
v_lshlrev_b32 v7, 4, v7
v_lshl_add_u32 v30, v2, 8, v7
v_add_u32 v5, 12, v2
v_xor_b32 v7, v5, v3
v_lshlrev_b32 v7, 4, v7
v_lshl_add_u32 v31, v2, 8, v7
s_mov_b32 s95, 0
s_lshr_b32 s95, s54, 18
s_mul_i32 s95, s95, 11
s_lshr_b32 s95, s95, 0
s_and_b32 s95, s95, 31
s_lshl_b32 s95, s95, 13
s_mov_b32 s96, s95
s_add_u32 s101, s95, 73728
v_lshlrev_b32 v15, 7, v1
s_cmp_eq_u32 s3, 0
s_cbranch_scc0 L_np3
s_lshl_b32 s54, s6, 4
s_add_u32 s54, s54, s4
s_mul_i32 s54, s54, 4352
s_lshl_b32 s55, s5, 2
s_add_u32 s54, s54, s55
s_add_u32 s54, s54, 0x1000800
s_add_u32 s55, s33, 1
v_mov_b32 v5, s55
v_mov_b32 v6, s54
s_mov_b64 exec, 1
global_store_dword v6, v5, s[52:53] sc1
s_mov_b64 exec, -1
L_np3:
s_waitcnt vmcnt(8)
s_barrier
v_mfma_f32_16x16x32_bf16 v[48:51], a[152:155], a[216:219], v[48:51]
ds_read_b64_tr_b16 a[184:185], v20 offset:8192
v_mfma_f32_16x16x32_bf16 v[52:55], a[152:155], a[220:223], v[52:55]
ds_read_b64_tr_b16 a[186:187], v20 offset:12288
v_mfma_f32_16x16x32_bf16 v[56:59], a[152:155], a[224:227], v[56:59]
ds_read_b64_tr_b16 a[188:189], v21 offset:8192
v_mfma_f32_16x16x32_bf16 v[60:63], a[152:155], a[228:231], v[60:63]
ds_read_b64_tr_b16 a[190:191], v21 offset:12288
v_mfma_f32_16x16x32_bf16 v[64:67], a[152:155], a[232:235], v[64:67]
ds_read_b64_tr_b16 a[192:193], v22 offset:8192
v_mfma_f32_16x16x32_bf16 v[68:71], a[156:159], a[216:219], v[68:71]
ds_read_b64_tr_b16 a[194:195], v22 offset:12288
v_mfma_f32_16x16x32_bf16 v[72:75], a[156:159], a[220:223], v[72:75]
ds_read_b64_tr_b16 a[196:197], v23 offset:8192
v_mfma_f32_16x16x32_bf16 v[76:79], a[156:159], a[224:227], v[76:79]
ds_read_b64_tr_b16 a[198:199], v23 offset:12288
v_mfma_f32_16x16x32_bf16 v[80:83], a[156:159], a[228:231], v[80:83]
ds_read_b64_tr_b16 a[200:201], v24 offset:8192
v_mfma_f32_16x16x32_bf16 v[84:87], a[156:159], a[232:235], v[84:87]
ds_read_b64_tr_b16 a[202:203], v24 offset:12288
v_mfma_f32_16x16x32_bf16 v[88:91], a[160:163], a[216:219], v[88:91]
ds_read_b64_tr_b16 a[204:205], v25 offset:8192
v_mfma_f32_16x16x32_bf16 v[92:95], a[160:163], a[220:223], v[92:95]
ds_read_b64_tr_b16 a[206:207], v25 offset:12288
v_mfma_f32_16x16x32_bf16 v[96:99], a[160:163], a[224:227], v[96:99]
ds_read_b64_tr_b16 a[208:209], v26 offset:8192
v_mfma_f32_16x16x32_bf16 v[100:103], a[160:163], a[228:231], v[100:103]
ds_read_b64_tr_b16 a[210:211], v26 offset:12288
v_mfma_f32_16x16x32_bf16 v[104:107], a[160:163], a[232:235], v[104:107]
ds_read_b64_tr_b16 a[212:213], v27 offset:8192
v_mfma_f32_16x16x32_bf16 v[108:111], a[164:167], a[216:219], v[108:111]
ds_read_b64_tr_b16 a[214:215], v27 offset:12288
v_mfma_f32_16x16x32_bf16 v[112:115], a[164:167], a[220:223], v[112:115]
ds_read_b128 a[236:239], v17 offset:0
v_mfma_f32_16x16x32_bf16 v[116:119], a[164:167], a[224:227], v[116:119]
ds_read_b128 a[240:243], v17 offset:4096
v_mfma_f32_16x16x32_bf16 v[120:123], a[164:167], a[228:231], v[120:123]
ds_read_b128 a[244:247], v17 offset:8192
v_mfma_f32_16x16x32_bf16 v[124:127], a[164:167], a[232:235], v[124:127]
ds_read_b128 a[248:251], v17 offset:12288
v_mfma_f32_16x16x32_bf16 v[128:131], a[168:171], a[216:219], v[128:131]
ds_read_b128 a[252:255], v17 offset:16384
v_mfma_f32_16x16x32_bf16 v[132:135], a[168:171], a[220:223], v[132:135]
s_cmp_gt_i32 s91, 0
s_cselect_b32 s92, s88, 0x7f000000
v_mfma_f32_16x16x32_bf16 v[136:139], a[168:171], a[224:227], v[136:139]
s_sub_u32 s91, s91, 1
s_add_u32 s88, s88, s89
v_mfma_f32_16x16x32_bf16 v[140:143], a[168:171], a[228:231], v[140:143]
s_and_b32 s88, s88, s90
s_add_u32 m0, s93, 8192
v_mfma_f32_16x16x32_bf16 v[144:147], a[168:171], a[232:235], v[144:147]
s_waitcnt lgkmcnt(5)
buffer_load_dwordx4 v244, s[16:19], s92 offen offset:0 lds
v_mfma_f32_16x16x32_bf16 v[148:151], a[172:175], a[216:219], v[148:151]
v_mfma_f32_16x16x32_bf16 v[152:155], a[172:175], a[220:223], v[152:155]
buffer_load_dwordx4 v245, s[16:19], s92 offen offset:1024 lds
v_mfma_f32_16x16x32_bf16 v[156:159], a[172:175], a[224:227], v[156:159]
v_mfma_f32_16x16x32_bf16 v[160:163], a[172:175], a[228:231], v[160:163]
buffer_load_dwordx4 v246, s[16:19], s92 offen offset:2048 lds
v_mfma_f32_16x16x32_bf16 v[164:167], a[172:175], a[232:235], v[164:167]
v_mfma_f32_16x16x32_bf16 v[168:171], a[176:179], a[216:219], v[168:171]
buffer_load_dwordx4 v247, s[16:19], s92 offen offset:3072 lds
v_mfma_f32_16x16x32_bf16 v[172:175], a[176:179], a[220:223], v[172:175]
s_add_u32 m0, s93, 12288
v_mfma_f32_16x16x32_bf16 v[176:179], a[176:179], a[224:227], v[176:179]
buffer_load_dwordx4 v248, s[16:19], s92 offen offset:0 lds
v_mfma_f32_16x16x32_bf16 v[180:183], a[176:179], a[228:231], v[180:183]
v_mfma_f32_16x16x32_bf16 v[184:187], a[176:179], a[232:235], v[184:187]
buffer_load_dwordx4 v249, s[16:19], s92 offen offset:1024 lds
v_mfma_f32_16x16x32_bf16 v[188:191], a[180:183], a[216:219], v[188:191]
v_mfma_f32_16x16x32_bf16 v[192:195], a[180:183], a[220:223], v[192:195]
buffer_load_dwordx4 v250, s[16:19], s92 offen offset:2048 lds
v_mfma_f32_16x16x32_bf16 v[196:199], a[180:183], a[224:227], v[196:199]
v_mfma_f32_16x16x32_bf16 v[200:203], a[180:183], a[228:231], v[200:203]
v_mfma_f32_16x16x32_bf16 v[204:207], a[180:183], a[232:235], v[204:207]
s_waitcnt lgkmcnt(0)
buffer_load_dwordx4 v251, s[16:19], s92 offen offset:3072 lds
s_waitcnt vmcnt(8)
v_mfma_f32_16x16x32_bf16 v[48:51], a[184:187], a[236:239], v[48:51]
ds_read_b64_tr_b16 a[152:153], v20 offset:0
s_lshl_b32 s54, s5, 19
s_lshl_b32 s55, s3, 8
v_mfma_f32_16x16x32_bf16 v[52:55], a[184:187], a[240:243], v[52:55]
ds_read_b64_tr_b16 a[154:155], v20 offset:4096
s_add_u32 s54, s54, s55
s_sub_u32 s55, 0x80000, s55
v_mfma_f32_16x16x32_bf16 v[56:59], a[184:187], a[244:247], v[56:59]
ds_read_b64_tr_b16 a[156:157], v21 offset:0
s_add_u32 s16, s44, s54
s_addc_u32 s17, s45, 0
s_mov_b32 s18, s55
v_mfma_f32_16x16x32_bf16 v[60:63], a[184:187], a[248:251], v[60:63]
ds_read_b64_tr_b16 a[158:159], v21 offset:4096
v_lshrrev_b32 v6, 1, v2
v_lshlrev_b32 v7, 10, v2
v_mfma_f32_16x16x32_bf16 v[64:67], a[184:187], a[252:255], v[64:67]
ds_read_b64_tr_b16 a[160:161], v22 offset:0
v_add_u32 v5, 0, v6
v_lshlrev_b32 v5, 2, v5
v_mfma_f32_16x16x32_bf16 v[68:71], a[188:191], a[236:239], v[68:71]
ds_read_b64_tr_b16 a[162:163], v22 offset:4096
v_xor_b32 v5, v5, v3
v_lshl_add_u32 v244, v5, 4, v7
v_mfma_f32_16x16x32_bf16 v[72:75], a[188:191], a[240:243], v[72:75]
ds_read_b64_tr_b16 a[164:165], v23 offset:0
v_add_u32 v5, 2, v6
v_lshlrev_b32 v5, 2, v5
v_mfma_f32_16x16x32_bf16 v[76:79], a[188:191], a[244:247], v[76:79]
ds_read_b64_tr_b16 a[166:167], v23 offset:4096
v_xor_b32 v5, v5, v3
v_lshl_add_u32 v245, v5, 4, v7
v_mfma_f32_16x16x32_bf16 v[80:83], a[188:191], a[248:251], v[80:83]
ds_read_b64_tr_b16 a[168:169], v24 offset:0
v_add_u32 v245, 3072, v245
v_add_u32 v5, 0, v6
v_mfma_f32_16x16x32_bf16 v[84:87], a[188:191], a[252:255], v[84:87]
ds_read_b64_tr_b16 a[170:171], v24 offset:4096
v_lshlrev_b32 v5, 2, v5
v_xor_b32 v5, v5, v3
v_mfma_f32_16x16x32_bf16 v[88:91], a[192:195], a[236:239], v[88:91]
ds_read_b64_tr_b16 a[172:173], v25 offset:0
v_lshl_add_u32 v246, v5, 4, v7
v_add_u32 v246, 6144, v246
v_mfma_f32_16x16x32_bf16 v[92:95], a[192:195], a[240:243], v[92:95]
ds_read_b64_tr_b16 a[174:175], v25 offset:4096
v_add_u32 v5, 2, v6
v_lshlrev_b32 v5, 2, v5
v_mfma_f32_16x16x32_bf16 v[96:99], a[192:195], a[244:247], v[96:99]
ds_read_b64_tr_b16 a[176:177], v26 offset:0
v_xor_b32 v5, v5, v3
v_lshl_add_u32 v247, v5, 4, v7
v_mfma_f32_16x16x32_bf16 v[100:103], a[192:195], a[248:251], v[100:103]
ds_read_b64_tr_b16 a[178:179], v26 offset:4096
v_add_u32 v247, 9216, v247
v_add_u32 v5, 0, v6
v_mfma_f32_16x16x32_bf16 v[104:107], a[192:195], a[252:255], v[104:107]
ds_read_b64_tr_b16 a[180:181], v27 offset:0
v_lshlrev_b32 v5, 2, v5
v_xor_b32 v5, v5, v3
v_mfma_f32_16x16x32_bf16 v[108:111], a[196:199], a[236:239], v[108:111]
ds_read_b64_tr_b16 a[182:183], v27 offset:4096
v_lshl_add_u32 v248, v5, 4, v7
v_add_u32 v248, 16384, v248
v_mfma_f32_16x16x32_bf16 v[112:115], a[196:199], a[240:243], v[112:115]
ds_read_b128 a[216:219], v18 offset:0
v_add_u32 v5, 2, v6
v_lshlrev_b32 v5, 2, v5
v_mfma_f32_16x16x32_bf16 v[116:119], a[196:199], a[244:247], v[116:119]
ds_read_b128 a[220:223], v18 offset:4096
v_xor_b32 v5, v5, v3
v_lshl_add_u32 v249, v5, 4, v7
v_mfma_f32_16x16x32_bf16 v[120:123], a[196:199], a[248:251], v[120:123]
ds_read_b128 a[224:227], v18 offset:8192
v_add_u32 v249, 19456, v249
v_add_u32 v5, 0, v6
v_mfma_f32_16x16x32_bf16 v[124:127], a[196:199], a[252:255], v[124:127]
ds_read_b128 a[228:231], v18 offset:12288
v_lshlrev_b32 v5, 2, v5
v_xor_b32 v5, v5, v3
v_mfma_f32_16x16x32_bf16 v[128:131], a[200:203], a[236:239], v[128:131]
ds_read_b128 a[232:235], v18 offset:16384
v_lshl_add_u32 v250, v5, 4, v7
v_add_u32 v250, 22528, v250
v_mfma_f32_16x16x32_bf16 v[132:135], a[200:203], a[240:243], v[132:135]
v_add_u32 v5, 2, v6
v_lshlrev_b32 v5, 2, v5
v_mfma_f32_16x16x32_bf16 v[136:139], a[200:203], a[244:247], v[136:139]
v_xor_b32 v5, v5, v3
v_lshl_add_u32 v251, v5, 4, v7
v_mfma_f32_16x16x32_bf16 v[140:143], a[200:203], a[248:251], v[140:143]
v_add_u32 v251, 25600, v251
s_and_b32 s56, s4, 3
v_mfma_f32_16x16x32_bf16 v[144:147], a[200:203], a[252:255], v[144:147]
s_waitcnt lgkmcnt(5)
s_lshl_b32 s88, s56, 17
s_mov_b32 s89, 0x8000
v_mfma_f32_16x16x32_bf16 v[148:151], a[204:207], a[236:239], v[148:151]
s_add_u32 m0, s93, 0
s_mov_b32 s90, 0x7ffff
s_mov_b32 s91, 16
v_mfma_f32_16x16x32_bf16 v[152:155], a[204:207], a[240:243], v[152:155]
buffer_load_dwordx4 v28, s[8:11], s95 offen offset:0 nt lds
v_mfma_f32_16x16x32_bf16 v[156:159], a[204:207], a[244:247], v[156:159]
v_mfma_f32_16x16x32_bf16 v[160:163], a[204:207], a[248:251], v[160:163]
v_mfma_f32_16x16x32_bf16 v[164:167], a[204:207], a[252:255], v[164:167]
v_mfma_f32_16x16x32_bf16 v[168:171], a[208:211], a[236:239], v[168:171]
buffer_load_dwordx4 v29, s[8:11], s95 offen offset:1024 nt lds
v_mfma_f32_16x16x32_bf16 v[172:175], a[208:211], a[240:243], v[172:175]
v_mfma_f32_16x16x32_bf16 v[176:179], a[208:211], a[244:247], v[176:179]
v_mfma_f32_16x16x32_bf16 v[180:183], a[208:211], a[248:251], v[180:183]
v_mfma_f32_16x16x32_bf16 v[184:187], a[208:211], a[252:255], v[184:187]
buffer_load_dwordx4 v30, s[8:11], s95 offen offset:2048 nt lds
v_mfma_f32_16x16x32_bf16 v[188:191], a[212:215], a[236:239], v[188:191]
v_mfma_f32_16x16x32_bf16 v[192:195], a[212:215], a[240:243], v[192:195]
v_mfma_f32_16x16x32_bf16 v[196:199], a[212:215], a[244:247], v[196:199]
v_mfma_f32_16x16x32_bf16 v[200:203], a[212:215], a[248:251], v[200:203]
buffer_load_dwordx4 v31, s[8:11], s95 offen offset:3072 nt lds
v_mfma_f32_16x16x32_bf16 v[204:207], a[212:215], a[252:255], v[204:207]
s_waitcnt lgkmcnt(0)
s_add_u32 s95, s95, 4096
s_waitcnt vmcnt(4)
v_mfma_f32_16x16x32_bf16 v[48:51], a[152:155], a[216:219], v[48:51]
ds_read_b64_tr_b16 a[184:185], v20 offset:8192
v_mfma_f32_16x16x32_bf16 v[52:55], a[152:155], a[220:223], v[52:55]
ds_read_b64_tr_b16 a[186:187], v20 offset:12288
s_add_u32 m0, s93, 4096
v_mfma_f32_16x16x32_bf16 v[56:59], a[152:155], a[224:227], v[56:59]
ds_read_b64_tr_b16 a[188:189], v21 offset:8192
buffer_load_dwordx4 v28, s[8:11], s95 offen offset:0 nt lds
v_mfma_f32_16x16x32_bf16 v[60:63], a[152:155], a[228:231], v[60:63]
ds_read_b64_tr_b16 a[190:191], v21 offset:12288
v_mfma_f32_16x16x32_bf16 v[64:67], a[152:155], a[232:235], v[64:67]
ds_read_b64_tr_b16 a[192:193], v22 offset:8192
v_mfma_f32_16x16x32_bf16 v[68:71], a[156:159], a[216:219], v[68:71]
ds_read_b64_tr_b16 a[194:195], v22 offset:12288
v_mfma_f32_16x16x32_bf16 v[72:75], a[156:159], a[220:223], v[72:75]
ds_read_b64_tr_b16 a[196:197], v23 offset:8192
v_mfma_f32_16x16x32_bf16 v[76:79], a[156:159], a[224:227], v[76:79]
ds_read_b64_tr_b16 a[198:199], v23 offset:12288
buffer_load_dwordx4 v29, s[8:11], s95 offen offset:1024 nt lds
v_mfma_f32_16x16x32_bf16 v[80:83], a[156:159], a[228:231], v[80:83]
ds_read_b64_tr_b16 a[200:201], v24 offset:8192
v_mfma_f32_16x16x32_bf16 v[84:87], a[156:159], a[232:235], v[84:87]
ds_read_b64_tr_b16 a[202:203], v24 offset:12288
v_mfma_f32_16x16x32_bf16 v[88:91], a[160:163], a[216:219], v[88:91]
ds_read_b64_tr_b16 a[204:205], v25 offset:8192
v_mfma_f32_16x16x32_bf16 v[92:95], a[160:163], a[220:223], v[92:95]
ds_read_b64_tr_b16 a[206:207], v25 offset:12288
v_mfma_f32_16x16x32_bf16 v[96:99], a[160:163], a[224:227], v[96:99]
ds_read_b64_tr_b16 a[208:209], v26 offset:8192
buffer_load_dwordx4 v30, s[8:11], s95 offen offset:2048 nt lds
v_mfma_f32_16x16x32_bf16 v[100:103], a[160:163], a[228:231], v[100:103]
ds_read_b64_tr_b16 a[210:211], v26 offset:12288
v_mfma_f32_16x16x32_bf16 v[104:107], a[160:163], a[232:235], v[104:107]
ds_read_b64_tr_b16 a[212:213], v27 offset:8192
v_mfma_f32_16x16x32_bf16 v[108:111], a[164:167], a[216:219], v[108:111]
ds_read_b64_tr_b16 a[214:215], v27 offset:12288
v_mfma_f32_16x16x32_bf16 v[112:115], a[164:167], a[220:223], v[112:115]
ds_read_b128 a[236:239], v19 offset:0
v_mfma_f32_16x16x32_bf16 v[116:119], a[164:167], a[224:227], v[116:119]
ds_read_b128 a[240:243], v19 offset:4096
buffer_load_dwordx4 v31, s[8:11], s95 offen offset:3072 nt lds
v_mfma_f32_16x16x32_bf16 v[120:123], a[164:167], a[228:231], v[120:123]
ds_read_b128 a[244:247], v19 offset:8192
v_mfma_f32_16x16x32_bf16 v[124:127], a[164:167], a[232:235], v[124:127]
ds_read_b128 a[248:251], v19 offset:12288
v_mfma_f32_16x16x32_bf16 v[128:131], a[168:171], a[216:219], v[128:131]
ds_read_b128 a[252:255], v19 offset:16384
v_mfma_f32_16x16x32_bf16 v[132:135], a[168:171], a[220:223], v[132:135]
s_add_u32 s95, s95, 4096
s_and_b32 s95, s95, 0x3ffff
v_mfma_f32_16x16x32_bf16 v[136:139], a[168:171], a[224:227], v[136:139]
v_mfma_f32_16x16x32_bf16 v[140:143], a[168:171], a[228:231], v[140:143]
v_mfma_f32_16x16x32_bf16 v[144:147], a[168:171], a[232:235], v[144:147]
s_waitcnt lgkmcnt(5)
v_mfma_f32_16x16x32_bf16 v[148:151], a[172:175], a[216:219], v[148:151]
s_add_u32 m0, s93, 8192
v_mfma_f32_16x16x32_bf16 v[152:155], a[172:175], a[220:223], v[152:155]
buffer_load_dwordx4 v28, s[8:11], s95 offen offset:0 nt lds
v_mfma_f32_16x16x32_bf16 v[156:159], a[172:175], a[224:227], v[156:159]
v_mfma_f32_16x16x32_bf16 v[160:163], a[172:175], a[228:231], v[160:163]
v_mfma_f32_16x16x32_bf16 v[164:167], a[172:175], a[232:235], v[164:167]
v_mfma_f32_16x16x32_bf16 v[168:171], a[176:179], a[216:219], v[168:171]
buffer_load_dwordx4 v29, s[8:11], s95 offen offset:1024 nt lds
v_mfma_f32_16x16x32_bf16 v[172:175], a[176:179], a[220:223], v[172:175]
v_mfma_f32_16x16x32_bf16 v[176:179], a[176:179], a[224:227], v[176:179]
v_mfma_f32_16x16x32_bf16 v[180:183], a[176:179], a[228:231], v[180:183]
v_mfma_f32_16x16x32_bf16 v[184:187], a[176:179], a[232:235], v[184:187]
buffer_load_dwordx4 v30, s[8:11], s95 offen offset:2048 nt lds
v_mfma_f32_16x16x32_bf16 v[188:191], a[180:183], a[216:219], v[188:191]
v_mfma_f32_16x16x32_bf16 v[192:195], a[180:183], a[220:223], v[192:195]
v_mfma_f32_16x16x32_bf16 v[196:199], a[180:183], a[224:227], v[196:199]
v_mfma_f32_16x16x32_bf16 v[200:203], a[180:183], a[228:231], v[200:203]
buffer_load_dwordx4 v31, s[8:11], s95 offen offset:3072 nt lds
v_mfma_f32_16x16x32_bf16 v[204:207], a[180:183], a[232:235], v[204:207]
s_waitcnt lgkmcnt(0)
s_add_u32 s95, s95, 4096
v_mfma_f32_16x16x32_bf16 v[48:51], a[184:187], a[236:239], v[48:51]
v_add_u32 v5, 0, v2
v_xor_b32 v5, v5, v3
v_mfma_f32_16x16x32_bf16 v[52:55], a[184:187], a[240:243], v[52:55]
s_add_u32 m0, s93, 12288
v_lshlrev_b32 v5, 4, v5
v_lshl_add_u32 v16, v3, 8, v5
v_mfma_f32_16x16x32_bf16 v[56:59], a[184:187], a[244:247], v[56:59]
buffer_load_dwordx4 v28, s[8:11], s95 offen offset:0 nt lds
v_add_u32 v16, s93, v16
v_add_u32 v5, 4, v2
v_mfma_f32_16x16x32_bf16 v[60:63], a[184:187], a[248:251], v[60:63]
v_xor_b32 v5, v5, v3
v_lshlrev_b32 v5, 4, v5
v_mfma_f32_16x16x32_bf16 v[64:67], a[184:187], a[252:255], v[64:67]
v_lshl_add_u32 v17, v3, 8, v5
v_add_u32 v17, s93, v17
v_mfma_f32_16x16x32_bf16 v[68:71], a[188:191], a[236:239], v[68:71]
v_add_u32 v5, 8, v2
v_xor_b32 v5, v5, v3
v_mfma_f32_16x16x32_bf16 v[72:75], a[188:191], a[240:243], v[72:75]
v_lshlrev_b32 v5, 4, v5
v_lshl_add_u32 v18, v3, 8, v5
v_mfma_f32_16x16x32_bf16 v[76:79], a[188:191], a[244:247], v[76:79]
v_add_u32 v18, s93, v18
v_add_u32 v5, 12, v2
v_mfma_f32_16x16x32_bf16 v[80:83], a[188:191], a[248:251], v[80:83]
v_xor_b32 v5, v5, v3
v_lshlrev_b32 v5, 4, v5
v_mfma_f32_16x16x32_bf16 v[84:87], a[188:191], a[252:255], v[84:87]
v_lshl_add_u32 v19, v3, 8, v5
v_add_u32 v19, s93, v19
v_mfma_f32_16x16x32_bf16 v[88:91], a[192:195], a[236:239], v[88:91]
v_lshrrev_b32 v5, 2, v1
v_and_b32 v6, 7, v5
v_mfma_f32_16x16x32_bf16 v[92:95], a[192:195], a[240:243], v[92:95]
buffer_load_dwordx4 v29, s[8:11], s95 offen offset:1024 nt lds
v_and_b32 v7, 3, v1
v_lshlrev_b32 v7, 3, v7
v_mfma_f32_16x16x32_bf16 v[96:99], a[192:195], a[244:247], v[96:99]
v_lshl_add_u32 v7, v5, 8, v7
v_add_u32 v7, s93, v7
v_mfma_f32_16x16x32_bf16 v[100:103], a[192:195], a[248:251], v[100:103]
v_add_u32 v7, 65536, v7
v_xor_b32 v8, 0, v6
v_mfma_f32_16x16x32_bf16 v[104:107], a[192:195], a[252:255], v[104:107]
v_lshl_add_u32 v20, v8, 5, v7
v_xor_b32 v8, 1, v6
v_mfma_f32_16x16x32_bf16 v[108:111], a[196:199], a[236:239], v[108:111]
v_lshl_add_u32 v21, v8, 5, v7
v_xor_b32 v8, 2, v6
v_mfma_f32_16x16x32_bf16 v[112:115], a[196:199], a[240:243], v[112:115]
v_lshl_add_u32 v22, v8, 5, v7
v_xor_b32 v8, 3, v6
v_mfma_f32_16x16x32_bf16 v[116:119], a[196:199], a[244:247], v[116:119]
v_lshl_add_u32 v23, v8, 5, v7
v_xor_b32 v8, 4, v6
v_mfma_f32_16x16x32_bf16 v[120:123], a[196:199], a[248:251], v[120:123]
v_lshl_add_u32 v24, v8, 5, v7
v_xor_b32 v8, 5, v6
v_mfma_f32_16x16x32_bf16 v[124:127], a[196:199], a[252:255], v[124:127]
v_lshl_add_u32 v25, v8, 5, v7
v_xor_b32 v8, 6, v6
v_mfma_f32_16x16x32_bf16 v[128:131], a[200:203], a[236:239], v[128:131]
buffer_load_dwordx4 v30, s[8:11], s95 offen offset:2048 nt lds
v_lshl_add_u32 v26, v8, 5, v7
v_xor_b32 v8, 7, v6
v_mfma_f32_16x16x32_bf16 v[132:135], a[200:203], a[240:243], v[132:135]
v_lshl_add_u32 v27, v8, 5, v7
v_mov_b32 v240, 0x3f803f80
v_mfma_f32_16x16x32_bf16 v[136:139], a[200:203], a[244:247], v[136:139]
v_mov_b32 v241, 0x3f803f80
v_mov_b32 v242, 0x3f803f80
v_mfma_f32_16x16x32_bf16 v[140:143], a[200:203], a[248:251], v[140:143]
v_mov_b32 v243, 0x3f803f80
v_mfma_f32_16x16x32_bf16 v[144:147], a[200:203], a[252:255], v[144:147]
v_mfma_f32_16x16x32_bf16 v[148:151], a[204:207], a[236:239], v[148:151]
v_mfma_f32_16x16x32_bf16 v[152:155], a[204:207], a[240:243], v[152:155]
v_mfma_f32_16x16x32_bf16 v[156:159], a[204:207], a[244:247], v[156:159]
v_mfma_f32_16x16x32_bf16 v[160:163], a[204:207], a[248:251], v[160:163]
v_mfma_f32_16x16x32_bf16 v[164:167], a[204:207], a[252:255], v[164:167]
buffer_load_dwordx4 v31, s[8:11], s95 offen offset:3072 nt lds
v_mfma_f32_16x16x32_bf16 v[168:171], a[208:211], a[236:239], v[168:171]
v_mfma_f32_16x16x32_bf16 v[172:175], a[208:211], a[240:243], v[172:175]
v_mfma_f32_16x16x32_bf16 v[176:179], a[208:211], a[244:247], v[176:179]
v_mfma_f32_16x16x32_bf16 v[180:183], a[208:211], a[248:251], v[180:183]
v_mfma_f32_16x16x32_bf16 v[184:187], a[208:211], a[252:255], v[184:187]
v_mfma_f32_16x16x32_bf16 v[188:191], a[212:215], a[236:239], v[188:191]
v_mfma_f32_16x16x32_bf16 v[192:195], a[212:215], a[240:243], v[192:195]
v_mfma_f32_16x16x32_bf16 v[196:199], a[212:215], a[244:247], v[196:199]
s_add_u32 s95, s95, 4096
s_and_b32 s95, s95, 0x3ffff
v_mfma_f32_16x16x32_bf16 v[200:203], a[212:215], a[248:251], v[200:203]
v_mfma_f32_16x16x32_bf16 v[204:207], a[212:215], a[252:255], v[204:207]
v_pk_mul_f32 v[48:49], v[48:49], s[62:63]
v_pk_mul_f32 v[50:51], v[50:51], s[62:63]
v_pk_mul_f32 v[68:69], v[68:69], s[62:63]
v_pk_mul_f32 v[70:71], v[70:71], s[62:63]
v_cvt_pk_bf16_f32 v48, v48, v49
v_cvt_pk_bf16_f32 v49, v50, v51
v_cvt_pk_bf16_f32 v50, v68, v69
v_cvt_pk_bf16_f32 v51, v70, v71
v_accvgpr_write_b32 a160, v48
v_accvgpr_write_b32 a161, v49
v_accvgpr_write_b32 a162, v50
v_accvgpr_write_b32 a163, v51
s_add_u32 m0, s93, 65536
s_nop 0
buffer_load_dwordx4 v32, s[12:15], s96 offen offset:0 nt lds
v_pk_mul_f32 v[52:53], v[52:53], s[62:63]
v_pk_mul_f32 v[54:55], v[54:55], s[62:63]
v_pk_mul_f32 v[72:73], v[72:73], s[62:63]
v_pk_mul_f32 v[74:75], v[74:75], s[62:63]
v_cvt_pk_bf16_f32 v52, v52, v53
v_cvt_pk_bf16_f32 v53, v54, v55
v_cvt_pk_bf16_f32 v54, v72, v73
v_cvt_pk_bf16_f32 v55, v74, v75
v_accvgpr_write_b32 a164, v52
v_accvgpr_write_b32 a165, v53
v_accvgpr_write_b32 a166, v54
v_accvgpr_write_b32 a167, v55
buffer_load_dwordx4 v33, s[12:15], s96 offen offset:1024 nt lds
v_pk_mul_f32 v[56:57], v[56:57], s[62:63]
v_pk_mul_f32 v[58:59], v[58:59], s[62:63]
v_pk_mul_f32 v[76:77], v[76:77], s[62:63]
v_pk_mul_f32 v[78:79], v[78:79], s[62:63]
v_cvt_pk_bf16_f32 v56, v56, v57
v_cvt_pk_bf16_f32 v57, v58, v59
v_cvt_pk_bf16_f32 v58, v76, v77
v_cvt_pk_bf16_f32 v59, v78, v79
v_accvgpr_write_b32 a168, v56
v_accvgpr_write_b32 a169, v57
v_accvgpr_write_b32 a170, v58
v_accvgpr_write_b32 a171, v59
buffer_load_dwordx4 v32, s[12:15], s96 offen offset:2048 nt lds
v_pk_mul_f32 v[60:61], v[60:61], s[62:63]
v_pk_mul_f32 v[62:63], v[62:63], s[62:63]
v_pk_mul_f32 v[80:81], v[80:81], s[62:63]
v_pk_mul_f32 v[82:83], v[82:83], s[62:63]
v_cvt_pk_bf16_f32 v60, v60, v61
v_cvt_pk_bf16_f32 v61, v62, v63
v_cvt_pk_bf16_f32 v62, v80, v81
v_cvt_pk_bf16_f32 v63, v82, v83
v_accvgpr_write_b32 a172, v60
v_accvgpr_write_b32 a173, v61
v_accvgpr_write_b32 a174, v62
v_accvgpr_write_b32 a175, v63
buffer_load_dwordx4 v33, s[12:15], s96 offen offset:3072 nt lds
v_pk_mul_f32 v[64:65], v[64:65], s[62:63]
v_pk_mul_f32 v[66:67], v[66:67], s[62:63]
v_pk_mul_f32 v[84:85], v[84:85], s[62:63]
v_pk_mul_f32 v[86:87], v[86:87], s[62:63]
v_cvt_pk_bf16_f32 v64, v64, v65
v_cvt_pk_bf16_f32 v65, v66, v67
v_cvt_pk_bf16_f32 v66, v84, v85
v_cvt_pk_bf16_f32 v67, v86, v87
v_accvgpr_write_b32 a176, v64
v_accvgpr_write_b32 a177, v65
v_accvgpr_write_b32 a178, v66
v_accvgpr_write_b32 a179, v67
s_add_u32 s96, s96, 4096
s_add_u32 m0, s93, 69632
s_nop 0
buffer_load_dwordx4 v32, s[12:15], s96 offen offset:0 nt lds
v_pk_mul_f32 v[88:89], v[88:89], s[62:63]
v_pk_mul_f32 v[90:91], v[90:91], s[62:63]
v_pk_mul_f32 v[108:109], v[108:109], s[62:63]
v_pk_mul_f32 v[110:111], v[110:111], s[62:63]
v_cvt_pk_bf16_f32 v88, v88, v89
v_cvt_pk_bf16_f32 v89, v90, v91
v_cvt_pk_bf16_f32 v90, v108, v109
v_cvt_pk_bf16_f32 v91, v110, v111
v_accvgpr_write_b32 a180, v88
v_accvgpr_write_b32 a181, v89
v_accvgpr_write_b32 a182, v90
v_accvgpr_write_b32 a183, v91
buffer_load_dwordx4 v33, s[12:15], s96 offen offset:1024 nt lds
v_pk_mul_f32 v[92:93], v[92:93], s[62:63]
v_pk_mul_f32 v[94:95], v[94:95], s[62:63]
v_pk_mul_f32 v[112:113], v[112:113], s[62:63]
v_pk_mul_f32 v[114:115], v[114:115], s[62:63]
v_cvt_pk_bf16_f32 v92, v92, v93
v_cvt_pk_bf16_f32 v93, v94, v95
v_cvt_pk_bf16_f32 v94, v112, v113
v_cvt_pk_bf16_f32 v95, v114, v115
v_accvgpr_write_b32 a184, v92
v_accvgpr_write_b32 a185, v93
v_accvgpr_write_b32 a186, v94
v_accvgpr_write_b32 a187, v95
buffer_load_dwordx4 v32, s[12:15], s96 offen offset:2048 nt lds
v_pk_mul_f32 v[96:97], v[96:97], s[62:63]
v_pk_mul_f32 v[98:99], v[98:99], s[62:63]
v_pk_mul_f32 v[116:117], v[116:117], s[62:63]
v_pk_mul_f32 v[118:119], v[118:119], s[62:63]
v_cvt_pk_bf16_f32 v96, v96, v97
v_cvt_pk_bf16_f32 v97, v98, v99
v_cvt_pk_bf16_f32 v98, v116, v117
v_cvt_pk_bf16_f32 v99, v118, v119
v_accvgpr_write_b32 a188, v96
v_accvgpr_write_b32 a189, v97
v_accvgpr_write_b32 a190, v98
v_accvgpr_write_b32 a191, v99
buffer_load_dwordx4 v33, s[12:15], s96 offen offset:3072 nt lds
v_pk_mul_f32 v[100:101], v[100:101], s[62:63]
v_pk_mul_f32 v[102:103], v[102:103], s[62:63]
v_pk_mul_f32 v[120:121], v[120:121], s[62:63]
v_pk_mul_f32 v[122:123], v[122:123], s[62:63]
v_cvt_pk_bf16_f32 v100, v100, v101
v_cvt_pk_bf16_f32 v101, v102, v103
v_cvt_pk_bf16_f32 v102, v120, v121
v_cvt_pk_bf16_f32 v103, v122, v123
v_accvgpr_write_b32 a192, v100
v_accvgpr_write_b32 a193, v101
v_accvgpr_write_b32 a194, v102
v_accvgpr_write_b32 a195, v103
s_add_u32 s96, s96, 4096
s_and_b32 s96, s96, 0x3ffff
v_pk_mul_f32 v[104:105], v[104:105], s[62:63]
v_pk_mul_f32 v[106:107], v[106:107], s[62:63]
v_pk_mul_f32 v[124:125], v[124:125], s[62:63]
v_pk_mul_f32 v[126:127], v[126:127], s[62:63]
v_cvt_pk_bf16_f32 v104, v104, v105
v_cvt_pk_bf16_f32 v105, v106, v107
v_cvt_pk_bf16_f32 v106, v124, v125
v_cvt_pk_bf16_f32 v107, v126, v127
v_accvgpr_write_b32 a196, v104
v_accvgpr_write_b32 a197, v105
v_accvgpr_write_b32 a198, v106
v_accvgpr_write_b32 a199, v107
v_pk_mul_f32 v[128:129], v[128:129], s[62:63]
v_pk_mul_f32 v[130:131], v[130:131], s[62:63]
v_pk_mul_f32 v[148:149], v[148:149], s[62:63]
v_pk_mul_f32 v[150:151], v[150:151], s[62:63]
v_cvt_pk_bf16_f32 v128, v128, v129
v_cvt_pk_bf16_f32 v129, v130, v131
v_cvt_pk_bf16_f32 v130, v148, v149
v_cvt_pk_bf16_f32 v131, v150, v151
v_accvgpr_write_b32 a200, v128
v_accvgpr_write_b32 a201, v129
v_accvgpr_write_b32 a202, v130
v_accvgpr_write_b32 a203, v131
v_pk_mul_f32 v[132:133], v[132:133], s[62:63]
v_pk_mul_f32 v[134:135], v[134:135], s[62:63]
v_pk_mul_f32 v[152:153], v[152:153], s[62:63]
v_pk_mul_f32 v[154:155], v[154:155], s[62:63]
v_cvt_pk_bf16_f32 v132, v132, v133
v_cvt_pk_bf16_f32 v133, v134, v135
v_cvt_pk_bf16_f32 v134, v152, v153
v_cvt_pk_bf16_f32 v135, v154, v155
v_accvgpr_write_b32 a204, v132
v_accvgpr_write_b32 a205, v133
v_accvgpr_write_b32 a206, v134
v_accvgpr_write_b32 a207, v135
v_pk_mul_f32 v[136:137], v[136:137], s[62:63]
v_pk_mul_f32 v[138:139], v[138:139], s[62:63]
v_pk_mul_f32 v[156:157], v[156:157], s[62:63]
v_pk_mul_f32 v[158:159], v[158:159], s[62:63]
v_cvt_pk_bf16_f32 v136, v136, v137
v_cvt_pk_bf16_f32 v137, v138, v139
v_cvt_pk_bf16_f32 v138, v156, v157
v_cvt_pk_bf16_f32 v139, v158, v159
v_accvgpr_write_b32 a208, v136
v_accvgpr_write_b32 a209, v137
v_accvgpr_write_b32 a210, v138
v_accvgpr_write_b32 a211, v139
v_pk_mul_f32 v[140:141], v[140:141], s[62:63]
v_pk_mul_f32 v[142:143], v[142:143], s[62:63]
v_pk_mul_f32 v[160:161], v[160:161], s[62:63]
v_pk_mul_f32 v[162:163], v[162:163], s[62:63]
v_cvt_pk_bf16_f32 v140, v140, v141
v_cvt_pk_bf16_f32 v141, v142, v143
v_cvt_pk_bf16_f32 v142, v160, v161
v_cvt_pk_bf16_f32 v143, v162, v163
v_accvgpr_write_b32 a212, v140
v_accvgpr_write_b32 a213, v141
v_accvgpr_write_b32 a214, v142
v_accvgpr_write_b32 a215, v143
v_pk_mul_f32 v[144:145], v[144:145], s[62:63]
v_pk_mul_f32 v[146:147], v[146:147], s[62:63]
v_pk_mul_f32 v[164:165], v[164:165], s[62:63]
v_pk_mul_f32 v[166:167], v[166:167], s[62:63]
v_cvt_pk_bf16_f32 v144, v144, v145
v_cvt_pk_bf16_f32 v145, v146, v147
v_cvt_pk_bf16_f32 v146, v164, v165
v_cvt_pk_bf16_f32 v147, v166, v167
v_accvgpr_write_b32 a216, v144
v_accvgpr_write_b32 a217, v145
v_accvgpr_write_b32 a218, v146
v_accvgpr_write_b32 a219, v147
v_pk_mul_f32 v[168:169], v[168:169], s[62:63]
v_pk_mul_f32 v[170:171], v[170:171], s[62:63]
v_pk_mul_f32 v[188:189], v[188:189], s[62:63]
v_pk_mul_f32 v[190:191], v[190:191], s[62:63]
v_cvt_pk_bf16_f32 v168, v168, v169
v_cvt_pk_bf16_f32 v169, v170, v171
v_cvt_pk_bf16_f32 v170, v188, v189
v_cvt_pk_bf16_f32 v171, v190, v191
v_accvgpr_write_b32 a220, v168
v_accvgpr_write_b32 a221, v169
v_accvgpr_write_b32 a222, v170
v_accvgpr_write_b32 a223, v171
v_pk_mul_f32 v[172:173], v[172:173], s[62:63]
v_pk_mul_f32 v[174:175], v[174:175], s[62:63]
v_pk_mul_f32 v[192:193], v[192:193], s[62:63]
v_pk_mul_f32 v[194:195], v[194:195], s[62:63]
v_cvt_pk_bf16_f32 v172, v172, v173
v_cvt_pk_bf16_f32 v173, v174, v175
v_cvt_pk_bf16_f32 v174, v192, v193
v_cvt_pk_bf16_f32 v175, v194, v195
v_accvgpr_write_b32 a224, v172
v_accvgpr_write_b32 a225, v173
v_accvgpr_write_b32 a226, v174
v_accvgpr_write_b32 a227, v175
v_pk_mul_f32 v[176:177], v[176:177], s[62:63]
v_pk_mul_f32 v[178:179], v[178:179], s[62:63]
v_pk_mul_f32 v[196:197], v[196:197], s[62:63]
v_pk_mul_f32 v[198:199], v[198:199], s[62:63]
v_cvt_pk_bf16_f32 v176, v176, v177
v_cvt_pk_bf16_f32 v177, v178, v179
v_cvt_pk_bf16_f32 v178, v196, v197
v_cvt_pk_bf16_f32 v179, v198, v199
v_accvgpr_write_b32 a228, v176
v_accvgpr_write_b32 a229, v177
v_accvgpr_write_b32 a230, v178
v_accvgpr_write_b32 a231, v179
v_pk_mul_f32 v[180:181], v[180:181], s[62:63]
v_pk_mul_f32 v[182:183], v[182:183], s[62:63]
v_pk_mul_f32 v[200:201], v[200:201], s[62:63]
v_pk_mul_f32 v[202:203], v[202:203], s[62:63]
v_cvt_pk_bf16_f32 v180, v180, v181
v_cvt_pk_bf16_f32 v181, v182, v183
v_cvt_pk_bf16_f32 v182, v200, v201
v_cvt_pk_bf16_f32 v183, v202, v203
v_accvgpr_write_b32 a232, v180
v_accvgpr_write_b32 a233, v181
v_accvgpr_write_b32 a234, v182
v_accvgpr_write_b32 a235, v183
v_pk_mul_f32 v[184:185], v[184:185], s[62:63]
v_pk_mul_f32 v[186:187], v[186:187], s[62:63]
v_pk_mul_f32 v[204:205], v[204:205], s[62:63]
v_pk_mul_f32 v[206:207], v[206:207], s[62:63]
v_cvt_pk_bf16_f32 v184, v184, v185
v_cvt_pk_bf16_f32 v185, v186, v187
v_cvt_pk_bf16_f32 v186, v204, v205
v_cvt_pk_bf16_f32 v187, v206, v207
v_accvgpr_write_b32 a236, v184
v_accvgpr_write_b32 a237, v185
v_accvgpr_write_b32 a238, v186
v_accvgpr_write_b32 a239, v187
s_lshl_b32 s97, s3, 13
s_sub_u32 s100, 57344, s97
s_add_u32 s97, s97, 131072
s_waitcnt vmcnt(16)
ds_read_b128 v[188:191], v16 offset:0
ds_read_b128 v[192:195], v17 offset:0
ds_read_b128 v[196:199], v18 offset:0
ds_read_b128 v[200:203], v19 offset:0
s_waitcnt lgkmcnt(2)
v_mfma_f32_16x16x32_bf16 v[48:51], v[188:191], a[160:163], 0
ds_read_b128 v[204:207], v16 offset:4096
v_mfma_f32_16x16x32_bf16 v[52:55], v[188:191], a[164:167], 0
v_mfma_f32_16x16x32_bf16 v[56:59], v[188:191], a[168:171], 0
v_mfma_f32_16x16x32_bf16 v[60:63], v[188:191], a[172:175], 0
v_mfma_f32_16x16x32_bf16 v[64:67], v[188:191], a[176:179], 0
v_mfma_f32_16x16x32_bf16 v[48:51], v[192:195], a[180:183], v[48:51]
ds_read_b128 v[208:211], v17 offset:4096
v_mfma_f32_16x16x32_bf16 v[52:55], v[192:195], a[184:187], v[52:55]
v_mfma_f32_16x16x32_bf16 v[56:59], v[192:195], a[188:191], v[56:59]
v_mfma_f32_16x16x32_bf16 v[60:63], v[192:195], a[192:195], v[60:63]
v_mfma_f32_16x16x32_bf16 v[64:67], v[192:195], a[196:199], v[64:67]
s_waitcnt lgkmcnt(2)
v_mfma_f32_16x16x32_bf16 v[48:51], v[196:199], a[200:203], v[48:51]
ds_read_b128 v[212:215], v18 offset:4096
s_add_u32 m0, s93, 0
v_mfma_f32_16x16x32_bf16 v[52:55], v[196:199], a[204:207], v[52:55]
buffer_load_dwordx4 v28, s[8:11], s95 offen offset:0 nt lds
v_mfma_f32_16x16x32_bf16 v[56:59], v[196:199], a[208:211], v[56:59]
v_mfma_f32_16x16x32_bf16 v[60:63], v[196:199], a[212:215], v[60:63]
v_mfma_f32_16x16x32_bf16 v[64:67], v[196:199], a[216:219], v[64:67]
v_mfma_f32_16x16x32_bf16 v[48:51], v[200:203], a[220:223], v[48:51]
ds_read_b128 v[216:219], v19 offset:4096
buffer_load_dwordx4 v29, s[8:11], s95 offen offset:1024 nt lds
v_mfma_f32_16x16x32_bf16 v[52:55], v[200:203], a[224:227], v[52:55]
v_mfma_f32_16x16x32_bf16 v[56:59], v[200:203], a[228:231], v[56:59]
v_mfma_f32_16x16x32_bf16 v[60:63], v[200:203], a[232:235], v[60:63]
v_mfma_f32_16x16x32_bf16 v[64:67], v[200:203], a[236:239], v[64:67]
buffer_load_dwordx4 v30, s[8:11], s95 offen offset:2048 nt lds
s_waitcnt vmcnt(11)
s_waitcnt lgkmcnt(2)
v_mfma_f32_16x16x32_bf16 v[68:71], v[204:207], a[160:163], 0
ds_read_b128 v[188:191], v16 offset:8192
v_mfma_f32_16x16x32_bf16 v[72:75], v[204:207], a[164:167], 0
v_mfma_f32_16x16x32_bf16 v[76:79], v[204:207], a[168:171], 0
v_mfma_f32_16x16x32_bf16 v[80:83], v[204:207], a[172:175], 0
buffer_load_dwordx4 v31, s[8:11], s95 offen offset:3072 nt lds
v_mfma_f32_16x16x32_bf16 v[84:87], v[204:207], a[176:179], 0
v_mfma_f32_16x16x32_bf16 v[68:71], v[208:211], a[180:183], v[68:71]
ds_read_b128 v[192:195], v17 offset:8192
v_mfma_f32_16x16x32_bf16 v[72:75], v[208:211], a[184:187], v[72:75]
s_add_u32 s95, s95, 4096
v_mfma_f32_16x16x32_bf16 v[76:79], v[208:211], a[188:191], v[76:79]
v_mfma_f32_16x16x32_bf16 v[80:83], v[208:211], a[192:195], v[80:83]
v_mfma_f32_16x16x32_bf16 v[84:87], v[208:211], a[196:199], v[84:87]
s_waitcnt lgkmcnt(2)
v_mfma_f32_16x16x32_bf16 v[68:71], v[212:215], a[200:203], v[68:71]
ds_read_b128 v[196:199], v18 offset:8192
s_add_u32 m0, s93, 4096
v_mfma_f32_16x16x32_bf16 v[72:75], v[212:215], a[204:207], v[72:75]
buffer_load_dwordx4 v28, s[8:11], s95 offen offset:0 nt lds
v_mfma_f32_16x16x32_bf16 v[76:79], v[212:215], a[208:211], v[76:79]
v_mfma_f32_16x16x32_bf16 v[80:83], v[212:215], a[212:215], v[80:83]
buffer_load_dwordx4 v29, s[8:11], s95 offen offset:1024 nt lds
v_mfma_f32_16x16x32_bf16 v[84:87], v[212:215], a[216:219], v[84:87]
v_mfma_f32_16x16x32_bf16 v[68:71], v[216:219], a[220:223], v[68:71]
ds_read_b128 v[200:203], v19 offset:8192
buffer_load_dwordx4 v30, s[8:11], s95 offen offset:2048 nt lds
v_mfma_f32_16x16x32_bf16 v[72:75], v[216:219], a[224:227], v[72:75]
v_mfma_f32_16x16x32_bf16 v[76:79], v[216:219], a[228:231], v[76:79]
buffer_load_dwordx4 v31, s[8:11], s95 offen offset:3072 nt lds
v_mfma_f32_16x16x32_bf16 v[80:83], v[216:219], a[232:235], v[80:83]
s_add_u32 s95, s95, 4096
s_and_b32 s95, s95, 0x3ffff
v_mfma_f32_16x16x32_bf16 v[84:87], v[216:219], a[236:239], v[84:87]
s_nop 7
s_add_u32 m0, s93, 73728
s_nop 0
buffer_load_dwordx4 v32, s[12:15], s96 offen offset:0 nt lds
buffer_load_dwordx4 v33, s[12:15], s96 offen offset:1024 nt lds
v_max3_f32 v36, v48, v49, v50
v_max3_f32 v36, v36, v51, v68
v_max3_f32 v36, v36, v69, v70
v_max_f32 v36, v36, v71
v_mov_b32 v37, v36
s_nop 1
v_permlane32_swap_b32 v36, v37
s_nop 1
v_max_f32 v36, v36, v37
v_mov_b32 v37, v36
s_nop 1
v_permlane16_swap_b32 v36, v37
s_nop 1
v_max_f32 v36, v36, v37
v_add_f32 v36, 0x41000000, v36
v_sub_f32 v168, 0, v36
v_sub_f32 v169, 0, v36
v_sub_f32 v170, 0, v36
v_sub_f32 v171, 0, v36
v_sub_f32 v48, v48, v36
v_sub_f32 v49, v49, v36
v_sub_f32 v50, v50, v36
v_sub_f32 v51, v51, v36
v_sub_f32 v68, v68, v36
v_sub_f32 v69, v69, v36
v_sub_f32 v70, v70, v36
v_sub_f32 v71, v71, v36
buffer_load_dwordx4 v32, s[12:15], s96 offen offset:2048 nt lds
buffer_load_dwordx4 v33, s[12:15], s96 offen offset:3072 nt lds
v_max3_f32 v36, v52, v53, v54
v_max3_f32 v36, v36, v55, v72
v_max3_f32 v36, v36, v73, v74
v_max_f32 v36, v36, v75
v_mov_b32 v37, v36
s_nop 1
v_permlane32_swap_b32 v36, v37
s_nop 1
v_max_f32 v36, v36, v37
v_mov_b32 v37, v36
s_nop 1
v_permlane16_swap_b32 v36, v37
s_nop 1
v_max_f32 v36, v36, v37
v_add_f32 v36, 0x41000000, v36
v_sub_f32 v172, 0, v36
v_sub_f32 v173, 0, v36
v_sub_f32 v174, 0, v36
v_sub_f32 v175, 0, v36
v_sub_f32 v52, v52, v36
v_sub_f32 v53, v53, v36
v_sub_f32 v54, v54, v36
v_sub_f32 v55, v55, v36
v_sub_f32 v72, v72, v36
v_sub_f32 v73, v73, v36
v_sub_f32 v74, v74, v36
v_sub_f32 v75, v75, v36
s_add_u32 s96, s96, 4096
s_add_u32 m0, s93, 77824
s_nop 0
buffer_load_dwordx4 v32, s[12:15], s96 offen offset:0 nt lds
buffer_load_dwordx4 v33, s[12:15], s96 offen offset:1024 nt lds
v_max3_f32 v36, v56, v57, v58
v_max3_f32 v36, v36, v59, v76
v_max3_f32 v36, v36, v77, v78
v_max_f32 v36, v36, v79
v_mov_b32 v37, v36
s_nop 1
v_permlane32_swap_b32 v36, v37
s_nop 1
v_max_f32 v36, v36, v37
v_mov_b32 v37, v36
s_nop 1
v_permlane16_swap_b32 v36, v37
s_nop 1
v_max_f32 v36, v36, v37
v_add_f32 v36, 0x41000000, v36
v_sub_f32 v176, 0, v36
v_sub_f32 v177, 0, v36
v_sub_f32 v178, 0, v36
v_sub_f32 v179, 0, v36
v_sub_f32 v56, v56, v36
v_sub_f32 v57, v57, v36
v_sub_f32 v58, v58, v36
v_sub_f32 v59, v59, v36
v_sub_f32 v76, v76, v36
v_sub_f32 v77, v77, v36
v_sub_f32 v78, v78, v36
v_sub_f32 v79, v79, v36
buffer_load_dwordx4 v32, s[12:15], s96 offen offset:2048 nt lds
buffer_load_dwordx4 v33, s[12:15], s96 offen offset:3072 nt lds
v_max3_f32 v36, v60, v61, v62
v_max3_f32 v36, v36, v63, v80
v_max3_f32 v36, v36, v81, v82
v_max_f32 v36, v36, v83
v_mov_b32 v37, v36
s_nop 1
v_permlane32_swap_b32 v36, v37
s_nop 1
v_max_f32 v36, v36, v37
v_mov_b32 v37, v36
s_nop 1
v_permlane16_swap_b32 v36, v37
s_nop 1
v_max_f32 v36, v36, v37
v_add_f32 v36, 0x41000000, v36
v_sub_f32 v180, 0, v36
v_sub_f32 v181, 0, v36
v_sub_f32 v182, 0, v36
v_sub_f32 v183, 0, v36
v_sub_f32 v60, v60, v36
v_sub_f32 v61, v61, v36
v_sub_f32 v62, v62, v36
v_sub_f32 v63, v63, v36
v_sub_f32 v80, v80, v36
v_sub_f32 v81, v81, v36
v_sub_f32 v82, v82, v36
v_sub_f32 v83, v83, v36
s_add_u32 s96, s96, 4096
s_and_b32 s96, s96, 0x3ffff
v_max3_f32 v36, v64, v65, v66
v_max3_f32 v36, v36, v67, v84
v_max3_f32 v36, v36, v85, v86
v_max_f32 v36, v36, v87
v_mov_b32 v37, v36
s_nop 1
v_permlane32_swap_b32 v36, v37
s_nop 1
v_max_f32 v36, v36, v37
v_mov_b32 v37, v36
s_nop 1
v_permlane16_swap_b32 v36, v37
s_nop 1
v_max_f32 v36, v36, v37
v_add_f32 v36, 0x41000000, v36
v_sub_f32 v184, 0, v36
v_sub_f32 v185, 0, v36
v_sub_f32 v186, 0, v36
v_sub_f32 v187, 0, v36
v_sub_f32 v64, v64, v36
v_sub_f32 v65, v65, v36
v_sub_f32 v66, v66, v36
v_sub_f32 v67, v67, v36
v_sub_f32 v84, v84, v36
v_sub_f32 v85, v85, v36
v_sub_f32 v86, v86, v36
v_sub_f32 v87, v87, v36
s_barrier
s_waitcnt lgkmcnt(2)
v_mfma_f32_16x16x32_bf16 v[88:91], v[188:191], a[160:163], v[168:171]
ds_read_b128 v[204:207], v16 offset:12288
v_exp_f32 v36, v48
v_mfma_f32_16x16x32_bf16 v[92:95], v[188:191], a[164:167], v[172:175]
v_exp_f32 v37, v49
v_exp_f32 v38, v50
v_mfma_f32_16x16x32_bf16 v[96:99], v[188:191], a[168:171], v[176:179]
v_exp_f32 v39, v51
v_cvt_pk_bf16_f32 v128, v36, v37
v_cvt_pk_bf16_f32 v129, v38, v39
v_mfma_f32_16x16x32_bf16 v[100:103], v[188:191], a[172:175], v[180:183]
v_exp_f32 v40, v68
v_exp_f32 v41, v69
v_exp_f32 v42, v70
v_mfma_f32_16x16x32_bf16 v[104:107], v[188:191], a[176:179], v[184:187]
v_exp_f32 v43, v71
v_cvt_pk_bf16_f32 v130, v40, v41
v_cvt_pk_bf16_f32 v131, v42, v43
v_mfma_f32_16x16x32_bf16 v[88:91], v[192:195], a[180:183], v[88:91]
ds_read_b128 v[208:211], v17 offset:12288
v_or_b32 v44, v128, v129
v_or3_b32 v44, v44, v130, v131
v_mfma_f32_16x16x32_bf16 v[92:95], v[192:195], a[184:187], v[92:95]
v_exp_f32 v36, v52
v_exp_f32 v37, v53
v_mfma_f32_16x16x32_bf16 v[96:99], v[192:195], a[188:191], v[96:99]
v_exp_f32 v38, v54
v_exp_f32 v39, v55
v_cvt_pk_bf16_f32 v132, v36, v37
v_mfma_f32_16x16x32_bf16 v[100:103], v[192:195], a[192:195], v[100:103]
v_cvt_pk_bf16_f32 v133, v38, v39
v_exp_f32 v40, v72
v_exp_f32 v41, v73
v_mfma_f32_16x16x32_bf16 v[104:107], v[192:195], a[196:199], v[104:107]
v_exp_f32 v42, v74
v_exp_f32 v43, v75
s_waitcnt lgkmcnt(2)
v_mfma_f32_16x16x32_bf16 v[88:91], v[196:199], a[200:203], v[88:91]
ds_read_b128 v[212:215], v18 offset:12288
s_add_u32 m0, s93, 8192
v_mfma_f32_16x16x32_bf16 v[92:95], v[196:199], a[204:207], v[92:95]
buffer_load_dwordx4 v28, s[8:11], s95 offen offset:0 nt lds
v_mfma_f32_16x16x32_bf16 v[96:99], v[196:199], a[208:211], v[96:99]
v_cvt_pk_bf16_f32 v134, v40, v41
v_cvt_pk_bf16_f32 v135, v42, v43
v_or3_b32 v44, v44, v132, v133
v_or3_b32 v44, v44, v134, v135
v_mfma_f32_16x16x32_bf16 v[100:103], v[196:199], a[212:215], v[100:103]
v_exp_f32 v36, v56
v_exp_f32 v37, v57
v_mfma_f32_16x16x32_bf16 v[104:107], v[196:199], a[216:219], v[104:107]
v_exp_f32 v38, v58
v_exp_f32 v39, v59
v_cvt_pk_bf16_f32 v136, v36, v37
v_mfma_f32_16x16x32_bf16 v[88:91], v[200:203], a[220:223], v[88:91]
ds_read_b128 v[216:219], v19 offset:12288
buffer_load_dwordx4 v29, s[8:11], s95 offen offset:1024 nt lds
v_mfma_f32_16x16x32_bf16 v[92:95], v[200:203], a[224:227], v[92:95]
v_cvt_pk_bf16_f32 v137, v38, v39
v_exp_f32 v40, v76
v_exp_f32 v41, v77
v_mfma_f32_16x16x32_bf16 v[96:99], v[200:203], a[228:231], v[96:99]
v_exp_f32 v42, v78
v_exp_f32 v43, v79
v_mfma_f32_16x16x32_bf16 v[100:103], v[200:203], a[232:235], v[100:103]
v_cvt_pk_bf16_f32 v138, v40, v41
v_cvt_pk_bf16_f32 v139, v42, v43
v_or3_b32 v44, v44, v136, v137
v_or3_b32 v44, v44, v138, v139
v_mfma_f32_16x16x32_bf16 v[104:107], v[200:203], a[236:239], v[104:107]
buffer_load_dwordx4 v30, s[8:11], s95 offen offset:2048 nt lds
s_waitcnt vmcnt(11)
s_waitcnt lgkmcnt(2)
v_mfma_f32_16x16x32_bf16 v[108:111], v[204:207], a[160:163], v[168:171]
ds_read_b128 v[188:191], v16 offset:0
v_exp_f32 v36, v60
v_mfma_f32_16x16x32_bf16 v[112:115], v[204:207], a[164:167], v[172:175]
v_exp_f32 v37, v61
v_exp_f32 v38, v62
v_mfma_f32_16x16x32_bf16 v[116:119], v[204:207], a[168:171], v[176:179]
v_exp_f32 v39, v63
v_cvt_pk_bf16_f32 v140, v36, v37
v_cvt_pk_bf16_f32 v141, v38, v39
v_mfma_f32_16x16x32_bf16 v[120:123], v[204:207], a[172:175], v[180:183]
buffer_load_dwordx4 v31, s[8:11], s95 offen offset:3072 nt lds
v_mfma_f32_16x16x32_bf16 v[124:127], v[204:207], a[176:179], v[184:187]
v_exp_f32 v40, v80
v_exp_f32 v41, v81
v_exp_f32 v42, v82
v_mfma_f32_16x16x32_bf16 v[108:111], v[208:211], a[180:183], v[108:111]
ds_read_b128 v[192:195], v17 offset:0
v_exp_f32 v43, v83
v_mfma_f32_16x16x32_bf16 v[112:115], v[208:211], a[184:187], v[112:115]
s_add_u32 s95, s95, 4096
v_cvt_pk_bf16_f32 v142, v40, v41
v_cvt_pk_bf16_f32 v143, v42, v43
v_mfma_f32_16x16x32_bf16 v[116:119], v[208:211], a[188:191], v[116:119]
v_or3_b32 v44, v44, v140, v141
v_or3_b32 v44, v44, v142, v143
v_exp_f32 v36, v64
v_mfma_f32_16x16x32_bf16 v[120:123], v[208:211], a[192:195], v[120:123]
v_exp_f32 v37, v65
v_exp_f32 v38, v66
v_mfma_f32_16x16x32_bf16 v[124:127], v[208:211], a[196:199], v[124:127]
v_exp_f32 v39, v67
v_cvt_pk_bf16_f32 v144, v36, v37
v_cvt_pk_bf16_f32 v145, v38, v39
s_waitcnt lgkmcnt(2)
v_mfma_f32_16x16x32_bf16 v[108:111], v[212:215], a[200:203], v[108:111]
ds_read_b128 v[196:199], v18 offset:0
s_add_u32 m0, s93, 12288
v_mfma_f32_16x16x32_bf16 v[112:115], v[212:215], a[204:207], v[112:115]
buffer_load_dwordx4 v28, s[8:11], s95 offen offset:0 nt lds
v_mfma_f32_16x16x32_bf16 v[116:119], v[212:215], a[208:211], v[116:119]
v_exp_f32 v40, v84
v_exp_f32 v41, v85
v_exp_f32 v42, v86
v_mfma_f32_16x16x32_bf16 v[120:123], v[212:215], a[212:215], v[120:123]
buffer_load_dwordx4 v29, s[8:11], s95 offen offset:1024 nt lds
v_mfma_f32_16x16x32_bf16 v[124:127], v[212:215], a[216:219], v[124:127]
v_exp_f32 v43, v87
v_cvt_pk_bf16_f32 v146, v40, v41
v_cvt_pk_bf16_f32 v147, v42, v43
v_mfma_f32_16x16x32_bf16 v[108:111], v[216:219], a[220:223], v[108:111]
ds_read_b128 v[200:203], v19 offset:0
buffer_load_dwordx4 v30, s[8:11], s95 offen offset:2048 nt lds
v_mfma_f32_16x16x32_bf16 v[112:115], v[216:219], a[224:227], v[112:115]
v_or3_b32 v44, v44, v144, v145
v_or3_b32 v44, v44, v146, v147
v_and_b32 v44, 0x40004000, v44
v_cmp_ne_u32 vcc, 0, v44
v_mfma_f32_16x16x32_bf16 v[116:119], v[216:219], a[228:231], v[116:119]
buffer_load_dwordx4 v31, s[8:11], s95 offen offset:3072 nt lds
v_mfma_f32_16x16x32_bf16 v[120:123], v[216:219], a[232:235], v[120:123]
s_add_u32 s95, s95, 4096
s_and_b32 s95, s95, 0x3ffff
v_mfma_f32_16x16x32_bf16 v[124:127], v[216:219], a[236:239], v[124:127]
s_cbranch_vccnz L_rare_5
L_rare_5_ret:
s_waitcnt lgkmcnt(2)
v_mfma_f32_16x16x32_bf16 v[48:51], v[188:191], a[160:163], v[168:171]
ds_read_b128 v[204:207], v16 offset:4096
v_mfma_f32_16x16x32_bf16 v[52:55], v[188:191], a[164:167], v[172:175]
v_exp_f32 v36, v88
v_mfma_f32_16x16x32_bf16 v[56:59], v[188:191], a[168:171], v[176:179]
v_exp_f32 v37, v89
v_mfma_f32_16x16x32_bf16 v[60:63], v[188:191], a[172:175], v[180:183]
v_exp_f32 v38, v90
v_mfma_f32_16x16x32_bf16 v[64:67], v[188:191], a[176:179], v[184:187]
v_exp_f32 v39, v91
v_cvt_pk_bf16_f32 v148, v36, v37
v_mfma_f32_16x16x32_bf16 v[48:51], v[192:195], a[180:183], v[48:51]
ds_read_b128 v[208:211], v17 offset:4096
v_cvt_pk_bf16_f32 v149, v38, v39
v_mfma_f32_16x16x32_bf16 v[52:55], v[192:195], a[184:187], v[52:55]
v_exp_f32 v40, v108
v_mfma_f32_16x16x32_bf16 v[56:59], v[192:195], a[188:191], v[56:59]
v_exp_f32 v41, v109
v_mfma_f32_16x16x32_bf16 v[60:63], v[192:195], a[192:195], v[60:63]
v_exp_f32 v42, v110
v_mfma_f32_16x16x32_bf16 v[64:67], v[192:195], a[196:199], v[64:67]
v_exp_f32 v43, v111
s_waitcnt lgkmcnt(2)
v_mfma_f32_16x16x32_bf16 v[48:51], v[196:199], a[200:203], v[48:51]
ds_read_b128 v[212:215], v18 offset:4096
s_add_u32 m0, s93, 0
v_mfma_f32_16x16x32_bf16 v[52:55], v[196:199], a[204:207], v[52:55]
buffer_load_dwordx4 v28, s[8:11], s95 offen offset:0 nt lds
v_mfma_f32_16x16x32_bf16 v[56:59], v[196:199], a[208:211], v[56:59]
v_cvt_pk_bf16_f32 v150, v40, v41
v_mfma_f32_16x16x32_bf16 v[60:63], v[196:199], a[212:215], v[60:63]
v_cvt_pk_bf16_f32 v151, v42, v43
v_or_b32 v44, v148, v149
v_mfma_f32_16x16x32_bf16 v[64:67], v[196:199], a[216:219], v[64:67]
v_or3_b32 v44, v44, v150, v151
v_exp_f32 v36, v92
v_mfma_f32_16x16x32_bf16 v[48:51], v[200:203], a[220:223], v[48:51]
ds_read_b128 v[216:219], v19 offset:4096
buffer_load_dwordx4 v29, s[8:11], s95 offen offset:1024 nt lds
v_mfma_f32_16x16x32_bf16 v[52:55], v[200:203], a[224:227], v[52:55]
v_exp_f32 v37, v93
v_mfma_f32_16x16x32_bf16 v[56:59], v[200:203], a[228:231], v[56:59]
v_exp_f32 v38, v94
v_mfma_f32_16x16x32_bf16 v[60:63], v[200:203], a[232:235], v[60:63]
v_exp_f32 v39, v95
v_mfma_f32_16x16x32_bf16 v[64:67], v[200:203], a[236:239], v[64:67]
buffer_load_dwordx4 v30, s[8:11], s95 offen offset:2048 nt lds
s_waitcnt lgkmcnt(2)
v_mfma_f32_16x16x32_bf16 v[68:71], v[204:207], a[160:163], v[168:171]
ds_read_b64_tr_b16 v[188:189], v20 offset:0
v_mfma_f32_16x16x32_bf16 v[72:75], v[204:207], a[164:167], v[172:175]
ds_read_b64_tr_b16 v[190:191], v20 offset:4096
v_cvt_pk_bf16_f32 v152, v36, v37
v_mfma_f32_16x16x32_bf16 v[76:79], v[204:207], a[168:171], v[176:179]
v_cvt_pk_bf16_f32 v153, v38, v39
v_exp_f32 v40, v112
v_mfma_f32_16x16x32_bf16 v[80:83], v[204:207], a[172:175], v[180:183]
buffer_load_dwordx4 v31, s[8:11], s95 offen offset:3072 nt lds
v_mfma_f32_16x16x32_bf16 v[84:87], v[204:207], a[176:179], v[184:187]
v_exp_f32 v41, v113
v_mfma_f32_16x16x32_bf16 v[68:71], v[208:211], a[180:183], v[68:71]
ds_read_b64_tr_b16 v[192:193], v21 offset:0
v_mfma_f32_16x16x32_bf16 v[72:75], v[208:211], a[184:187], v[72:75]
ds_read_b64_tr_b16 v[194:195], v21 offset:4096
s_add_u32 s95, s95, 4096
v_mfma_f32_16x16x32_bf16 v[76:79], v[208:211], a[188:191], v[76:79]
v_exp_f32 v42, v114
v_mfma_f32_16x16x32_bf16 v[80:83], v[208:211], a[192:195], v[80:83]
v_exp_f32 v43, v115
v_mfma_f32_16x16x32_bf16 v[84:87], v[208:211], a[196:199], v[84:87]
v_cvt_pk_bf16_f32 v154, v40, v41
v_cvt_pk_bf16_f32 v155, v42, v43
s_waitcnt lgkmcnt(4)
v_mfma_f32_16x16x32_bf16 v[68:71], v[212:215], a[200:203], v[68:71]
ds_read_b64_tr_b16 v[196:197], v22 offset:0
s_add_u32 m0, s93, 4096
v_mfma_f32_16x16x32_bf16 v[72:75], v[212:215], a[204:207], v[72:75]
ds_read_b64_tr_b16 v[198:199], v22 offset:4096
buffer_load_dwordx4 v28, s[8:11], s95 offen offset:0 nt lds
v_mfma_f32_16x16x32_bf16 v[76:79], v[212:215], a[208:211], v[76:79]
v_or3_b32 v44, v44, v152, v153
v_or3_b32 v44, v44, v154, v155
v_mfma_f32_16x16x32_bf16 v[80:83], v[212:215], a[212:215], v[80:83]
v_exp_f32 v36, v96
v_mfma_f32_16x16x32_bf16 v[84:87], v[212:215], a[216:219], v[84:87]
v_exp_f32 v37, v97
v_mfma_f32_16x16x32_bf16 v[68:71], v[216:219], a[220:223], v[68:71]
ds_read_b64_tr_b16 v[200:201], v23 offset:0
buffer_load_dwordx4 v29, s[8:11], s95 offen offset:1024 nt lds
v_mfma_f32_16x16x32_bf16 v[72:75], v[216:219], a[224:227], v[72:75]
ds_read_b64_tr_b16 v[202:203], v23 offset:4096
v_mfma_f32_16x16x32_bf16 v[76:79], v[216:219], a[228:231], v[76:79]
v_exp_f32 v38, v98
v_mfma_f32_16x16x32_bf16 v[80:83], v[216:219], a[232:235], v[80:83]
v_exp_f32 v39, v99
v_cvt_pk_bf16_f32 v156, v36, v37
v_mfma_f32_16x16x32_bf16 v[84:87], v[216:219], a[236:239], v[84:87]
buffer_load_dwordx4 v30, s[8:11], s95 offen offset:2048 nt lds
s_waitcnt lgkmcnt(4)
v_mfma_f32_16x16x32_bf16 a[0:3], v[188:191], v[128:131], 0
ds_read_b64_tr_b16 v[204:205], v24 offset:0
v_cvt_pk_bf16_f32 v157, v38, v39
v_mfma_f32_16x16x32_bf16 a[4:7], v[188:191], v[132:135], 0
ds_read_b64_tr_b16 v[206:207], v24 offset:4096
v_mfma_f32_16x16x32_bf16 a[8:11], v[188:191], v[136:139], 0
v_exp_f32 v40, v116
v_mfma_f32_16x16x32_bf16 a[12:15], v[188:191], v[140:143], 0
buffer_load_dwordx4 v31, s[8:11], s95 offen offset:3072 nt lds
v_mfma_f32_16x16x32_bf16 a[16:19], v[188:191], v[144:147], 0
v_exp_f32 v41, v117
v_mfma_f32_16x16x32_bf16 a[20:23], v[192:195], v[128:131], 0
ds_read_b64_tr_b16 v[208:209], v25 offset:0
v_exp_f32 v42, v118
v_mfma_f32_16x16x32_bf16 a[24:27], v[192:195], v[132:135], 0
ds_read_b64_tr_b16 v[210:211], v25 offset:4096
s_add_u32 s95, s95, 4096
s_and_b32 s95, s95, 0x3ffff
v_mfma_f32_16x16x32_bf16 a[28:31], v[192:195], v[136:139], 0
v_exp_f32 v43, v119
v_mfma_f32_16x16x32_bf16 a[32:35], v[192:195], v[140:143], 0
v_cvt_pk_bf16_f32 v158, v40, v41
v_mfma_f32_16x16x32_bf16 a[36:39], v[192:195], v[144:147], 0
v_cvt_pk_bf16_f32 v159, v42, v43
v_or3_b32 v44, v44, v156, v157
s_waitcnt lgkmcnt(4)
v_mfma_f32_16x16x32_bf16 a[40:43], v[196:199], v[128:131], 0
ds_read_b64_tr_b16 v[212:213], v26 offset:0
v_or3_b32 v44, v44, v158, v159
v_mfma_f32_16x16x32_bf16 a[44:47], v[196:199], v[132:135], 0
ds_read_b64_tr_b16 v[214:215], v26 offset:4096
v_exp_f32 v36, v100
v_mfma_f32_16x16x32_bf16 a[48:51], v[196:199], v[136:139], 0
v_exp_f32 v37, v101
v_mfma_f32_16x16x32_bf16 a[52:55], v[196:199], v[140:143], 0
v_exp_f32 v38, v102
v_mfma_f32_16x16x32_bf16 a[56:59], v[196:199], v[144:147], 0
v_exp_f32 v39, v103
v_mfma_f32_16x16x32_bf16 a[60:63], v[200:203], v[128:131], 0
ds_read_b64_tr_b16 v[216:217], v27 offset:0
v_mfma_f32_16x16x32_bf16 a[64:67], v[200:203], v[132:135], 0
ds_read_b64_tr_b16 v[218:219], v27 offset:4096
v_cvt_pk_bf16_f32 v160, v36, v37
v_mfma_f32_16x16x32_bf16 a[68:71], v[200:203], v[136:139], 0
v_cvt_pk_bf16_f32 v161, v38, v39
v_mfma_f32_16x16x32_bf16 a[72:75], v[200:203], v[140:143], 0
v_exp_f32 v40, v120
v_mfma_f32_16x16x32_bf16 a[76:79], v[200:203], v[144:147], 0
v_exp_f32 v41, v121
s_waitcnt vmcnt(8)
s_waitcnt lgkmcnt(4)
v_mfma_f32_16x16x32_bf16 a[80:83], v[204:207], v[128:131], 0
ds_read_b128 v[188:191], v16 offset:8192
v_exp_f32 v42, v122
v_mfma_f32_16x16x32_bf16 a[84:87], v[204:207], v[132:135], 0
v_exp_f32 v43, v123
v_mfma_f32_16x16x32_bf16 a[88:91], v[204:207], v[136:139], 0
v_cvt_pk_bf16_f32 v162, v40, v41
v_cvt_pk_bf16_f32 v163, v42, v43
v_mfma_f32_16x16x32_bf16 a[92:95], v[204:207], v[140:143], 0
v_or3_b32 v44, v44, v160, v161
v_or3_b32 v44, v44, v162, v163
v_mfma_f32_16x16x32_bf16 a[96:99], v[204:207], v[144:147], 0
v_exp_f32 v36, v104
v_mfma_f32_16x16x32_bf16 a[100:103], v[208:211], v[128:131], 0
ds_read_b128 v[192:195], v17 offset:8192
v_mfma_f32_16x16x32_bf16 a[104:107], v[208:211], v[132:135], 0
v_exp_f32 v37, v105
v_mfma_f32_16x16x32_bf16 a[108:111], v[208:211], v[136:139], 0
v_exp_f32 v38, v106
v_mfma_f32_16x16x32_bf16 a[112:115], v[208:211], v[140:143], 0
v_exp_f32 v39, v107
v_mfma_f32_16x16x32_bf16 a[116:119], v[208:211], v[144:147], 0
v_cvt_pk_bf16_f32 v164, v36, v37
v_cvt_pk_bf16_f32 v165, v38, v39
s_waitcnt lgkmcnt(2)
v_mfma_f32_16x16x32_bf16 a[120:123], v[212:215], v[128:131], 0
ds_read_b128 v[196:199], v18 offset:8192
s_add_u32 m0, s93, 65536
v_mfma_f32_16x16x32_bf16 a[124:127], v[212:215], v[132:135], 0
buffer_load_dwordx4 v32, s[12:15], s96 offen offset:0 nt lds
v_mfma_f32_16x16x32_bf16 a[128:131], v[212:215], v[136:139], 0
v_exp_f32 v40, v124
v_mfma_f32_16x16x32_bf16 a[132:135], v[212:215], v[140:143], 0
v_exp_f32 v41, v125
v_mfma_f32_16x16x32_bf16 a[136:139], v[212:215], v[144:147], 0
buffer_load_dwordx4 v33, s[12:15], s96 offen offset:1024 nt lds
v_mfma_f32_16x16x32_bf16 a[140:143], v[216:219], v[128:131], 0
ds_read_b128 v[200:203], v19 offset:8192
v_exp_f32 v42, v126
v_mfma_f32_16x16x32_bf16 a[144:147], v[216:219], v[132:135], 0
v_exp_f32 v43, v127
v_mfma_f32_16x16x32_bf16 a[148:151], v[216:219], v[136:139], 0
buffer_load_dwordx4 v32, s[12:15], s96 offen offset:2048 nt lds
v_mfma_f32_16x16x32_bf16 a[152:155], v[216:219], v[140:143], 0
v_cvt_pk_bf16_f32 v166, v40, v41
v_mfma_f32_16x16x32_bf16 a[156:159], v[216:219], v[144:147], 0
v_cvt_pk_bf16_f32 v167, v42, v43
v_or3_b32 v44, v44, v164, v165
v_mfma_f32_16x16x32_bf16 v[220:223], v[240:243], v[128:131], 0
buffer_load_dwordx4 v33, s[12:15], s96 offen offset:3072 nt lds
v_mfma_f32_16x16x32_bf16 v[224:227], v[240:243], v[132:135], 0
v_or3_b32 v44, v44, v166, v167
v_and_b32 v44, 0x40004000, v44
v_mfma_f32_16x16x32_bf16 v[228:231], v[240:243], v[136:139], 0
s_add_u32 s96, s96, 4096
v_cmp_ne_u32 vcc, 0, v44
v_mfma_f32_16x16x32_bf16 v[232:235], v[240:243], v[140:143], 0
v_mfma_f32_16x16x32_bf16 v[236:239], v[240:243], v[144:147], 0
s_cbranch_vccnz L_rare_6
L_rare_6_ret:
s_mov_b32 s94, 14
L_B_loop:
s_waitcnt lgkmcnt(2)
v_mfma_f32_16x16x32_bf16 v[88:91], v[188:191], a[160:163], v[168:171]
ds_read_b128 v[204:207], v16 offset:12288
s_add_u32 m0, s93, 69632
v_mfma_f32_16x16x32_bf16 v[92:95], v[188:191], a[164:167], v[172:175]
buffer_load_dwordx4 v32, s[12:15], s96 offen offset:0 nt lds
v_mfma_f32_16x16x32_bf16 v[96:99], v[188:191], a[168:171], v[176:179]
v_exp_f32 v36, v48
v_mfma_f32_16x16x32_bf16 v[100:103], v[188:191], a[172:175], v[180:183]
buffer_load_dwordx4 v33, s[12:15], s96 offen offset:1024 nt lds
v_mfma_f32_16x16x32_bf16 v[104:107], v[188:191], a[176:179], v[184:187]
v_exp_f32 v37, v49
v_mfma_f32_16x16x32_bf16 v[88:91], v[192:195], a[180:183], v[88:91]
ds_read_b128 v[208:211], v17 offset:12288
buffer_load_dwordx4 v32, s[12:15], s96 offen offset:2048 nt lds
v_mfma_f32_16x16x32_bf16 v[92:95], v[192:195], a[184:187], v[92:95]
v_exp_f32 v38, v50
v_mfma_f32_16x16x32_bf16 v[96:99], v[192:195], a[188:191], v[96:99]
buffer_load_dwordx4 v33, s[12:15], s96 offen offset:3072 nt lds
v_mfma_f32_16x16x32_bf16 v[100:103], v[192:195], a[192:195], v[100:103]
s_add_u32 s96, s96, 4096
s_and_b32 s96, s96, 0x3ffff
v_mfma_f32_16x16x32_bf16 v[104:107], v[192:195], a[196:199], v[104:107]
v_exp_f32 v39, v51
v_cvt_pk_bf16_f32 v128, v36, v37
s_waitcnt lgkmcnt(2)
v_mfma_f32_16x16x32_bf16 v[88:91], v[196:199], a[200:203], v[88:91]
ds_read_b128 v[212:215], v18 offset:12288
s_add_u32 m0, s93, 8192
v_mfma_f32_16x16x32_bf16 v[92:95], v[196:199], a[204:207], v[92:95]
buffer_load_dwordx4 v28, s[8:11], s95 offen offset:0 nt lds
v_mfma_f32_16x16x32_bf16 v[96:99], v[196:199], a[208:211], v[96:99]
v_cvt_pk_bf16_f32 v129, v38, v39
v_mfma_f32_16x16x32_bf16 v[100:103], v[196:199], a[212:215], v[100:103]
v_exp_f32 v40, v68
v_mfma_f32_16x16x32_bf16 v[104:107], v[196:199], a[216:219], v[104:107]
v_exp_f32 v41, v69
v_mfma_f32_16x16x32_bf16 v[88:91], v[200:203], a[220:223], v[88:91]
ds_read_b128 v[216:219], v19 offset:12288
buffer_load_dwordx4 v29, s[8:11], s95 offen offset:1024 nt lds
v_mfma_f32_16x16x32_bf16 v[92:95], v[200:203], a[224:227], v[92:95]
v_exp_f32 v42, v70
v_exp_f32 v43, v71
v_mfma_f32_16x16x32_bf16 v[96:99], v[200:203], a[228:231], v[96:99]
v_cvt_pk_bf16_f32 v130, v40, v41
v_mfma_f32_16x16x32_bf16 v[100:103], v[200:203], a[232:235], v[100:103]
v_cvt_pk_bf16_f32 v131, v42, v43
v_or_b32 v44, v128, v129
v_mfma_f32_16x16x32_bf16 v[104:107], v[200:203], a[236:239], v[104:107]
buffer_load_dwordx4 v30, s[8:11], s95 offen offset:2048 nt lds
s_waitcnt vmcnt(19)
s_waitcnt lgkmcnt(2)
v_mfma_f32_16x16x32_bf16 v[108:111], v[204:207], a[160:163], v[168:171]
ds_read_b64_tr_b16 v[188:189], v20 offset:8192
v_or3_b32 v44, v44, v130, v131
v_mfma_f32_16x16x32_bf16 v[112:115], v[204:207], a[164:167], v[172:175]
ds_read_b64_tr_b16 v[190:191], v20 offset:12288
v_exp_f32 v36, v52
v_mfma_f32_16x16x32_bf16 v[116:119], v[204:207], a[168:171], v[176:179]
v_exp_f32 v37, v53
v_mfma_f32_16x16x32_bf16 v[120:123], v[204:207], a[172:175], v[180:183]
buffer_load_dwordx4 v31, s[8:11], s95 offen offset:3072 nt lds
v_mfma_f32_16x16x32_bf16 v[124:127], v[204:207], a[176:179], v[184:187]
v_exp_f32 v38, v54
v_mfma_f32_16x16x32_bf16 v[108:111], v[208:211], a[180:183], v[108:111]
ds_read_b64_tr_b16 v[192:193], v21 offset:8192
v_mfma_f32_16x16x32_bf16 v[112:115], v[208:211], a[184:187], v[112:115]
ds_read_b64_tr_b16 v[194:195], v21 offset:12288
s_add_u32 s95, s95, 4096
v_mfma_f32_16x16x32_bf16 v[116:119], v[208:211], a[188:191], v[116:119]
v_exp_f32 v39, v55
v_cvt_pk_bf16_f32 v132, v36, v37
v_mfma_f32_16x16x32_bf16 v[120:123], v[208:211], a[192:195], v[120:123]
v_cvt_pk_bf16_f32 v133, v38, v39
v_exp_f32 v40, v72
v_mfma_f32_16x16x32_bf16 v[124:127], v[208:211], a[196:199], v[124:127]
v_exp_f32 v41, v73
s_waitcnt lgkmcnt(4)
v_mfma_f32_16x16x32_bf16 v[108:111], v[212:215], a[200:203], v[108:111]
ds_read_b64_tr_b16 v[196:197], v22 offset:8192
s_add_u32 m0, s93, 12288
v_mfma_f32_16x16x32_bf16 v[112:115], v[212:215], a[204:207], v[112:115]
ds_read_b64_tr_b16 v[198:199], v22 offset:12288
buffer_load_dwordx4 v28, s[8:11], s95 offen offset:0 nt lds
v_mfma_f32_16x16x32_bf16 v[116:119], v[212:215], a[208:211], v[116:119]
v_exp_f32 v42, v74
v_mfma_f32_16x16x32_bf16 v[120:123], v[212:215], a[212:215], v[120:123]
v_exp_f32 v43, v75
v_mfma_f32_16x16x32_bf16 v[124:127], v[212:215], a[216:219], v[124:127]
v_cvt_pk_bf16_f32 v134, v40, v41
v_cvt_pk_bf16_f32 v135, v42, v43
v_mfma_f32_16x16x32_bf16 v[108:111], v[216:219], a[220:223], v[108:111]
ds_read_b64_tr_b16 v[200:201], v23 offset:8192
buffer_load_dwordx4 v29, s[8:11], s95 offen offset:1024 nt lds
v_mfma_f32_16x16x32_bf16 v[112:115], v[216:219], a[224:227], v[112:115]
ds_read_b64_tr_b16 v[202:203], v23 offset:12288
v_or3_b32 v44, v44, v132, v133
v_mfma_f32_16x16x32_bf16 v[116:119], v[216:219], a[228:231], v[116:119]
v_or3_b32 v44, v44, v134, v135
v_mfma_f32_16x16x32_bf16 v[120:123], v[216:219], a[232:235], v[120:123]
v_exp_f32 v36, v56
v_mfma_f32_16x16x32_bf16 v[124:127], v[216:219], a[236:239], v[124:127]
buffer_load_dwordx4 v30, s[8:11], s95 offen offset:2048 nt lds
s_waitcnt lgkmcnt(4)
v_mfma_f32_16x16x32_bf16 a[0:3], v[188:191], v[148:151], a[0:3]
ds_read_b64_tr_b16 v[204:205], v24 offset:8192
v_exp_f32 v37, v57
v_mfma_f32_16x16x32_bf16 a[4:7], v[188:191], v[152:155], a[4:7]
ds_read_b64_tr_b16 v[206:207], v24 offset:12288
v_exp_f32 v38, v58
v_mfma_f32_16x16x32_bf16 a[8:11], v[188:191], v[156:159], a[8:11]
v_exp_f32 v39, v59
v_mfma_f32_16x16x32_bf16 a[12:15], v[188:191], v[160:163], a[12:15]
buffer_load_dwordx4 v31, s[8:11], s95 offen offset:3072 nt lds
v_mfma_f32_16x16x32_bf16 a[16:19], v[188:191], v[164:167], a[16:19]
v_cvt_pk_bf16_f32 v136, v36, v37
v_mfma_f32_16x16x32_bf16 a[20:23], v[192:195], v[148:151], a[20:23]
ds_read_b64_tr_b16 v[208:209], v25 offset:8192
v_cvt_pk_bf16_f32 v137, v38, v39
v_mfma_f32_16x16x32_bf16 a[24:27], v[192:195], v[152:155], a[24:27]
ds_read_b64_tr_b16 v[210:211], v25 offset:12288
s_add_u32 s95, s95, 4096
s_and_b32 s95, s95, 0x3ffff
v_mfma_f32_16x16x32_bf16 a[28:31], v[192:195], v[156:159], a[28:31]
v_exp_f32 v40, v76
v_mfma_f32_16x16x32_bf16 a[32:35], v[192:195], v[160:163], a[32:35]
v_exp_f32 v41, v77
v_mfma_f32_16x16x32_bf16 a[36:39], v[192:195], v[164:167], a[36:39]
v_exp_f32 v42, v78
s_waitcnt lgkmcnt(4)
v_mfma_f32_16x16x32_bf16 a[40:43], v[196:199], v[148:151], a[40:43]
ds_read_b64_tr_b16 v[212:213], v26 offset:8192
v_exp_f32 v43, v79
v_mfma_f32_16x16x32_bf16 a[44:47], v[196:199], v[152:155], a[44:47]
ds_read_b64_tr_b16 v[214:215], v26 offset:12288
v_cvt_pk_bf16_f32 v138, v40, v41
v_mfma_f32_16x16x32_bf16 a[48:51], v[196:199], v[156:159], a[48:51]
v_cvt_pk_bf16_f32 v139, v42, v43
v_or3_b32 v44, v44, v136, v137
v_mfma_f32_16x16x32_bf16 a[52:55], v[196:199], v[160:163], a[52:55]
v_or3_b32 v44, v44, v138, v139
v_exp_f32 v36, v60
v_mfma_f32_16x16x32_bf16 a[56:59], v[196:199], v[164:167], a[56:59]
v_exp_f32 v37, v61
v_mfma_f32_16x16x32_bf16 a[60:63], v[200:203], v[148:151], a[60:63]
ds_read_b64_tr_b16 v[216:217], v27 offset:8192
v_mfma_f32_16x16x32_bf16 a[64:67], v[200:203], v[152:155], a[64:67]
ds_read_b64_tr_b16 v[218:219], v27 offset:12288
v_exp_f32 v38, v62
v_mfma_f32_16x16x32_bf16 a[68:71], v[200:203], v[156:159], a[68:71]
v_exp_f32 v39, v63
v_mfma_f32_16x16x32_bf16 a[72:75], v[200:203], v[160:163], a[72:75]
v_cvt_pk_bf16_f32 v140, v36, v37
v_cvt_pk_bf16_f32 v141, v38, v39
v_mfma_f32_16x16x32_bf16 a[76:79], v[200:203], v[164:167], a[76:79]
v_exp_f32 v40, v80
s_waitcnt vmcnt(16)
s_waitcnt lgkmcnt(4)
v_mfma_f32_16x16x32_bf16 a[80:83], v[204:207], v[148:151], a[80:83]
ds_read_b128 v[188:191], v16 offset:0
v_mfma_f32_16x16x32_bf16 a[84:87], v[204:207], v[152:155], a[84:87]
v_exp_f32 v41, v81
v_exp_f32 v42, v82
v_mfma_f32_16x16x32_bf16 a[88:91], v[204:207], v[156:159], a[88:91]
v_exp_f32 v43, v83
v_mfma_f32_16x16x32_bf16 a[92:95], v[204:207], v[160:163], a[92:95]
v_cvt_pk_bf16_f32 v142, v40, v41
v_mfma_f32_16x16x32_bf16 a[96:99], v[204:207], v[164:167], a[96:99]
v_cvt_pk_bf16_f32 v143, v42, v43
v_or3_b32 v44, v44, v140, v141
v_mfma_f32_16x16x32_bf16 a[100:103], v[208:211], v[148:151], a[100:103]
ds_read_b128 v[192:195], v17 offset:0
v_or3_b32 v44, v44, v142, v143
v_mfma_f32_16x16x32_bf16 a[104:107], v[208:211], v[152:155], a[104:107]
v_exp_f32 v36, v64
v_mfma_f32_16x16x32_bf16 a[108:111], v[208:211], v[156:159], a[108:111]
v_exp_f32 v37, v65
v_mfma_f32_16x16x32_bf16 a[112:115], v[208:211], v[160:163], a[112:115]
v_exp_f32 v38, v66
v_mfma_f32_16x16x32_bf16 a[116:119], v[208:211], v[164:167], a[116:119]
v_exp_f32 v39, v67
v_cvt_pk_bf16_f32 v144, v36, v37
s_waitcnt lgkmcnt(2)
v_mfma_f32_16x16x32_bf16 a[120:123], v[212:215], v[148:151], a[120:123]
ds_read_b128 v[196:199], v18 offset:0
s_add_u32 m0, s93, 73728
v_mfma_f32_16x16x32_bf16 a[124:127], v[212:215], v[152:155], a[124:127]
buffer_load_dwordx4 v32, s[12:15], s96 offen offset:0 nt lds
v_mfma_f32_16x16x32_bf16 a[128:131], v[212:215], v[156:159], a[128:131]
v_cvt_pk_bf16_f32 v145, v38, v39
v_exp_f32 v40, v84
v_mfma_f32_16x16x32_bf16 a[132:135], v[212:215], v[160:163], a[132:135]
v_exp_f32 v41, v85
v_mfma_f32_16x16x32_bf16 a[136:139], v[212:215], v[164:167], a[136:139]
buffer_load_dwordx4 v33, s[12:15], s96 offen offset:1024 nt lds
v_mfma_f32_16x16x32_bf16 a[140:143], v[216:219], v[148:151], a[140:143]
ds_read_b128 v[200:203], v19 offset:0
v_mfma_f32_16x16x32_bf16 a[144:147], v[216:219], v[152:155], a[144:147]
v_exp_f32 v42, v86
v_mfma_f32_16x16x32_bf16 a[148:151], v[216:219], v[156:159], a[148:151]
buffer_load_dwordx4 v32, s[12:15], s96 offen offset:2048 nt lds
v_mfma_f32_16x16x32_bf16 a[152:155], v[216:219], v[160:163], a[152:155]
v_exp_f32 v43, v87
v_cvt_pk_bf16_f32 v146, v40, v41
v_mfma_f32_16x16x32_bf16 a[156:159], v[216:219], v[164:167], a[156:159]
v_cvt_pk_bf16_f32 v147, v42, v43
v_or3_b32 v44, v44, v144, v145
v_mfma_f32_16x16x32_bf16 v[220:223], v[240:243], v[148:151], v[220:223]
buffer_load_dwordx4 v33, s[12:15], s96 offen offset:3072 nt lds
v_mfma_f32_16x16x32_bf16 v[224:227], v[240:243], v[152:155], v[224:227]
v_or3_b32 v44, v44, v146, v147
v_and_b32 v44, 0x40004000, v44
v_mfma_f32_16x16x32_bf16 v[228:231], v[240:243], v[156:159], v[228:231]
s_add_u32 s96, s96, 4096
v_cmp_ne_u32 vcc, 0, v44
v_mfma_f32_16x16x32_bf16 v[232:235], v[240:243], v[160:163], v[232:235]
v_mfma_f32_16x16x32_bf16 v[236:239], v[240:243], v[164:167], v[236:239]
s_cbranch_vccnz L_rare_7
L_rare_7_ret:
s_waitcnt lgkmcnt(2)
v_mfma_f32_16x16x32_bf16 v[48:51], v[188:191], a[160:163], v[168:171]
ds_read_b128 v[204:207], v16 offset:4096
s_add_u32 m0, s93, 77824
v_mfma_f32_16x16x32_bf16 v[52:55], v[188:191], a[164:167], v[172:175]
buffer_load_dwordx4 v32, s[12:15], s96 offen offset:0 nt lds
v_mfma_f32_16x16x32_bf16 v[56:59], v[188:191], a[168:171], v[176:179]
v_exp_f32 v36, v88
v_mfma_f32_16x16x32_bf16 v[60:63], v[188:191], a[172:175], v[180:183]
buffer_load_dwordx4 v33, s[12:15], s96 offen offset:1024 nt lds
v_mfma_f32_16x16x32_bf16 v[64:67], v[188:191], a[176:179], v[184:187]
v_exp_f32 v37, v89
v_mfma_f32_16x16x32_bf16 v[48:51], v[192:195], a[180:183], v[48:51]
ds_read_b128 v[208:211], v17 offset:4096
buffer_load_dwordx4 v32, s[12:15], s96 offen offset:2048 nt lds
v_mfma_f32_16x16x32_bf16 v[52:55], v[192:195], a[184:187], v[52:55]
v_exp_f32 v38, v90
v_mfma_f32_16x16x32_bf16 v[56:59], v[192:195], a[188:191], v[56:59]
buffer_load_dwordx4 v33, s[12:15], s96 offen offset:3072 nt lds
v_mfma_f32_16x16x32_bf16 v[60:63], v[192:195], a[192:195], v[60:63]
s_add_u32 s96, s96, 4096
s_and_b32 s96, s96, 0x3ffff
v_mfma_f32_16x16x32_bf16 v[64:67], v[192:195], a[196:199], v[64:67]
v_exp_f32 v39, v91
v_cvt_pk_bf16_f32 v148, v36, v37
s_waitcnt lgkmcnt(2)
v_mfma_f32_16x16x32_bf16 v[48:51], v[196:199], a[200:203], v[48:51]
ds_read_b128 v[212:215], v18 offset:4096
s_cmp_eq_u32 s94, 1
s_cselect_b32 s95, 0x7f000000, s95
s_add_u32 m0, s93, 0
v_mfma_f32_16x16x32_bf16 v[52:55], v[196:199], a[204:207], v[52:55]
buffer_load_dwordx4 v28, s[8:11], s95 offen offset:0 nt lds
v_mfma_f32_16x16x32_bf16 v[56:59], v[196:199], a[208:211], v[56:59]
v_cvt_pk_bf16_f32 v149, v38, v39
v_mfma_f32_16x16x32_bf16 v[60:63], v[196:199], a[212:215], v[60:63]
v_exp_f32 v40, v108
v_mfma_f32_16x16x32_bf16 v[64:67], v[196:199], a[216:219], v[64:67]
v_exp_f32 v41, v109
v_mfma_f32_16x16x32_bf16 v[48:51], v[200:203], a[220:223], v[48:51]
ds_read_b128 v[216:219], v19 offset:4096
buffer_load_dwordx4 v29, s[8:11], s95 offen offset:1024 nt lds
v_mfma_f32_16x16x32_bf16 v[52:55], v[200:203], a[224:227], v[52:55]
v_exp_f32 v42, v110
v_exp_f32 v43, v111
v_mfma_f32_16x16x32_bf16 v[56:59], v[200:203], a[228:231], v[56:59]
v_cvt_pk_bf16_f32 v150, v40, v41
v_mfma_f32_16x16x32_bf16 v[60:63], v[200:203], a[232:235], v[60:63]
v_cvt_pk_bf16_f32 v151, v42, v43
v_or_b32 v44, v148, v149
v_mfma_f32_16x16x32_bf16 v[64:67], v[200:203], a[236:239], v[64:67]
buffer_load_dwordx4 v30, s[8:11], s95 offen offset:2048 nt lds
s_waitcnt vmcnt(19)
s_waitcnt lgkmcnt(2)
v_mfma_f32_16x16x32_bf16 v[68:71], v[204:207], a[160:163], v[168:171]
ds_read_b64_tr_b16 v[188:189], v20 offset:0
v_or3_b32 v44, v44, v150, v151
v_mfma_f32_16x16x32_bf16 v[72:75], v[204:207], a[164:167], v[172:175]
ds_read_b64_tr_b16 v[190:191], v20 offset:4096
v_exp_f32 v36, v92
v_mfma_f32_16x16x32_bf16 v[76:79], v[204:207], a[168:171], v[176:179]
v_exp_f32 v37, v93
v_mfma_f32_16x16x32_bf16 v[80:83], v[204:207], a[172:175], v[180:183]
buffer_load_dwordx4 v31, s[8:11], s95 offen offset:3072 nt lds
v_mfma_f32_16x16x32_bf16 v[84:87], v[204:207], a[176:179], v[184:187]
v_exp_f32 v38, v94
v_mfma_f32_16x16x32_bf16 v[68:71], v[208:211], a[180:183], v[68:71]
ds_read_b64_tr_b16 v[192:193], v21 offset:0
v_mfma_f32_16x16x32_bf16 v[72:75], v[208:211], a[184:187], v[72:75]
ds_read_b64_tr_b16 v[194:195], v21 offset:4096
s_add_u32 s95, s95, 4096
v_mfma_f32_16x16x32_bf16 v[76:79], v[208:211], a[188:191], v[76:79]
v_exp_f32 v39, v95
v_cvt_pk_bf16_f32 v152, v36, v37
v_mfma_f32_16x16x32_bf16 v[80:83], v[208:211], a[192:195], v[80:83]
v_cvt_pk_bf16_f32 v153, v38, v39
v_exp_f32 v40, v112
v_mfma_f32_16x16x32_bf16 v[84:87], v[208:211], a[196:199], v[84:87]
v_exp_f32 v41, v113
s_waitcnt lgkmcnt(4)
v_mfma_f32_16x16x32_bf16 v[68:71], v[212:215], a[200:203], v[68:71]
ds_read_b64_tr_b16 v[196:197], v22 offset:0
s_add_u32 m0, s93, 4096
v_mfma_f32_16x16x32_bf16 v[72:75], v[212:215], a[204:207], v[72:75]
ds_read_b64_tr_b16 v[198:199], v22 offset:4096
buffer_load_dwordx4 v28, s[8:11], s95 offen offset:0 nt lds
v_mfma_f32_16x16x32_bf16 v[76:79], v[212:215], a[208:211], v[76:79]
v_exp_f32 v42, v114
v_mfma_f32_16x16x32_bf16 v[80:83], v[212:215], a[212:215], v[80:83]
v_exp_f32 v43, v115
v_mfma_f32_16x16x32_bf16 v[84:87], v[212:215], a[216:219], v[84:87]
v_cvt_pk_bf16_f32 v154, v40, v41
v_cvt_pk_bf16_f32 v155, v42, v43
v_mfma_f32_16x16x32_bf16 v[68:71], v[216:219], a[220:223], v[68:71]
ds_read_b64_tr_b16 v[200:201], v23 offset:0
buffer_load_dwordx4 v29, s[8:11], s95 offen offset:1024 nt lds
v_mfma_f32_16x16x32_bf16 v[72:75], v[216:219], a[224:227], v[72:75]
ds_read_b64_tr_b16 v[202:203], v23 offset:4096
v_or3_b32 v44, v44, v152, v153
v_mfma_f32_16x16x32_bf16 v[76:79], v[216:219], a[228:231], v[76:79]
v_or3_b32 v44, v44, v154, v155
v_mfma_f32_16x16x32_bf16 v[80:83], v[216:219], a[232:235], v[80:83]
v_exp_f32 v36, v96
v_mfma_f32_16x16x32_bf16 v[84:87], v[216:219], a[236:239], v[84:87]
buffer_load_dwordx4 v30, s[8:11], s95 offen offset:2048 nt lds
s_waitcnt lgkmcnt(4)
v_mfma_f32_16x16x32_bf16 a[0:3], v[188:191], v[128:131], a[0:3]
ds_read_b64_tr_b16 v[204:205], v24 offset:0
v_exp_f32 v37, v97
v_mfma_f32_16x16x32_bf16 a[4:7], v[188:191], v[132:135], a[4:7]
ds_read_b64_tr_b16 v[206:207], v24 offset:4096
v_exp_f32 v38, v98
v_mfma_f32_16x16x32_bf16 a[8:11], v[188:191], v[136:139], a[8:11]
v_exp_f32 v39, v99
v_mfma_f32_16x16x32_bf16 a[12:15], v[188:191], v[140:143], a[12:15]
buffer_load_dwordx4 v31, s[8:11], s95 offen offset:3072 nt lds
v_mfma_f32_16x16x32_bf16 a[16:19], v[188:191], v[144:147], a[16:19]
v_cvt_pk_bf16_f32 v156, v36, v37
v_mfma_f32_16x16x32_bf16 a[20:23], v[192:195], v[128:131], a[20:23]
ds_read_b64_tr_b16 v[208:209], v25 offset:0
v_cvt_pk_bf16_f32 v157, v38, v39
v_mfma_f32_16x16x32_bf16 a[24:27], v[192:195], v[132:135], a[24:27]
ds_read_b64_tr_b16 v[210:211], v25 offset:4096
s_add_u32 s95, s95, 4096
s_and_b32 s95, s95, 0x3ffff
v_mfma_f32_16x16x32_bf16 a[28:31], v[192:195], v[136:139], a[28:31]
v_exp_f32 v40, v116
v_mfma_f32_16x16x32_bf16 a[32:35], v[192:195], v[140:143], a[32:35]
v_exp_f32 v41, v117
v_mfma_f32_16x16x32_bf16 a[36:39], v[192:195], v[144:147], a[36:39]
v_exp_f32 v42, v118
s_waitcnt lgkmcnt(4)
v_mfma_f32_16x16x32_bf16 a[40:43], v[196:199], v[128:131], a[40:43]
ds_read_b64_tr_b16 v[212:213], v26 offset:0
v_exp_f32 v43, v119
v_mfma_f32_16x16x32_bf16 a[44:47], v[196:199], v[132:135], a[44:47]
ds_read_b64_tr_b16 v[214:215], v26 offset:4096
v_cvt_pk_bf16_f32 v158, v40, v41
v_mfma_f32_16x16x32_bf16 a[48:51], v[196:199], v[136:139], a[48:51]
v_cvt_pk_bf16_f32 v159, v42, v43
v_or3_b32 v44, v44, v156, v157
v_mfma_f32_16x16x32_bf16 a[52:55], v[196:199], v[140:143], a[52:55]
v_or3_b32 v44, v44, v158, v159
v_exp_f32 v36, v100
v_mfma_f32_16x16x32_bf16 a[56:59], v[196:199], v[144:147], a[56:59]
v_exp_f32 v37, v101
v_mfma_f32_16x16x32_bf16 a[60:63], v[200:203], v[128:131], a[60:63]
ds_read_b64_tr_b16 v[216:217], v27 offset:0
v_mfma_f32_16x16x32_bf16 a[64:67], v[200:203], v[132:135], a[64:67]
ds_read_b64_tr_b16 v[218:219], v27 offset:4096
v_exp_f32 v38, v102
v_mfma_f32_16x16x32_bf16 a[68:71], v[200:203], v[136:139], a[68:71]
v_exp_f32 v39, v103
v_mfma_f32_16x16x32_bf16 a[72:75], v[200:203], v[140:143], a[72:75]
v_cvt_pk_bf16_f32 v160, v36, v37
v_cvt_pk_bf16_f32 v161, v38, v39
v_mfma_f32_16x16x32_bf16 a[76:79], v[200:203], v[144:147], a[76:79]
v_exp_f32 v40, v120
s_waitcnt vmcnt(16)
s_waitcnt lgkmcnt(4)
v_mfma_f32_16x16x32_bf16 a[80:83], v[204:207], v[128:131], a[80:83]
ds_read_b128 v[188:191], v16 offset:8192
v_mfma_f32_16x16x32_bf16 a[84:87], v[204:207], v[132:135], a[84:87]
v_exp_f32 v41, v121
v_exp_f32 v42, v122
v_mfma_f32_16x16x32_bf16 a[88:91], v[204:207], v[136:139], a[88:91]
v_exp_f32 v43, v123
v_mfma_f32_16x16x32_bf16 a[92:95], v[204:207], v[140:143], a[92:95]
v_cvt_pk_bf16_f32 v162, v40, v41
v_mfma_f32_16x16x32_bf16 a[96:99], v[204:207], v[144:147], a[96:99]
v_cvt_pk_bf16_f32 v163, v42, v43
v_or3_b32 v44, v44, v160, v161
v_mfma_f32_16x16x32_bf16 a[100:103], v[208:211], v[128:131], a[100:103]
ds_read_b128 v[192:195], v17 offset:8192
v_or3_b32 v44, v44, v162, v163
v_mfma_f32_16x16x32_bf16 a[104:107], v[208:211], v[132:135], a[104:107]
v_exp_f32 v36, v104
v_mfma_f32_16x16x32_bf16 a[108:111], v[208:211], v[136:139], a[108:111]
v_exp_f32 v37, v105
v_mfma_f32_16x16x32_bf16 a[112:115], v[208:211], v[140:143], a[112:115]
v_exp_f32 v38, v106
v_mfma_f32_16x16x32_bf16 a[116:119], v[208:211], v[144:147], a[116:119]
v_exp_f32 v39, v107
v_cvt_pk_bf16_f32 v164, v36, v37
s_waitcnt lgkmcnt(2)
v_mfma_f32_16x16x32_bf16 a[120:123], v[212:215], v[128:131], a[120:123]
ds_read_b128 v[196:199], v18 offset:8192
s_add_u32 m0, s93, 65536
v_mfma_f32_16x16x32_bf16 a[124:127], v[212:215], v[132:135], a[124:127]
buffer_load_dwordx4 v32, s[12:15], s96 offen offset:0 nt lds
v_mfma_f32_16x16x32_bf16 a[128:131], v[212:215], v[136:139], a[128:131]
v_cvt_pk_bf16_f32 v165, v38, v39
v_exp_f32 v40, v124
v_mfma_f32_16x16x32_bf16 a[132:135], v[212:215], v[140:143], a[132:135]
v_exp_f32 v41, v125
v_mfma_f32_16x16x32_bf16 a[136:139], v[212:215], v[144:147], a[136:139]
buffer_load_dwordx4 v33, s[12:15], s96 offen offset:1024 nt lds
v_mfma_f32_16x16x32_bf16 a[140:143], v[216:219], v[128:131], a[140:143]
ds_read_b128 v[200:203], v19 offset:8192
v_mfma_f32_16x16x32_bf16 a[144:147], v[216:219], v[132:135], a[144:147]
v_exp_f32 v42, v126
v_mfma_f32_16x16x32_bf16 a[148:151], v[216:219], v[136:139], a[148:151]
buffer_load_dwordx4 v32, s[12:15], s96 offen offset:2048 nt lds
v_mfma_f32_16x16x32_bf16 a[152:155], v[216:219], v[140:143], a[152:155]
v_exp_f32 v43, v127
v_cvt_pk_bf16_f32 v166, v40, v41
v_mfma_f32_16x16x32_bf16 a[156:159], v[216:219], v[144:147], a[156:159]
v_cvt_pk_bf16_f32 v167, v42, v43
v_or3_b32 v44, v44, v164, v165
v_mfma_f32_16x16x32_bf16 v[220:223], v[240:243], v[128:131], v[220:223]
buffer_load_dwordx4 v33, s[12:15], s96 offen offset:3072 nt lds
v_mfma_f32_16x16x32_bf16 v[224:227], v[240:243], v[132:135], v[224:227]
v_or3_b32 v44, v44, v166, v167
v_and_b32 v44, 0x40004000, v44
v_mfma_f32_16x16x32_bf16 v[228:231], v[240:243], v[136:139], v[228:231]
s_add_u32 s96, s96, 4096
v_cmp_ne_u32 vcc, 0, v44
v_mfma_f32_16x16x32_bf16 v[232:235], v[240:243], v[140:143], v[232:235]
v_mfma_f32_16x16x32_bf16 v[236:239], v[240:243], v[144:147], v[236:239]
s_cbranch_vccnz L_rare_8
L_rare_8_ret:
s_barrier
s_sub_u32 s94, s94, 1
s_cmp_lg_u32 s94, 0
s_cbranch_scc1 L_B_loop
s_waitcnt lgkmcnt(2)
v_mfma_f32_16x16x32_bf16 v[88:91], v[188:191], a[160:163], v[168:171]
ds_read_b128 v[204:207], v16 offset:12288
s_add_u32 m0, s93, 69632
v_mfma_f32_16x16x32_bf16 v[92:95], v[188:191], a[164:167], v[172:175]
buffer_load_dwordx4 v32, s[12:15], s96 offen offset:0 nt lds
v_mfma_f32_16x16x32_bf16 v[96:99], v[188:191], a[168:171], v[176:179]
v_exp_f32 v36, v48
v_mfma_f32_16x16x32_bf16 v[100:103], v[188:191], a[172:175], v[180:183]
buffer_load_dwordx4 v33, s[12:15], s96 offen offset:1024 nt lds
v_mfma_f32_16x16x32_bf16 v[104:107], v[188:191], a[176:179], v[184:187]
v_exp_f32 v37, v49
v_mfma_f32_16x16x32_bf16 v[88:91], v[192:195], a[180:183], v[88:91]
ds_read_b128 v[208:211], v17 offset:12288
buffer_load_dwordx4 v32, s[12:15], s96 offen offset:2048 nt lds
v_mfma_f32_16x16x32_bf16 v[92:95], v[192:195], a[184:187], v[92:95]
v_exp_f32 v38, v50
v_exp_f32 v39, v51
v_mfma_f32_16x16x32_bf16 v[96:99], v[192:195], a[188:191], v[96:99]
buffer_load_dwordx4 v33, s[12:15], s96 offen offset:3072 nt lds
v_mfma_f32_16x16x32_bf16 v[100:103], v[192:195], a[192:195], v[100:103]
s_add_u32 s96, s96, 4096
s_and_b32 s96, s96, 0x3ffff
v_mfma_f32_16x16x32_bf16 v[104:107], v[192:195], a[196:199], v[104:107]
v_cvt_pk_bf16_f32 v128, v36, v37
s_waitcnt lgkmcnt(2)
v_mfma_f32_16x16x32_bf16 v[88:91], v[196:199], a[200:203], v[88:91]
ds_read_b128 v[212:215], v18 offset:12288
s_add_u32 m0, s97, 0
v_mfma_f32_16x16x32_bf16 v[92:95], v[196:199], a[204:207], v[92:95]
buffer_load_dwordx4 v32, s[12:15], s96 offen offset:0 nt lds
v_mfma_f32_16x16x32_bf16 v[96:99], v[196:199], a[208:211], v[96:99]
v_cvt_pk_bf16_f32 v129, v38, v39
v_exp_f32 v40, v68
v_mfma_f32_16x16x32_bf16 v[100:103], v[196:199], a[212:215], v[100:103]
v_exp_f32 v41, v69
v_mfma_f32_16x16x32_bf16 v[104:107], v[196:199], a[216:219], v[104:107]
buffer_load_dwordx4 v33, s[12:15], s96 offen offset:1024 nt lds
v_mfma_f32_16x16x32_bf16 v[88:91], v[200:203], a[220:223], v[88:91]
ds_read_b128 v[216:219], v19 offset:12288
v_exp_f32 v42, v70
v_mfma_f32_16x16x32_bf16 v[92:95], v[200:203], a[224:227], v[92:95]
v_exp_f32 v43, v71
v_mfma_f32_16x16x32_bf16 v[96:99], v[200:203], a[228:231], v[96:99]
buffer_load_dwordx4 v32, s[12:15], s96 offen offset:2048 nt lds
v_mfma_f32_16x16x32_bf16 v[100:103], v[200:203], a[232:235], v[100:103]
v_cvt_pk_bf16_f32 v130, v40, v41
v_cvt_pk_bf16_f32 v131, v42, v43
v_mfma_f32_16x16x32_bf16 v[104:107], v[200:203], a[236:239], v[104:107]
v_or_b32 v44, v128, v129
v_or3_b32 v44, v44, v130, v131
s_waitcnt vmcnt(19)
s_waitcnt lgkmcnt(2)
v_mfma_f32_16x16x32_bf16 v[108:111], v[204:207], a[160:163], v[168:171]
ds_read_b64_tr_b16 v[188:189], v20 offset:8192
buffer_load_dwordx4 v33, s[12:15], s96 offen offset:3072 nt lds
v_mfma_f32_16x16x32_bf16 v[112:115], v[204:207], a[164:167], v[172:175]
ds_read_b64_tr_b16 v[190:191], v20 offset:12288
v_exp_f32 v36, v52
v_mfma_f32_16x16x32_bf16 v[116:119], v[204:207], a[168:171], v[176:179]
s_add_u32 s96, s96, 4096
s_add_u32 m0, s97, 4096
v_mfma_f32_16x16x32_bf16 v[120:123], v[204:207], a[172:175], v[180:183]
buffer_load_dwordx4 v32, s[12:15], s96 offen offset:0 nt lds
v_mfma_f32_16x16x32_bf16 v[124:127], v[204:207], a[176:179], v[184:187]
v_exp_f32 v37, v53
v_mfma_f32_16x16x32_bf16 v[108:111], v[208:211], a[180:183], v[108:111]
ds_read_b64_tr_b16 v[192:193], v21 offset:8192
v_exp_f32 v38, v54
v_mfma_f32_16x16x32_bf16 v[112:115], v[208:211], a[184:187], v[112:115]
ds_read_b64_tr_b16 v[194:195], v21 offset:12288
buffer_load_dwordx4 v33, s[12:15], s96 offen offset:1024 nt lds
v_mfma_f32_16x16x32_bf16 v[116:119], v[208:211], a[188:191], v[116:119]
v_exp_f32 v39, v55
v_mfma_f32_16x16x32_bf16 v[120:123], v[208:211], a[192:195], v[120:123]
v_cvt_pk_bf16_f32 v132, v36, v37
v_cvt_pk_bf16_f32 v133, v38, v39
v_mfma_f32_16x16x32_bf16 v[124:127], v[208:211], a[196:199], v[124:127]
buffer_load_dwordx4 v32, s[12:15], s96 offen offset:2048 nt lds
s_waitcnt lgkmcnt(4)
v_mfma_f32_16x16x32_bf16 v[108:111], v[212:215], a[200:203], v[108:111]
ds_read_b64_tr_b16 v[196:197], v22 offset:8192
v_exp_f32 v40, v72
v_mfma_f32_16x16x32_bf16 v[112:115], v[212:215], a[204:207], v[112:115]
ds_read_b64_tr_b16 v[198:199], v22 offset:12288
v_mfma_f32_16x16x32_bf16 v[116:119], v[212:215], a[208:211], v[116:119]
buffer_load_dwordx4 v33, s[12:15], s96 offen offset:3072 nt lds
v_mfma_f32_16x16x32_bf16 v[120:123], v[212:215], a[212:215], v[120:123]
v_exp_f32 v41, v73
v_mfma_f32_16x16x32_bf16 v[124:127], v[212:215], a[216:219], v[124:127]
s_add_u32 s96, s96, 4096
s_and_b32 s96, s96, 0x3ffff
v_mfma_f32_16x16x32_bf16 v[108:111], v[216:219], a[220:223], v[108:111]
ds_read_b64_tr_b16 v[200:201], v23 offset:8192
v_exp_f32 v42, v74
v_mfma_f32_16x16x32_bf16 v[112:115], v[216:219], a[224:227], v[112:115]
ds_read_b64_tr_b16 v[202:203], v23 offset:12288
v_mfma_f32_16x16x32_bf16 v[116:119], v[216:219], a[228:231], v[116:119]
v_exp_f32 v43, v75
v_cvt_pk_bf16_f32 v134, v40, v41
v_mfma_f32_16x16x32_bf16 v[120:123], v[216:219], a[232:235], v[120:123]
v_cvt_pk_bf16_f32 v135, v42, v43
v_or3_b32 v44, v44, v132, v133
v_or3_b32 v44, v44, v134, v135
v_mfma_f32_16x16x32_bf16 v[124:127], v[216:219], a[236:239], v[124:127]
v_exp_f32 v36, v56
s_waitcnt lgkmcnt(4)
v_mfma_f32_16x16x32_bf16 a[0:3], v[188:191], v[148:151], a[0:3]
ds_read_b64_tr_b16 v[204:205], v24 offset:8192
s_cmp_gt_i32 s91, 0
s_cselect_b32 s92, s88, 0x7f000000
s_sub_u32 s91, s91, 1
s_add_u32 s88, s88, s89
s_and_b32 s88, s88, s90
s_add_u32 m0, s93, 0
v_mfma_f32_16x16x32_bf16 a[4:7], v[188:191], v[152:155], a[4:7]
ds_read_b64_tr_b16 v[206:207], v24 offset:12288
buffer_load_dwordx4 v244, s[16:19], s92 offen offset:0 lds
v_mfma_f32_16x16x32_bf16 a[8:11], v[188:191], v[156:159], a[8:11]
v_exp_f32 v37, v57
v_mfma_f32_16x16x32_bf16 a[12:15], v[188:191], v[160:163], a[12:15]
v_exp_f32 v38, v58
v_mfma_f32_16x16x32_bf16 a[16:19], v[188:191], v[164:167], a[16:19]
v_exp_f32 v39, v59
v_cvt_pk_bf16_f32 v136, v36, v37
v_mfma_f32_16x16x32_bf16 a[20:23], v[192:195], v[148:151], a[20:23]
ds_read_b64_tr_b16 v[208:209], v25 offset:8192
buffer_load_dwordx4 v245, s[16:19], s92 offen offset:1024 lds
v_mfma_f32_16x16x32_bf16 a[24:27], v[192:195], v[152:155], a[24:27]
ds_read_b64_tr_b16 v[210:211], v25 offset:12288
v_cvt_pk_bf16_f32 v137, v38, v39
v_mfma_f32_16x16x32_bf16 a[28:31], v[192:195], v[156:159], a[28:31]
v_exp_f32 v40, v76
v_mfma_f32_16x16x32_bf16 a[32:35], v[192:195], v[160:163], a[32:35]
v_exp_f32 v41, v77
v_mfma_f32_16x16x32_bf16 a[36:39], v[192:195], v[164:167], a[36:39]
buffer_load_dwordx4 v246, s[16:19], s92 offen offset:2048 lds
s_waitcnt lgkmcnt(4)
v_mfma_f32_16x16x32_bf16 a[40:43], v[196:199], v[148:151], a[40:43]
ds_read_b64_tr_b16 v[212:213], v26 offset:8192
v_exp_f32 v42, v78
v_mfma_f32_16x16x32_bf16 a[44:47], v[196:199], v[152:155], a[44:47]
ds_read_b64_tr_b16 v[214:215], v26 offset:12288
v_exp_f32 v43, v79
v_mfma_f32_16x16x32_bf16 a[48:51], v[196:199], v[156:159], a[48:51]
v_cvt_pk_bf16_f32 v138, v40, v41
v_cvt_pk_bf16_f32 v139, v42, v43
v_mfma_f32_16x16x32_bf16 a[52:55], v[196:199], v[160:163], a[52:55]
buffer_load_dwordx4 v247, s[16:19], s92 offen offset:3072 lds
v_mfma_f32_16x16x32_bf16 a[56:59], v[196:199], v[164:167], a[56:59]
v_or3_b32 v44, v44, v136, v137
v_or3_b32 v44, v44, v138, v139
v_mfma_f32_16x16x32_bf16 a[60:63], v[200:203], v[148:151], a[60:63]
ds_read_b64_tr_b16 v[216:217], v27 offset:8192
v_exp_f32 v36, v60
v_mfma_f32_16x16x32_bf16 a[64:67], v[200:203], v[152:155], a[64:67]
ds_read_b64_tr_b16 v[218:219], v27 offset:12288
s_add_u32 m0, s93, 4096
v_mfma_f32_16x16x32_bf16 a[68:71], v[200:203], v[156:159], a[68:71]
buffer_load_dwordx4 v248, s[16:19], s92 offen offset:0 lds
v_mfma_f32_16x16x32_bf16 a[72:75], v[200:203], v[160:163], a[72:75]
v_exp_f32 v37, v61
v_mfma_f32_16x16x32_bf16 a[76:79], v[200:203], v[164:167], a[76:79]
v_exp_f32 v38, v62
s_waitcnt vmcnt(13)
s_waitcnt lgkmcnt(4)
v_mfma_f32_16x16x32_bf16 a[80:83], v[204:207], v[148:151], a[80:83]
ds_read_b64_tr_b16 v[188:189], v20 offset:0
v_exp_f32 v39, v63
v_mfma_f32_16x16x32_bf16 a[84:87], v[204:207], v[152:155], a[84:87]
ds_read_b64_tr_b16 v[190:191], v20 offset:4096
buffer_load_dwordx4 v249, s[16:19], s92 offen offset:1024 lds
v_mfma_f32_16x16x32_bf16 a[88:91], v[204:207], v[156:159], a[88:91]
v_cvt_pk_bf16_f32 v140, v36, v37
v_mfma_f32_16x16x32_bf16 a[92:95], v[204:207], v[160:163], a[92:95]
v_cvt_pk_bf16_f32 v141, v38, v39
v_exp_f32 v40, v80
v_mfma_f32_16x16x32_bf16 a[96:99], v[204:207], v[164:167], a[96:99]
v_exp_f32 v41, v81
v_mfma_f32_16x16x32_bf16 a[100:103], v[208:211], v[148:151], a[100:103]
ds_read_b64_tr_b16 v[192:193], v21 offset:0
buffer_load_dwordx4 v250, s[16:19], s92 offen offset:2048 lds
v_mfma_f32_16x16x32_bf16 a[104:107], v[208:211], v[152:155], a[104:107]
ds_read_b64_tr_b16 v[194:195], v21 offset:4096
v_exp_f32 v42, v82
v_mfma_f32_16x16x32_bf16 a[108:111], v[208:211], v[156:159], a[108:111]
v_exp_f32 v43, v83
v_mfma_f32_16x16x32_bf16 a[112:115], v[208:211], v[160:163], a[112:115]
v_cvt_pk_bf16_f32 v142, v40, v41
v_cvt_pk_bf16_f32 v143, v42, v43
v_mfma_f32_16x16x32_bf16 a[116:119], v[208:211], v[164:167], a[116:119]
buffer_load_dwordx4 v251, s[16:19], s92 offen offset:3072 lds
s_waitcnt lgkmcnt(4)
v_mfma_f32_16x16x32_bf16 a[120:123], v[212:215], v[148:151], a[120:123]
ds_read_b64_tr_b16 v[196:197], v22 offset:0
v_or3_b32 v44, v44, v140, v141
v_mfma_f32_16x16x32_bf16 a[124:127], v[212:215], v[152:155], a[124:127]
ds_read_b64_tr_b16 v[198:199], v22 offset:4096
v_or3_b32 v44, v44, v142, v143
v_mfma_f32_16x16x32_bf16 a[128:131], v[212:215], v[156:159], a[128:131]
v_exp_f32 v36, v64
v_mfma_f32_16x16x32_bf16 a[132:135], v[212:215], v[160:163], a[132:135]
v_exp_f32 v37, v65
v_exp_f32 v38, v66
v_mfma_f32_16x16x32_bf16 a[136:139], v[212:215], v[164:167], a[136:139]
v_exp_f32 v39, v67
v_mfma_f32_16x16x32_bf16 a[140:143], v[216:219], v[148:151], a[140:143]
ds_read_b64_tr_b16 v[200:201], v23 offset:0
v_cvt_pk_bf16_f32 v144, v36, v37
v_mfma_f32_16x16x32_bf16 a[144:147], v[216:219], v[152:155], a[144:147]
ds_read_b64_tr_b16 v[202:203], v23 offset:4096
v_cvt_pk_bf16_f32 v145, v38, v39
v_mfma_f32_16x16x32_bf16 a[148:151], v[216:219], v[156:159], a[148:151]
v_exp_f32 v40, v84
v_mfma_f32_16x16x32_bf16 a[152:155], v[216:219], v[160:163], a[152:155]
v_exp_f32 v41, v85
v_mfma_f32_16x16x32_bf16 a[156:159], v[216:219], v[164:167], a[156:159]
v_exp_f32 v42, v86
v_mfma_f32_16x16x32_bf16 v[220:223], v[240:243], v[148:151], v[220:223]
v_exp_f32 v43, v87
v_cvt_pk_bf16_f32 v146, v40, v41
v_mfma_f32_16x16x32_bf16 v[224:227], v[240:243], v[152:155], v[224:227]
v_cvt_pk_bf16_f32 v147, v42, v43
v_or3_b32 v44, v44, v144, v145
v_or3_b32 v44, v44, v146, v147
v_mfma_f32_16x16x32_bf16 v[228:231], v[240:243], v[156:159], v[228:231]
v_and_b32 v44, 0x40004000, v44
v_cmp_ne_u32 vcc, 0, v44
v_mfma_f32_16x16x32_bf16 v[232:235], v[240:243], v[160:163], v[232:235]
v_mfma_f32_16x16x32_bf16 v[236:239], v[240:243], v[164:167], v[236:239]
s_cbranch_vccnz L_rare_9
L_rare_9_ret:
v_add_u32 v20, s100, v20
v_add_u32 v21, s100, v21
v_add_u32 v22, s100, v22
v_add_u32 v23, s100, v23
s_waitcnt lgkmcnt(4)
v_mfma_f32_16x16x32_bf16 a[0:3], v[188:191], v[128:131], a[0:3]
ds_read_b64_tr_b16 v[204:205], v24 offset:0
v_exp_f32 v36, v88
v_mfma_f32_16x16x32_bf16 a[4:7], v[188:191], v[132:135], a[4:7]
ds_read_b64_tr_b16 v[206:207], v24 offset:4096
v_exp_f32 v37, v89
v_mfma_f32_16x16x32_bf16 a[8:11], v[188:191], v[136:139], a[8:11]
v_exp_f32 v38, v90
v_exp_f32 v39, v91
v_mfma_f32_16x16x32_bf16 a[12:15], v[188:191], v[140:143], a[12:15]
v_cvt_pk_bf16_f32 v148, v36, v37
v_cvt_pk_bf16_f32 v149, v38, v39
v_exp_f32 v40, v108
v_mfma_f32_16x16x32_bf16 a[16:19], v[188:191], v[144:147], a[16:19]
v_exp_f32 v41, v109
v_exp_f32 v42, v110
v_mfma_f32_16x16x32_bf16 a[20:23], v[192:195], v[128:131], a[20:23]
ds_read_b64_tr_b16 v[208:209], v25 offset:0
v_exp_f32 v43, v111
v_mfma_f32_16x16x32_bf16 a[24:27], v[192:195], v[132:135], a[24:27]
ds_read_b64_tr_b16 v[210:211], v25 offset:4096
v_cvt_pk_bf16_f32 v150, v40, v41
v_cvt_pk_bf16_f32 v151, v42, v43
v_mfma_f32_16x16x32_bf16 a[28:31], v[192:195], v[136:139], a[28:31]
v_or_b32 v44, v148, v149
v_or3_b32 v44, v44, v150, v151
v_exp_f32 v36, v92
v_mfma_f32_16x16x32_bf16 a[32:35], v[192:195], v[140:143], a[32:35]
v_exp_f32 v37, v93
v_exp_f32 v38, v94
v_mfma_f32_16x16x32_bf16 a[36:39], v[192:195], v[144:147], a[36:39]
v_exp_f32 v39, v95
v_cvt_pk_bf16_f32 v152, v36, v37
v_cvt_pk_bf16_f32 v153, v38, v39
s_waitcnt lgkmcnt(4)
v_mfma_f32_16x16x32_bf16 a[40:43], v[196:199], v[128:131], a[40:43]
ds_read_b64_tr_b16 v[212:213], v26 offset:0
s_cmp_gt_i32 s91, 0
s_cselect_b32 s92, s88, 0x7f000000
s_sub_u32 s91, s91, 1
s_add_u32 s88, s88, s89
s_and_b32 s88, s88, s90
s_add_u32 m0, s93, 8192
v_mfma_f32_16x16x32_bf16 a[44:47], v[196:199], v[132:135], a[44:47]
ds_read_b64_tr_b16 v[214:215], v26 offset:4096
buffer_load_dwordx4 v244, s[16:19], s92 offen offset:0 lds
v_mfma_f32_16x16x32_bf16 a[48:51], v[196:199], v[136:139], a[48:51]
v_exp_f32 v40, v112
v_exp_f32 v41, v113
v_mfma_f32_16x16x32_bf16 a[52:55], v[196:199], v[140:143], a[52:55]
v_exp_f32 v42, v114
v_exp_f32 v43, v115
v_cvt_pk_bf16_f32 v154, v40, v41
v_mfma_f32_16x16x32_bf16 a[56:59], v[196:199], v[144:147], a[56:59]
buffer_load_dwordx4 v245, s[16:19], s92 offen offset:1024 lds
v_mfma_f32_16x16x32_bf16 a[60:63], v[200:203], v[128:131], a[60:63]
ds_read_b64_tr_b16 v[216:217], v27 offset:0
v_cvt_pk_bf16_f32 v155, v42, v43
v_or3_b32 v44, v44, v152, v153
v_mfma_f32_16x16x32_bf16 a[64:67], v[200:203], v[132:135], a[64:67]
ds_read_b64_tr_b16 v[218:219], v27 offset:4096
v_or3_b32 v44, v44, v154, v155
v_mfma_f32_16x16x32_bf16 a[68:71], v[200:203], v[136:139], a[68:71]
buffer_load_dwordx4 v246, s[16:19], s92 offen offset:2048 lds
v_mfma_f32_16x16x32_bf16 a[72:75], v[200:203], v[140:143], a[72:75]
v_exp_f32 v36, v96
v_exp_f32 v37, v97
v_mfma_f32_16x16x32_bf16 a[76:79], v[200:203], v[144:147], a[76:79]
v_exp_f32 v38, v98
v_exp_f32 v39, v99
v_cvt_pk_bf16_f32 v156, v36, v37
s_waitcnt vmcnt(11)
s_waitcnt lgkmcnt(4)
v_mfma_f32_16x16x32_bf16 a[80:83], v[204:207], v[128:131], a[80:83]
ds_read_b64_tr_b16 v[188:189], v20 offset:8192
buffer_load_dwordx4 v247, s[16:19], s92 offen offset:3072 lds
v_mfma_f32_16x16x32_bf16 a[84:87], v[204:207], v[132:135], a[84:87]
ds_read_b64_tr_b16 v[190:191], v20 offset:12288
v_cvt_pk_bf16_f32 v157, v38, v39
v_mfma_f32_16x16x32_bf16 a[88:91], v[204:207], v[136:139], a[88:91]
s_add_u32 m0, s93, 12288
v_exp_f32 v40, v116
v_exp_f32 v41, v117
v_mfma_f32_16x16x32_bf16 a[92:95], v[204:207], v[140:143], a[92:95]
buffer_load_dwordx4 v248, s[16:19], s92 offen offset:0 lds
v_mfma_f32_16x16x32_bf16 a[96:99], v[204:207], v[144:147], a[96:99]
v_exp_f32 v42, v118
v_exp_f32 v43, v119
v_mfma_f32_16x16x32_bf16 a[100:103], v[208:211], v[128:131], a[100:103]
ds_read_b64_tr_b16 v[192:193], v21 offset:8192
v_cvt_pk_bf16_f32 v158, v40, v41
v_mfma_f32_16x16x32_bf16 a[104:107], v[208:211], v[132:135], a[104:107]
ds_read_b64_tr_b16 v[194:195], v21 offset:12288
buffer_load_dwordx4 v249, s[16:19], s92 offen offset:1024 lds
v_mfma_f32_16x16x32_bf16 a[108:111], v[208:211], v[136:139], a[108:111]
v_cvt_pk_bf16_f32 v159, v42, v43
v_or3_b32 v44, v44, v156, v157
v_or3_b32 v44, v44, v158, v159
v_exp_f32 v36, v100
v_mfma_f32_16x16x32_bf16 a[112:115], v[208:211], v[140:143], a[112:115]
v_exp_f32 v37, v101
v_exp_f32 v38, v102
v_mfma_f32_16x16x32_bf16 a[116:119], v[208:211], v[144:147], a[116:119]
buffer_load_dwordx4 v250, s[16:19], s92 offen offset:2048 lds
s_waitcnt lgkmcnt(4)
v_mfma_f32_16x16x32_bf16 a[120:123], v[212:215], v[128:131], a[120:123]
ds_read_b64_tr_b16 v[196:197], v22 offset:8192
v_exp_f32 v39, v103
v_mfma_f32_16x16x32_bf16 a[124:127], v[212:215], v[132:135], a[124:127]
ds_read_b64_tr_b16 v[198:199], v22 offset:12288
v_cvt_pk_bf16_f32 v160, v36, v37
v_mfma_f32_16x16x32_bf16 a[128:131], v[212:215], v[136:139], a[128:131]
buffer_load_dwordx4 v251, s[16:19], s92 offen offset:3072 lds
v_mfma_f32_16x16x32_bf16 a[132:135], v[212:215], v[140:143], a[132:135]
v_cvt_pk_bf16_f32 v161, v38, v39
v_exp_f32 v40, v120
v_exp_f32 v41, v121
v_mfma_f32_16x16x32_bf16 a[136:139], v[212:215], v[144:147], a[136:139]
v_exp_f32 v42, v122
v_exp_f32 v43, v123
v_mfma_f32_16x16x32_bf16 a[140:143], v[216:219], v[128:131], a[140:143]
ds_read_b64_tr_b16 v[200:201], v23 offset:8192
v_cvt_pk_bf16_f32 v162, v40, v41
v_cvt_pk_bf16_f32 v163, v42, v43
v_mfma_f32_16x16x32_bf16 a[144:147], v[216:219], v[132:135], a[144:147]
ds_read_b64_tr_b16 v[202:203], v23 offset:12288
v_or3_b32 v44, v44, v160, v161
v_or3_b32 v44, v44, v162, v163
v_mfma_f32_16x16x32_bf16 a[148:151], v[216:219], v[136:139], a[148:151]
v_exp_f32 v36, v104
v_exp_f32 v37, v105
v_mfma_f32_16x16x32_bf16 a[152:155], v[216:219], v[140:143], a[152:155]
v_exp_f32 v38, v106
v_exp_f32 v39, v107
v_mfma_f32_16x16x32_bf16 a[156:159], v[216:219], v[144:147], a[156:159]
v_cvt_pk_bf16_f32 v164, v36, v37
v_cvt_pk_bf16_f32 v165, v38, v39
v_exp_f32 v40, v124
v_mfma_f32_16x16x32_bf16 v[220:223], v[240:243], v[128:131], v[220:223]
v_exp_f32 v41, v125
v_exp_f32 v42, v126
v_mfma_f32_16x16x32_bf16 v[224:227], v[240:243], v[132:135], v[224:227]
v_exp_f32 v43, v127
v_cvt_pk_bf16_f32 v166, v40, v41
v_cvt_pk_bf16_f32 v167, v42, v43
v_mfma_f32_16x16x32_bf16 v[228:231], v[240:243], v[136:139], v[228:231]
v_or3_b32 v44, v44, v164, v165
v_or3_b32 v44, v44, v166, v167
v_and_b32 v44, 0x40004000, v44
v_cmp_ne_u32 vcc, 0, v44
v_mfma_f32_16x16x32_bf16 v[232:235], v[240:243], v[140:143], v[232:235]
v_mfma_f32_16x16x32_bf16 v[236:239], v[240:243], v[144:147], v[236:239]
s_cbranch_vccnz L_rare_10
L_rare_10_ret:
v_add_u32 v24, s100, v24
v_add_u32 v25, s100, v25
v_add_u32 v26, s100, v26
v_add_u32 v27, s100, v27
s_waitcnt lgkmcnt(4)
v_mfma_f32_16x16x32_bf16 a[0:3], v[188:191], v[148:151], a[0:3]
ds_read_b64_tr_b16 v[204:205], v24 offset:8192
v_add_u32 v5, 0, v2
v_xor_b32 v5, v5, v3
v_mfma_f32_16x16x32_bf16 a[4:7], v[188:191], v[152:155], a[4:7]
ds_read_b64_tr_b16 v[206:207], v24 offset:12288
v_lshlrev_b32 v5, 4, v5
v_lshl_add_u32 v16, v3, 8, v5
v_mfma_f32_16x16x32_bf16 a[8:11], v[188:191], v[156:159], a[8:11]
v_add_u32 v16, 81920, v16
v_add_u32 v5, 4, v2
v_mfma_f32_16x16x32_bf16 a[12:15], v[188:191], v[160:163], a[12:15]
v_xor_b32 v5, v5, v3
v_lshlrev_b32 v5, 4, v5
v_mfma_f32_16x16x32_bf16 a[16:19], v[188:191], v[164:167], a[16:19]
v_lshl_add_u32 v17, v3, 8, v5
v_add_u32 v17, 81920, v17
v_mfma_f32_16x16x32_bf16 a[20:23], v[192:195], v[148:151], a[20:23]
ds_read_b64_tr_b16 v[208:209], v25 offset:8192
v_add_u32 v5, 8, v2
v_xor_b32 v5, v5, v3
v_mfma_f32_16x16x32_bf16 a[24:27], v[192:195], v[152:155], a[24:27]
ds_read_b64_tr_b16 v[210:211], v25 offset:12288
v_lshlrev_b32 v5, 4, v5
v_lshl_add_u32 v18, v3, 8, v5
v_mfma_f32_16x16x32_bf16 a[28:31], v[192:195], v[156:159], a[28:31]
v_add_u32 v18, 81920, v18
v_add_u32 v5, 12, v2
v_mfma_f32_16x16x32_bf16 a[32:35], v[192:195], v[160:163], a[32:35]
v_xor_b32 v5, v5, v3
v_lshlrev_b32 v5, 4, v5
v_mfma_f32_16x16x32_bf16 a[36:39], v[192:195], v[164:167], a[36:39]
v_lshl_add_u32 v19, v3, 8, v5
v_add_u32 v19, 81920, v19
s_waitcnt lgkmcnt(4)
v_mfma_f32_16x16x32_bf16 a[40:43], v[196:199], v[148:151], a[40:43]
ds_read_b64_tr_b16 v[212:213], v26 offset:8192
s_and_b32 s56, s4, 3
s_sub_u32 s54, s3, s56
v_mfma_f32_16x16x32_bf16 a[44:47], v[196:199], v[152:155], a[44:47]
ds_read_b64_tr_b16 v[214:215], v26 offset:12288
s_and_b32 s54, s54, 3
s_mul_i32 s54, s54, 20480
v_mfma_f32_16x16x32_bf16 a[48:51], v[196:199], v[156:159], a[48:51]
v_add_u32 v28, s54, v16
v_add_u32 v29, s54, v17
v_mfma_f32_16x16x32_bf16 a[52:55], v[196:199], v[160:163], a[52:55]
v_add_u32 v30, s54, v18
v_add_u32 v31, s54, v19
v_mfma_f32_16x16x32_bf16 a[56:59], v[196:199], v[164:167], a[56:59]
v_mfma_f32_16x16x32_bf16 a[60:63], v[200:203], v[148:151], a[60:63]
ds_read_b64_tr_b16 v[216:217], v27 offset:8192
v_mfma_f32_16x16x32_bf16 a[64:67], v[200:203], v[152:155], a[64:67]
ds_read_b64_tr_b16 v[218:219], v27 offset:12288
v_mfma_f32_16x16x32_bf16 a[68:71], v[200:203], v[156:159], a[68:71]
v_mfma_f32_16x16x32_bf16 a[72:75], v[200:203], v[160:163], a[72:75]
v_mfma_f32_16x16x32_bf16 a[76:79], v[200:203], v[164:167], a[76:79]
s_waitcnt lgkmcnt(4)
v_mfma_f32_16x16x32_bf16 a[80:83], v[204:207], v[148:151], a[80:83]
v_lshrrev_b32 v5, 2, v1
v_bfe_u32 v6, v1, 3, 2
v_mfma_f32_16x16x32_bf16 a[84:87], v[204:207], v[152:155], a[84:87]
v_and_b32 v7, 3, v1
v_lshlrev_b32 v7, 4, v7
v_mfma_f32_16x16x32_bf16 a[88:91], v[204:207], v[156:159], a[88:91]
v_lshl_add_u32 v7, v5, 8, v7
v_add_u32 v7, s93, v7
v_mfma_f32_16x16x32_bf16 a[92:95], v[204:207], v[160:163], a[92:95]
v_xor_b32 v8, 0, v6
v_lshl_add_u32 v20, v8, 6, v7
v_mfma_f32_16x16x32_bf16 a[96:99], v[204:207], v[164:167], a[96:99]
v_xor_b32 v8, 0, v6
v_lshl_add_u32 v21, v8, 6, v7
v_mfma_f32_16x16x32_bf16 a[100:103], v[208:211], v[148:151], a[100:103]
v_add_u32 v21, 8, v21
v_xor_b32 v8, 1, v6
v_mfma_f32_16x16x32_bf16 a[104:107], v[208:211], v[152:155], a[104:107]
v_lshl_add_u32 v22, v8, 6, v7
v_xor_b32 v8, 1, v6
v_mfma_f32_16x16x32_bf16 a[108:111], v[208:211], v[156:159], a[108:111]
v_lshl_add_u32 v23, v8, 6, v7
v_add_u32 v23, 8, v23
v_mfma_f32_16x16x32_bf16 a[112:115], v[208:211], v[160:163], a[112:115]
v_xor_b32 v8, 2, v6
v_lshl_add_u32 v24, v8, 6, v7
v_mfma_f32_16x16x32_bf16 a[116:119], v[208:211], v[164:167], a[116:119]
v_xor_b32 v8, 2, v6
v_lshl_add_u32 v25, v8, 6, v7
s_waitcnt lgkmcnt(0)
v_mfma_f32_16x16x32_bf16 a[120:123], v[212:215], v[148:151], a[120:123]
v_add_u32 v25, 8, v25
v_xor_b32 v8, 3, v6
v_mfma_f32_16x16x32_bf16 a[124:127], v[212:215], v[152:155], a[124:127]
v_lshl_add_u32 v26, v8, 6, v7
v_xor_b32 v8, 3, v6
v_mfma_f32_16x16x32_bf16 a[128:131], v[212:215], v[156:159], a[128:131]
v_lshl_add_u32 v27, v8, 6, v7
v_add_u32 v27, 8, v27
v_mfma_f32_16x16x32_bf16 a[132:135], v[212:215], v[160:163], a[132:135]
v_mfma_f32_16x16x32_bf16 a[136:139], v[212:215], v[164:167], a[136:139]
v_mfma_f32_16x16x32_bf16 a[140:143], v[216:219], v[148:151], a[140:143]
v_mfma_f32_16x16x32_bf16 a[144:147], v[216:219], v[152:155], a[144:147]
v_mfma_f32_16x16x32_bf16 a[148:151], v[216:219], v[156:159], a[148:151]
v_mfma_f32_16x16x32_bf16 a[152:155], v[216:219], v[160:163], a[152:155]
v_mfma_f32_16x16x32_bf16 a[156:159], v[216:219], v[164:167], a[156:159]
v_mfma_f32_16x16x32_bf16 v[220:223], v[240:243], v[148:151], v[220:223]
v_mfma_f32_16x16x32_bf16 v[224:227], v[240:243], v[152:155], v[224:227]
v_mfma_f32_16x16x32_bf16 v[228:231], v[240:243], v[156:159], v[228:231]
v_mfma_f32_16x16x32_bf16 v[232:235], v[240:243], v[160:163], v[232:235]
v_mfma_f32_16x16x32_bf16 v[236:239], v[240:243], v[164:167], v[236:239]
s_cmp_eq_u32 s3, 0
s_cbranch_scc0 L_np12
s_lshl_b32 s54, s6, 4
s_add_u32 s54, s54, s4
s_mul_i32 s54, s54, 4352
s_lshl_b32 s55, s5, 2
s_add_u32 s54, s54, s55
s_add_u32 s54, s54, 0x1000800
s_add_u32 s55, s33, 4
v_mov_b32 v5, s55
v_mov_b32 v6, s54
s_mov_b64 exec, 1
global_store_dword v6, v5, s[52:53] sc1
s_mov_b64 exec, -1
L_np12:
s_branch L_tail
L_roleA:
s_lshl_b32 s54, s4, 3
s_add_u32 s54, s54, s5
s_lshl_b32 s54, s54, 18
s_add_u32 s8, s38, s54
s_addc_u32 s9, s39, 0
s_mov_b32 s10, 0x40000
s_mov_b32 s11, 0x20000
s_add_u32 s12, s40, s54
s_addc_u32 s13, s41, 0
s_mov_b32 s14, 0x40000
s_mov_b32 s15, 0x20000
s_lshl_b32 s54, s3, 3
v_add_u32 v6, s54, v2
v_add_u32 v5, 0, v6
v_and_b32 v7, 15, v5
v_xor_b32 v7, v7, v3
v_lshlrev_b32 v7, 4, v7
v_lshl_add_u32 v28, v6, 8, v7
v_and_b32 v7, 7, v5
v_lshlrev_b32 v7, 1, v7
v_xor_b32 v7, v7, v3
v_lshlrev_b32 v7, 4, v7
v_lshl_add_u32 v32, v6, 8, v7
v_add_u32 v5, 4, v6
v_and_b32 v7, 15, v5
v_xor_b32 v7, v7, v3
v_lshlrev_b32 v7, 4, v7
v_lshl_add_u32 v29, v6, 8, v7
v_and_b32 v7, 7, v5
v_lshlrev_b32 v7, 1, v7
v_xor_b32 v7, v7, v3
v_lshlrev_b32 v7, 4, v7
v_lshl_add_u32 v33, v6, 8, v7
s_lshl_b32 s97, s3, 11
s_add_u32 s97, s97, 65536
s_mov_b32 s95, 0
s_mov_b32 s96, s95
s_waitcnt vmcnt(8)
s_barrier
v_mfma_f32_16x16x32_bf16 v[48:51], a[152:155], a[216:219], v[48:51]
ds_read_b64_tr_b16 a[184:185], v20 offset:8192
v_mfma_f32_16x16x32_bf16 v[52:55], a[152:155], a[220:223], v[52:55]
ds_read_b64_tr_b16 a[186:187], v20 offset:12288
v_mfma_f32_16x16x32_bf16 v[56:59], a[152:155], a[224:227], v[56:59]
ds_read_b64_tr_b16 a[188:189], v21 offset:8192
v_mfma_f32_16x16x32_bf16 v[60:63], a[152:155], a[228:231], v[60:63]
ds_read_b64_tr_b16 a[190:191], v21 offset:12288
v_mfma_f32_16x16x32_bf16 v[64:67], a[152:155], a[232:235], v[64:67]
ds_read_b64_tr_b16 a[192:193], v22 offset:8192
v_mfma_f32_16x16x32_bf16 v[68:71], a[156:159], a[216:219], v[68:71]
ds_read_b64_tr_b16 a[194:195], v22 offset:12288
v_mfma_f32_16x16x32_bf16 v[72:75], a[156:159], a[220:223], v[72:75]
ds_read_b64_tr_b16 a[196:197], v23 offset:8192
v_mfma_f32_16x16x32_bf16 v[76:79], a[156:159], a[224:227], v[76:79]
ds_read_b64_tr_b16 a[198:199], v23 offset:12288
v_mfma_f32_16x16x32_bf16 v[80:83], a[156:159], a[228:231], v[80:83]
ds_read_b64_tr_b16 a[200:201], v24 offset:8192
v_mfma_f32_16x16x32_bf16 v[84:87], a[156:159], a[232:235], v[84:87]
ds_read_b64_tr_b16 a[202:203], v24 offset:12288
v_mfma_f32_16x16x32_bf16 v[88:91], a[160:163], a[216:219], v[88:91]
ds_read_b64_tr_b16 a[204:205], v25 offset:8192
v_mfma_f32_16x16x32_bf16 v[92:95], a[160:163], a[220:223], v[92:95]
ds_read_b64_tr_b16 a[206:207], v25 offset:12288
v_mfma_f32_16x16x32_bf16 v[96:99], a[160:163], a[224:227], v[96:99]
ds_read_b64_tr_b16 a[208:209], v26 offset:8192
v_mfma_f32_16x16x32_bf16 v[100:103], a[160:163], a[228:231], v[100:103]
ds_read_b64_tr_b16 a[210:211], v26 offset:12288
v_mfma_f32_16x16x32_bf16 v[104:107], a[160:163], a[232:235], v[104:107]
ds_read_b64_tr_b16 a[212:213], v27 offset:8192
v_mfma_f32_16x16x32_bf16 v[108:111], a[164:167], a[216:219], v[108:111]
ds_read_b64_tr_b16 a[214:215], v27 offset:12288
v_mfma_f32_16x16x32_bf16 v[112:115], a[164:167], a[220:223], v[112:115]
ds_read_b128 a[236:239], v17 offset:0
v_mfma_f32_16x16x32_bf16 v[116:119], a[164:167], a[224:227], v[116:119]
ds_read_b128 a[240:243], v17 offset:4096
v_mfma_f32_16x16x32_bf16 v[120:123], a[164:167], a[228:231], v[120:123]
ds_read_b128 a[244:247], v17 offset:8192
v_mfma_f32_16x16x32_bf16 v[124:127], a[164:167], a[232:235], v[124:127]
ds_read_b128 a[248:251], v17 offset:12288
v_mfma_f32_16x16x32_bf16 v[128:131], a[168:171], a[216:219], v[128:131]
ds_read_b128 a[252:255], v17 offset:16384
v_mfma_f32_16x16x32_bf16 v[132:135], a[168:171], a[220:223], v[132:135]
s_cmp_gt_i32 s91, 0
s_cselect_b32 s92, s88, 0x7f000000
v_mfma_f32_16x16x32_bf16 v[136:139], a[168:171], a[224:227], v[136:139]
s_sub_u32 s91, s91, 1
s_add_u32 s88, s88, s89
v_mfma_f32_16x16x32_bf16 v[140:143], a[168:171], a[228:231], v[140:143]
s_and_b32 s88, s88, s90
s_add_u32 m0, s93, 8192
v_mfma_f32_16x16x32_bf16 v[144:147], a[168:171], a[232:235], v[144:147]
s_waitcnt lgkmcnt(5)
buffer_load_dwordx4 v244, s[16:19], s92 offen offset:0 lds
v_mfma_f32_16x16x32_bf16 v[148:151], a[172:175], a[216:219], v[148:151]
v_mfma_f32_16x16x32_bf16 v[152:155], a[172:175], a[220:223], v[152:155]
buffer_load_dwordx4 v245, s[16:19], s92 offen offset:1024 lds
v_mfma_f32_16x16x32_bf16 v[156:159], a[172:175], a[224:227], v[156:159]
v_mfma_f32_16x16x32_bf16 v[160:163], a[172:175], a[228:231], v[160:163]
buffer_load_dwordx4 v246, s[16:19], s92 offen offset:2048 lds
v_mfma_f32_16x16x32_bf16 v[164:167], a[172:175], a[232:235], v[164:167]
v_mfma_f32_16x16x32_bf16 v[168:171], a[176:179], a[216:219], v[168:171]
buffer_load_dwordx4 v247, s[16:19], s92 offen offset:3072 lds
v_mfma_f32_16x16x32_bf16 v[172:175], a[176:179], a[220:223], v[172:175]
s_add_u32 m0, s93, 12288
v_mfma_f32_16x16x32_bf16 v[176:179], a[176:179], a[224:227], v[176:179]
buffer_load_dwordx4 v248, s[16:19], s92 offen offset:0 lds
v_mfma_f32_16x16x32_bf16 v[180:183], a[176:179], a[228:231], v[180:183]
v_mfma_f32_16x16x32_bf16 v[184:187], a[176:179], a[232:235], v[184:187]
buffer_load_dwordx4 v249, s[16:19], s92 offen offset:1024 lds
v_mfma_f32_16x16x32_bf16 v[188:191], a[180:183], a[216:219], v[188:191]
v_mfma_f32_16x16x32_bf16 v[192:195], a[180:183], a[220:223], v[192:195]
buffer_load_dwordx4 v250, s[16:19], s92 offen offset:2048 lds
v_mfma_f32_16x16x32_bf16 v[196:199], a[180:183], a[224:227], v[196:199]
v_mfma_f32_16x16x32_bf16 v[200:203], a[180:183], a[228:231], v[200:203]
v_mfma_f32_16x16x32_bf16 v[204:207], a[180:183], a[232:235], v[204:207]
s_waitcnt lgkmcnt(0)
buffer_load_dwordx4 v251, s[16:19], s92 offen offset:3072 lds
s_waitcnt vmcnt(8)
v_mfma_f32_16x16x32_bf16 v[48:51], a[184:187], a[236:239], v[48:51]
ds_read_b64_tr_b16 a[152:153], v20 offset:0
s_lshl_b32 s54, s5, 19
s_lshl_b32 s55, s3, 8
v_mfma_f32_16x16x32_bf16 v[52:55], a[184:187], a[240:243], v[52:55]
ds_read_b64_tr_b16 a[154:155], v20 offset:4096
s_add_u32 s54, s54, s55
s_sub_u32 s55, 0x80000, s55
v_mfma_f32_16x16x32_bf16 v[56:59], a[184:187], a[244:247], v[56:59]
ds_read_b64_tr_b16 a[156:157], v21 offset:0
s_add_u32 s16, s44, s54
s_addc_u32 s17, s45, 0
s_mov_b32 s18, s55
v_mfma_f32_16x16x32_bf16 v[60:63], a[184:187], a[248:251], v[60:63]
ds_read_b64_tr_b16 a[158:159], v21 offset:4096
v_lshrrev_b32 v6, 1, v2
v_lshlrev_b32 v7, 10, v2
v_mfma_f32_16x16x32_bf16 v[64:67], a[184:187], a[252:255], v[64:67]
ds_read_b64_tr_b16 a[160:161], v22 offset:0
v_add_u32 v5, 0, v6
v_lshlrev_b32 v5, 2, v5
v_mfma_f32_16x16x32_bf16 v[68:71], a[188:191], a[236:239], v[68:71]
ds_read_b64_tr_b16 a[162:163], v22 offset:4096
v_xor_b32 v5, v5, v3
v_lshl_add_u32 v244, v5, 4, v7
v_mfma_f32_16x16x32_bf16 v[72:75], a[188:191], a[240:243], v[72:75]
ds_read_b64_tr_b16 a[164:165], v23 offset:0
v_add_u32 v5, 2, v6
v_lshlrev_b32 v5, 2, v5
v_mfma_f32_16x16x32_bf16 v[76:79], a[188:191], a[244:247], v[76:79]
ds_read_b64_tr_b16 a[166:167], v23 offset:4096
v_xor_b32 v5, v5, v3
v_lshl_add_u32 v245, v5, 4, v7
v_mfma_f32_16x16x32_bf16 v[80:83], a[188:191], a[248:251], v[80:83]
ds_read_b64_tr_b16 a[168:169], v24 offset:0
v_add_u32 v245, 3072, v245
v_add_u32 v5, 0, v6
v_mfma_f32_16x16x32_bf16 v[84:87], a[188:191], a[252:255], v[84:87]
ds_read_b64_tr_b16 a[170:171], v24 offset:4096
v_lshlrev_b32 v5, 2, v5
v_xor_b32 v5, v5, v3
v_mfma_f32_16x16x32_bf16 v[88:91], a[192:195], a[236:239], v[88:91]
ds_read_b64_tr_b16 a[172:173], v25 offset:0
v_lshl_add_u32 v246, v5, 4, v7
v_add_u32 v246, 6144, v246
v_mfma_f32_16x16x32_bf16 v[92:95], a[192:195], a[240:243], v[92:95]
ds_read_b64_tr_b16 a[174:175], v25 offset:4096
v_add_u32 v5, 2, v6
v_lshlrev_b32 v5, 2, v5
v_mfma_f32_16x16x32_bf16 v[96:99], a[192:195], a[244:247], v[96:99]
ds_read_b64_tr_b16 a[176:177], v26 offset:0
v_xor_b32 v5, v5, v3
v_lshl_add_u32 v247, v5, 4, v7
v_mfma_f32_16x16x32_bf16 v[100:103], a[192:195], a[248:251], v[100:103]
ds_read_b64_tr_b16 a[178:179], v26 offset:4096
v_add_u32 v247, 9216, v247
v_add_u32 v5, 0, v6
v_mfma_f32_16x16x32_bf16 v[104:107], a[192:195], a[252:255], v[104:107]
ds_read_b64_tr_b16 a[180:181], v27 offset:0
v_lshlrev_b32 v5, 2, v5
v_xor_b32 v5, v5, v3
v_mfma_f32_16x16x32_bf16 v[108:111], a[196:199], a[236:239], v[108:111]
ds_read_b64_tr_b16 a[182:183], v27 offset:4096
v_lshl_add_u32 v248, v5, 4, v7
v_add_u32 v248, 16384, v248
v_mfma_f32_16x16x32_bf16 v[112:115], a[196:199], a[240:243], v[112:115]
ds_read_b128 a[216:219], v18 offset:0
v_add_u32 v5, 2, v6
v_lshlrev_b32 v5, 2, v5
v_mfma_f32_16x16x32_bf16 v[116:119], a[196:199], a[244:247], v[116:119]
ds_read_b128 a[220:223], v18 offset:4096
v_xor_b32 v5, v5, v3
v_lshl_add_u32 v249, v5, 4, v7
v_mfma_f32_16x16x32_bf16 v[120:123], a[196:199], a[248:251], v[120:123]
ds_read_b128 a[224:227], v18 offset:8192
v_add_u32 v249, 19456, v249
v_add_u32 v5, 0, v6
v_mfma_f32_16x16x32_bf16 v[124:127], a[196:199], a[252:255], v[124:127]
ds_read_b128 a[228:231], v18 offset:12288
v_lshlrev_b32 v5, 2, v5
v_xor_b32 v5, v5, v3
v_mfma_f32_16x16x32_bf16 v[128:131], a[200:203], a[236:239], v[128:131]
ds_read_b128 a[232:235], v18 offset:16384
v_lshl_add_u32 v250, v5, 4, v7
v_add_u32 v250, 22528, v250
v_mfma_f32_16x16x32_bf16 v[132:135], a[200:203], a[240:243], v[132:135]
v_add_u32 v5, 2, v6
v_lshlrev_b32 v5, 2, v5
v_mfma_f32_16x16x32_bf16 v[136:139], a[200:203], a[244:247], v[136:139]
v_xor_b32 v5, v5, v3
v_lshl_add_u32 v251, v5, 4, v7
v_mfma_f32_16x16x32_bf16 v[140:143], a[200:203], a[248:251], v[140:143]
v_add_u32 v251, 25600, v251
s_and_b32 s56, s4, 3
v_mfma_f32_16x16x32_bf16 v[144:147], a[200:203], a[252:255], v[144:147]
s_waitcnt lgkmcnt(5)
s_lshl_b32 s88, s56, 17
s_mov_b32 s89, 0x8000
v_mfma_f32_16x16x32_bf16 v[148:151], a[204:207], a[236:239], v[148:151]
s_add_u32 m0, s97, 0
s_mov_b32 s90, 0x7ffff
s_mov_b32 s91, 16
v_mfma_f32_16x16x32_bf16 v[152:155], a[204:207], a[240:243], v[152:155]
buffer_load_dwordx4 v28, s[8:11], s95 offen nt lds
v_mfma_f32_16x16x32_bf16 v[156:159], a[204:207], a[244:247], v[156:159]
v_mfma_f32_16x16x32_bf16 v[160:163], a[204:207], a[248:251], v[160:163]
v_mfma_f32_16x16x32_bf16 v[164:167], a[204:207], a[252:255], v[164:167]
buffer_load_dwordx4 v29, s[8:11], s95 offen offset:1024 nt lds
v_mfma_f32_16x16x32_bf16 v[168:171], a[208:211], a[236:239], v[168:171]
v_mfma_f32_16x16x32_bf16 v[172:175], a[208:211], a[240:243], v[172:175]
s_add_u32 s95, s95, 8192
s_add_u32 m0, s97, 8192
v_mfma_f32_16x16x32_bf16 v[176:179], a[208:211], a[244:247], v[176:179]
buffer_load_dwordx4 v28, s[8:11], s95 offen nt lds
v_mfma_f32_16x16x32_bf16 v[180:183], a[208:211], a[248:251], v[180:183]
v_mfma_f32_16x16x32_bf16 v[184:187], a[208:211], a[252:255], v[184:187]
v_mfma_f32_16x16x32_bf16 v[188:191], a[212:215], a[236:239], v[188:191]
buffer_load_dwordx4 v29, s[8:11], s95 offen offset:1024 nt lds
v_mfma_f32_16x16x32_bf16 v[192:195], a[212:215], a[240:243], v[192:195]
v_mfma_f32_16x16x32_bf16 v[196:199], a[212:215], a[244:247], v[196:199]
s_add_u32 s95, s95, 8192
v_mfma_f32_16x16x32_bf16 v[200:203], a[212:215], a[248:251], v[200:203]
v_mfma_f32_16x16x32_bf16 v[204:207], a[212:215], a[252:255], v[204:207]
s_waitcnt lgkmcnt(0)
s_waitcnt vmcnt(4)
v_mfma_f32_16x16x32_bf16 v[48:51], a[152:155], a[216:219], v[48:51]
ds_read_b64_tr_b16 a[184:185], v20 offset:8192
v_mfma_f32_16x16x32_bf16 v[52:55], a[152:155], a[220:223], v[52:55]
ds_read_b64_tr_b16 a[186:187], v20 offset:12288
v_mfma_f32_16x16x32_bf16 v[56:59], a[152:155], a[224:227], v[56:59]
ds_read_b64_tr_b16 a[188:189], v21 offset:8192
v_mfma_f32_16x16x32_bf16 v[60:63], a[152:155], a[228:231], v[60:63]
ds_read_b64_tr_b16 a[190:191], v21 offset:12288
v_mfma_f32_16x16x32_bf16 v[64:67], a[152:155], a[232:235], v[64:67]
ds_read_b64_tr_b16 a[192:193], v22 offset:8192
v_mfma_f32_16x16x32_bf16 v[68:71], a[156:159], a[216:219], v[68:71]
ds_read_b64_tr_b16 a[194:195], v22 offset:12288
v_mfma_f32_16x16x32_bf16 v[72:75], a[156:159], a[220:223], v[72:75]
ds_read_b64_tr_b16 a[196:197], v23 offset:8192
v_mfma_f32_16x16x32_bf16 v[76:79], a[156:159], a[224:227], v[76:79]
ds_read_b64_tr_b16 a[198:199], v23 offset:12288
v_mfma_f32_16x16x32_bf16 v[80:83], a[156:159], a[228:231], v[80:83]
ds_read_b64_tr_b16 a[200:201], v24 offset:8192
v_mfma_f32_16x16x32_bf16 v[84:87], a[156:159], a[232:235], v[84:87]
ds_read_b64_tr_b16 a[202:203], v24 offset:12288
v_mfma_f32_16x16x32_bf16 v[88:91], a[160:163], a[216:219], v[88:91]
ds_read_b64_tr_b16 a[204:205], v25 offset:8192
v_mfma_f32_16x16x32_bf16 v[92:95], a[160:163], a[220:223], v[92:95]
ds_read_b64_tr_b16 a[206:207], v25 offset:12288
v_mfma_f32_16x16x32_bf16 v[96:99], a[160:163], a[224:227], v[96:99]
ds_read_b64_tr_b16 a[208:209], v26 offset:8192
v_mfma_f32_16x16x32_bf16 v[100:103], a[160:163], a[228:231], v[100:103]
ds_read_b64_tr_b16 a[210:211], v26 offset:12288
v_mfma_f32_16x16x32_bf16 v[104:107], a[160:163], a[232:235], v[104:107]
ds_read_b64_tr_b16 a[212:213], v27 offset:8192
v_mfma_f32_16x16x32_bf16 v[108:111], a[164:167], a[216:219], v[108:111]
ds_read_b64_tr_b16 a[214:215], v27 offset:12288
v_mfma_f32_16x16x32_bf16 v[112:115], a[164:167], a[220:223], v[112:115]
ds_read_b128 a[236:239], v19 offset:0
v_mfma_f32_16x16x32_bf16 v[116:119], a[164:167], a[224:227], v[116:119]
ds_read_b128 a[240:243], v19 offset:4096
v_mfma_f32_16x16x32_bf16 v[120:123], a[164:167], a[228:231], v[120:123]
ds_read_b128 a[244:247], v19 offset:8192
v_mfma_f32_16x16x32_bf16 v[124:127], a[164:167], a[232:235], v[124:127]
ds_read_b128 a[248:251], v19 offset:12288
v_mfma_f32_16x16x32_bf16 v[128:131], a[168:171], a[216:219], v[128:131]
ds_read_b128 a[252:255], v19 offset:16384
v_mfma_f32_16x16x32_bf16 v[132:135], a[168:171], a[220:223], v[132:135]
v_mfma_f32_16x16x32_bf16 v[136:139], a[168:171], a[224:227], v[136:139]
v_mfma_f32_16x16x32_bf16 v[140:143], a[168:171], a[228:231], v[140:143]
v_mfma_f32_16x16x32_bf16 v[144:147], a[168:171], a[232:235], v[144:147]
s_waitcnt lgkmcnt(5)
v_mfma_f32_16x16x32_bf16 v[148:151], a[172:175], a[216:219], v[148:151]
s_add_u32 m0, s97, 16384
v_mfma_f32_16x16x32_bf16 v[152:155], a[172:175], a[220:223], v[152:155]
buffer_load_dwordx4 v28, s[8:11], s95 offen nt lds
v_mfma_f32_16x16x32_bf16 v[156:159], a[172:175], a[224:227], v[156:159]
v_mfma_f32_16x16x32_bf16 v[160:163], a[172:175], a[228:231], v[160:163]
v_mfma_f32_16x16x32_bf16 v[164:167], a[172:175], a[232:235], v[164:167]
buffer_load_dwordx4 v29, s[8:11], s95 offen offset:1024 nt lds
v_mfma_f32_16x16x32_bf16 v[168:171], a[176:179], a[216:219], v[168:171]
v_mfma_f32_16x16x32_bf16 v[172:175], a[176:179], a[220:223], v[172:175]
s_add_u32 s95, s95, 8192
s_add_u32 m0, s97, 32768
v_mfma_f32_16x16x32_bf16 v[176:179], a[176:179], a[224:227], v[176:179]
buffer_load_dwordx4 v32, s[12:15], s96 offen nt lds
v_mfma_f32_16x16x32_bf16 v[180:183], a[176:179], a[228:231], v[180:183]
v_mfma_f32_16x16x32_bf16 v[184:187], a[176:179], a[232:235], v[184:187]
v_mfma_f32_16x16x32_bf16 v[188:191], a[180:183], a[216:219], v[188:191]
buffer_load_dwordx4 v33, s[12:15], s96 offen offset:1024 nt lds
v_mfma_f32_16x16x32_bf16 v[192:195], a[180:183], a[220:223], v[192:195]
v_mfma_f32_16x16x32_bf16 v[196:199], a[180:183], a[224:227], v[196:199]
s_add_u32 s96, s96, 8192
v_mfma_f32_16x16x32_bf16 v[200:203], a[180:183], a[228:231], v[200:203]
v_mfma_f32_16x16x32_bf16 v[204:207], a[180:183], a[232:235], v[204:207]
s_waitcnt lgkmcnt(0)
v_mfma_f32_16x16x32_bf16 v[48:51], a[184:187], a[236:239], v[48:51]
v_add_u32 v5, 0, v2
v_xor_b32 v5, v5, v3
v_mfma_f32_16x16x32_bf16 v[52:55], a[184:187], a[240:243], v[52:55]
v_lshlrev_b32 v5, 4, v5
v_lshl_add_u32 v16, v3, 8, v5
v_mfma_f32_16x16x32_bf16 v[56:59], a[184:187], a[244:247], v[56:59]
v_add_u32 v16, 65536, v16
v_add_u32 v5, 4, v2
v_mfma_f32_16x16x32_bf16 v[60:63], a[184:187], a[248:251], v[60:63]
v_xor_b32 v5, v5, v3
v_lshlrev_b32 v5, 4, v5
v_mfma_f32_16x16x32_bf16 v[64:67], a[184:187], a[252:255], v[64:67]
v_lshl_add_u32 v17, v3, 8, v5
v_add_u32 v17, 65536, v17
v_mfma_f32_16x16x32_bf16 v[68:71], a[188:191], a[236:239], v[68:71]
v_add_u32 v5, 8, v2
v_xor_b32 v5, v5, v3
v_mfma_f32_16x16x32_bf16 v[72:75], a[188:191], a[240:243], v[72:75]
v_lshlrev_b32 v5, 4, v5
v_lshl_add_u32 v18, v3, 8, v5
v_mfma_f32_16x16x32_bf16 v[76:79], a[188:191], a[244:247], v[76:79]
v_add_u32 v18, 65536, v18
v_add_u32 v5, 12, v2
v_mfma_f32_16x16x32_bf16 v[80:83], a[188:191], a[248:251], v[80:83]
v_xor_b32 v5, v5, v3
v_lshlrev_b32 v5, 4, v5
v_mfma_f32_16x16x32_bf16 v[84:87], a[188:191], a[252:255], v[84:87]
v_lshl_add_u32 v19, v3, 8, v5
v_add_u32 v19, 65536, v19
v_mfma_f32_16x16x32_bf16 v[88:91], a[192:195], a[236:239], v[88:91]
v_lshrrev_b32 v5, 2, v1
v_and_b32 v6, 7, v5
v_mfma_f32_16x16x32_bf16 v[92:95], a[192:195], a[240:243], v[92:95]
v_and_b32 v7, 3, v1
v_lshlrev_b32 v7, 3, v7
v_mfma_f32_16x16x32_bf16 v[96:99], a[192:195], a[244:247], v[96:99]
v_lshl_add_u32 v7, v5, 8, v7
v_add_u32 v7, 65536, v7
v_mfma_f32_16x16x32_bf16 v[100:103], a[192:195], a[248:251], v[100:103]
v_xor_b32 v8, 0, v6
v_lshl_add_u32 v20, v8, 5, v7
v_mfma_f32_16x16x32_bf16 v[104:107], a[192:195], a[252:255], v[104:107]
v_xor_b32 v8, 1, v6
v_lshl_add_u32 v21, v8, 5, v7
v_mfma_f32_16x16x32_bf16 v[108:111], a[196:199], a[236:239], v[108:111]
v_xor_b32 v8, 2, v6
v_lshl_add_u32 v22, v8, 5, v7
v_mfma_f32_16x16x32_bf16 v[112:115], a[196:199], a[240:243], v[112:115]
v_xor_b32 v8, 3, v6
v_lshl_add_u32 v23, v8, 5, v7
v_mfma_f32_16x16x32_bf16 v[116:119], a[196:199], a[244:247], v[116:119]
v_xor_b32 v8, 4, v6
v_lshl_add_u32 v24, v8, 5, v7
v_mfma_f32_16x16x32_bf16 v[120:123], a[196:199], a[248:251], v[120:123]
v_xor_b32 v8, 5, v6
v_lshl_add_u32 v25, v8, 5, v7
v_mfma_f32_16x16x32_bf16 v[124:127], a[196:199], a[252:255], v[124:127]
v_xor_b32 v8, 6, v6
v_lshl_add_u32 v26, v8, 5, v7
v_mfma_f32_16x16x32_bf16 v[128:131], a[200:203], a[236:239], v[128:131]
v_xor_b32 v8, 7, v6
v_lshl_add_u32 v27, v8, 5, v7
v_mfma_f32_16x16x32_bf16 v[132:135], a[200:203], a[240:243], v[132:135]
v_mov_b32 v240, 0x3f803f80
v_mov_b32 v241, 0x3f803f80
v_mfma_f32_16x16x32_bf16 v[136:139], a[200:203], a[244:247], v[136:139]
v_mov_b32 v242, 0x3f803f80
v_mov_b32 v243, 0x3f803f80
v_mfma_f32_16x16x32_bf16 v[140:143], a[200:203], a[248:251], v[140:143]
v_mfma_f32_16x16x32_bf16 v[144:147], a[200:203], a[252:255], v[144:147]
v_mfma_f32_16x16x32_bf16 v[148:151], a[204:207], a[236:239], v[148:151]
v_mfma_f32_16x16x32_bf16 v[152:155], a[204:207], a[240:243], v[152:155]
v_mfma_f32_16x16x32_bf16 v[156:159], a[204:207], a[244:247], v[156:159]
v_mfma_f32_16x16x32_bf16 v[160:163], a[204:207], a[248:251], v[160:163]
v_mfma_f32_16x16x32_bf16 v[164:167], a[204:207], a[252:255], v[164:167]
v_mfma_f32_16x16x32_bf16 v[168:171], a[208:211], a[236:239], v[168:171]
v_mfma_f32_16x16x32_bf16 v[172:175], a[208:211], a[240:243], v[172:175]
v_mfma_f32_16x16x32_bf16 v[176:179], a[208:211], a[244:247], v[176:179]
v_mfma_f32_16x16x32_bf16 v[180:183], a[208:211], a[248:251], v[180:183]
v_mfma_f32_16x16x32_bf16 v[184:187], a[208:211], a[252:255], v[184:187]
v_mfma_f32_16x16x32_bf16 v[188:191], a[212:215], a[236:239], v[188:191]
v_mfma_f32_16x16x32_bf16 v[192:195], a[212:215], a[240:243], v[192:195]
v_mfma_f32_16x16x32_bf16 v[196:199], a[212:215], a[244:247], v[196:199]
v_mfma_f32_16x16x32_bf16 v[200:203], a[212:215], a[248:251], v[200:203]
v_mfma_f32_16x16x32_bf16 v[204:207], a[212:215], a[252:255], v[204:207]
v_pk_mul_f32 v[48:49], v[48:49], s[62:63]
v_pk_mul_f32 v[50:51], v[50:51], s[62:63]
v_pk_mul_f32 v[68:69], v[68:69], s[62:63]
v_pk_mul_f32 v[70:71], v[70:71], s[62:63]
v_cvt_pk_bf16_f32 v48, v48, v49
v_cvt_pk_bf16_f32 v49, v50, v51
v_cvt_pk_bf16_f32 v50, v68, v69
v_cvt_pk_bf16_f32 v51, v70, v71
v_accvgpr_write_b32 a160, v48
v_accvgpr_write_b32 a161, v49
v_accvgpr_write_b32 a162, v50
v_accvgpr_write_b32 a163, v51
v_pk_mul_f32 v[52:53], v[52:53], s[62:63]
v_pk_mul_f32 v[54:55], v[54:55], s[62:63]
v_pk_mul_f32 v[72:73], v[72:73], s[62:63]
v_pk_mul_f32 v[74:75], v[74:75], s[62:63]
v_cvt_pk_bf16_f32 v52, v52, v53
v_cvt_pk_bf16_f32 v53, v54, v55
v_cvt_pk_bf16_f32 v54, v72, v73
v_cvt_pk_bf16_f32 v55, v74, v75
v_accvgpr_write_b32 a164, v52
v_accvgpr_write_b32 a165, v53
v_accvgpr_write_b32 a166, v54
v_accvgpr_write_b32 a167, v55
v_pk_mul_f32 v[56:57], v[56:57], s[62:63]
v_pk_mul_f32 v[58:59], v[58:59], s[62:63]
v_pk_mul_f32 v[76:77], v[76:77], s[62:63]
v_pk_mul_f32 v[78:79], v[78:79], s[62:63]
v_cvt_pk_bf16_f32 v56, v56, v57
v_cvt_pk_bf16_f32 v57, v58, v59
v_cvt_pk_bf16_f32 v58, v76, v77
v_cvt_pk_bf16_f32 v59, v78, v79
v_accvgpr_write_b32 a168, v56
v_accvgpr_write_b32 a169, v57
v_accvgpr_write_b32 a170, v58
v_accvgpr_write_b32 a171, v59
v_pk_mul_f32 v[60:61], v[60:61], s[62:63]
v_pk_mul_f32 v[62:63], v[62:63], s[62:63]
v_pk_mul_f32 v[80:81], v[80:81], s[62:63]
v_pk_mul_f32 v[82:83], v[82:83], s[62:63]
v_cvt_pk_bf16_f32 v60, v60, v61
v_cvt_pk_bf16_f32 v61, v62, v63
v_cvt_pk_bf16_f32 v62, v80, v81
v_cvt_pk_bf16_f32 v63, v82, v83
v_accvgpr_write_b32 a172, v60
v_accvgpr_write_b32 a173, v61
v_accvgpr_write_b32 a174, v62
v_accvgpr_write_b32 a175, v63
v_pk_mul_f32 v[64:65], v[64:65], s[62:63]
v_pk_mul_f32 v[66:67], v[66:67], s[62:63]
v_pk_mul_f32 v[84:85], v[84:85], s[62:63]
v_pk_mul_f32 v[86:87], v[86:87], s[62:63]
v_cvt_pk_bf16_f32 v64, v64, v65
v_cvt_pk_bf16_f32 v65, v66, v67
v_cvt_pk_bf16_f32 v66, v84, v85
v_cvt_pk_bf16_f32 v67, v86, v87
v_accvgpr_write_b32 a176, v64
v_accvgpr_write_b32 a177, v65
v_accvgpr_write_b32 a178, v66
v_accvgpr_write_b32 a179, v67
v_pk_mul_f32 v[88:89], v[88:89], s[62:63]
v_pk_mul_f32 v[90:91], v[90:91], s[62:63]
v_pk_mul_f32 v[108:109], v[108:109], s[62:63]
v_pk_mul_f32 v[110:111], v[110:111], s[62:63]
v_cvt_pk_bf16_f32 v88, v88, v89
v_cvt_pk_bf16_f32 v89, v90, v91
v_cvt_pk_bf16_f32 v90, v108, v109
v_cvt_pk_bf16_f32 v91, v110, v111
v_accvgpr_write_b32 a180, v88
v_accvgpr_write_b32 a181, v89
v_accvgpr_write_b32 a182, v90
v_accvgpr_write_b32 a183, v91
v_pk_mul_f32 v[92:93], v[92:93], s[62:63]
v_pk_mul_f32 v[94:95], v[94:95], s[62:63]
v_pk_mul_f32 v[112:113], v[112:113], s[62:63]
v_pk_mul_f32 v[114:115], v[114:115], s[62:63]
v_cvt_pk_bf16_f32 v92, v92, v93
v_cvt_pk_bf16_f32 v93, v94, v95
v_cvt_pk_bf16_f32 v94, v112, v113
v_cvt_pk_bf16_f32 v95, v114, v115
v_accvgpr_write_b32 a184, v92
v_accvgpr_write_b32 a185, v93
v_accvgpr_write_b32 a186, v94
v_accvgpr_write_b32 a187, v95
v_pk_mul_f32 v[96:97], v[96:97], s[62:63]
v_pk_mul_f32 v[98:99], v[98:99], s[62:63]
v_pk_mul_f32 v[116:117], v[116:117], s[62:63]
v_pk_mul_f32 v[118:119], v[118:119], s[62:63]
v_cvt_pk_bf16_f32 v96, v96, v97
v_cvt_pk_bf16_f32 v97, v98, v99
v_cvt_pk_bf16_f32 v98, v116, v117
v_cvt_pk_bf16_f32 v99, v118, v119
v_accvgpr_write_b32 a188, v96
v_accvgpr_write_b32 a189, v97
v_accvgpr_write_b32 a190, v98
v_accvgpr_write_b32 a191, v99
v_pk_mul_f32 v[100:101], v[100:101], s[62:63]
v_pk_mul_f32 v[102:103], v[102:103], s[62:63]
v_pk_mul_f32 v[120:121], v[120:121], s[62:63]
v_pk_mul_f32 v[122:123], v[122:123], s[62:63]
v_cvt_pk_bf16_f32 v100, v100, v101
v_cvt_pk_bf16_f32 v101, v102, v103
v_cvt_pk_bf16_f32 v102, v120, v121
v_cvt_pk_bf16_f32 v103, v122, v123
v_accvgpr_write_b32 a192, v100
v_accvgpr_write_b32 a193, v101
v_accvgpr_write_b32 a194, v102
v_accvgpr_write_b32 a195, v103
v_pk_mul_f32 v[104:105], v[104:105], s[62:63]
v_pk_mul_f32 v[106:107], v[106:107], s[62:63]
v_pk_mul_f32 v[124:125], v[124:125], s[62:63]
v_pk_mul_f32 v[126:127], v[126:127], s[62:63]
v_cvt_pk_bf16_f32 v104, v104, v105
v_cvt_pk_bf16_f32 v105, v106, v107
v_cvt_pk_bf16_f32 v106, v124, v125
v_cvt_pk_bf16_f32 v107, v126, v127
v_accvgpr_write_b32 a196, v104
v_accvgpr_write_b32 a197, v105
v_accvgpr_write_b32 a198, v106
v_accvgpr_write_b32 a199, v107
v_pk_mul_f32 v[128:129], v[128:129], s[62:63]
v_pk_mul_f32 v[130:131], v[130:131], s[62:63]
v_pk_mul_f32 v[148:149], v[148:149], s[62:63]
v_pk_mul_f32 v[150:151], v[150:151], s[62:63]
v_cvt_pk_bf16_f32 v128, v128, v129
v_cvt_pk_bf16_f32 v129, v130, v131
v_cvt_pk_bf16_f32 v130, v148, v149
v_cvt_pk_bf16_f32 v131, v150, v151
v_accvgpr_write_b32 a200, v128
v_accvgpr_write_b32 a201, v129
v_accvgpr_write_b32 a202, v130
v_accvgpr_write_b32 a203, v131
v_pk_mul_f32 v[132:133], v[132:133], s[62:63]
v_pk_mul_f32 v[134:135], v[134:135], s[62:63]
v_pk_mul_f32 v[152:153], v[152:153], s[62:63]
v_pk_mul_f32 v[154:155], v[154:155], s[62:63]
v_cvt_pk_bf16_f32 v132, v132, v133
v_cvt_pk_bf16_f32 v133, v134, v135
v_cvt_pk_bf16_f32 v134, v152, v153
v_cvt_pk_bf16_f32 v135, v154, v155
v_accvgpr_write_b32 a204, v132
v_accvgpr_write_b32 a205, v133
v_accvgpr_write_b32 a206, v134
v_accvgpr_write_b32 a207, v135
v_pk_mul_f32 v[136:137], v[136:137], s[62:63]
v_pk_mul_f32 v[138:139], v[138:139], s[62:63]
v_pk_mul_f32 v[156:157], v[156:157], s[62:63]
v_pk_mul_f32 v[158:159], v[158:159], s[62:63]
v_cvt_pk_bf16_f32 v136, v136, v137
v_cvt_pk_bf16_f32 v137, v138, v139
v_cvt_pk_bf16_f32 v138, v156, v157
v_cvt_pk_bf16_f32 v139, v158, v159
v_accvgpr_write_b32 a208, v136
v_accvgpr_write_b32 a209, v137
v_accvgpr_write_b32 a210, v138
v_accvgpr_write_b32 a211, v139
v_pk_mul_f32 v[140:141], v[140:141], s[62:63]
v_pk_mul_f32 v[142:143], v[142:143], s[62:63]
v_pk_mul_f32 v[160:161], v[160:161], s[62:63]
v_pk_mul_f32 v[162:163], v[162:163], s[62:63]
v_cvt_pk_bf16_f32 v140, v140, v141
v_cvt_pk_bf16_f32 v141, v142, v143
v_cvt_pk_bf16_f32 v142, v160, v161
v_cvt_pk_bf16_f32 v143, v162, v163
v_accvgpr_write_b32 a212, v140
v_accvgpr_write_b32 a213, v141
v_accvgpr_write_b32 a214, v142
v_accvgpr_write_b32 a215, v143
v_pk_mul_f32 v[144:145], v[144:145], s[62:63]
v_pk_mul_f32 v[146:147], v[146:147], s[62:63]
v_pk_mul_f32 v[164:165], v[164:165], s[62:63]
v_pk_mul_f32 v[166:167], v[166:167], s[62:63]
v_cvt_pk_bf16_f32 v144, v144, v145
v_cvt_pk_bf16_f32 v145, v146, v147
v_cvt_pk_bf16_f32 v146, v164, v165
v_cvt_pk_bf16_f32 v147, v166, v167
v_accvgpr_write_b32 a216, v144
v_accvgpr_write_b32 a217, v145
v_accvgpr_write_b32 a218, v146
v_accvgpr_write_b32 a219, v147
v_pk_mul_f32 v[168:169], v[168:169], s[62:63]
v_pk_mul_f32 v[170:171], v[170:171], s[62:63]
v_pk_mul_f32 v[188:189], v[188:189], s[62:63]
v_pk_mul_f32 v[190:191], v[190:191], s[62:63]
v_cvt_pk_bf16_f32 v168, v168, v169
v_cvt_pk_bf16_f32 v169, v170, v171
v_cvt_pk_bf16_f32 v170, v188, v189
v_cvt_pk_bf16_f32 v171, v190, v191
v_accvgpr_write_b32 a220, v168
v_accvgpr_write_b32 a221, v169
v_accvgpr_write_b32 a222, v170
v_accvgpr_write_b32 a223, v171
v_pk_mul_f32 v[172:173], v[172:173], s[62:63]
v_pk_mul_f32 v[174:175], v[174:175], s[62:63]
v_pk_mul_f32 v[192:193], v[192:193], s[62:63]
v_pk_mul_f32 v[194:195], v[194:195], s[62:63]
v_cvt_pk_bf16_f32 v172, v172, v173
v_cvt_pk_bf16_f32 v173, v174, v175
v_cvt_pk_bf16_f32 v174, v192, v193
v_cvt_pk_bf16_f32 v175, v194, v195
v_accvgpr_write_b32 a224, v172
v_accvgpr_write_b32 a225, v173
v_accvgpr_write_b32 a226, v174
v_accvgpr_write_b32 a227, v175
v_pk_mul_f32 v[176:177], v[176:177], s[62:63]
v_pk_mul_f32 v[178:179], v[178:179], s[62:63]
v_pk_mul_f32 v[196:197], v[196:197], s[62:63]
v_pk_mul_f32 v[198:199], v[198:199], s[62:63]
v_cvt_pk_bf16_f32 v176, v176, v177
v_cvt_pk_bf16_f32 v177, v178, v179
v_cvt_pk_bf16_f32 v178, v196, v197
v_cvt_pk_bf16_f32 v179, v198, v199
v_accvgpr_write_b32 a228, v176
v_accvgpr_write_b32 a229, v177
v_accvgpr_write_b32 a230, v178
v_accvgpr_write_b32 a231, v179
v_pk_mul_f32 v[180:181], v[180:181], s[62:63]
v_pk_mul_f32 v[182:183], v[182:183], s[62:63]
v_pk_mul_f32 v[200:201], v[200:201], s[62:63]
v_pk_mul_f32 v[202:203], v[202:203], s[62:63]
v_cvt_pk_bf16_f32 v180, v180, v181
v_cvt_pk_bf16_f32 v181, v182, v183
v_cvt_pk_bf16_f32 v182, v200, v201
v_cvt_pk_bf16_f32 v183, v202, v203
v_accvgpr_write_b32 a232, v180
v_accvgpr_write_b32 a233, v181
v_accvgpr_write_b32 a234, v182
v_accvgpr_write_b32 a235, v183
v_pk_mul_f32 v[184:185], v[184:185], s[62:63]
v_pk_mul_f32 v[186:187], v[186:187], s[62:63]
v_pk_mul_f32 v[204:205], v[204:205], s[62:63]
v_pk_mul_f32 v[206:207], v[206:207], s[62:63]
v_cvt_pk_bf16_f32 v184, v184, v185
v_cvt_pk_bf16_f32 v185, v186, v187
v_cvt_pk_bf16_f32 v186, v204, v205
v_cvt_pk_bf16_f32 v187, v206, v207
v_accvgpr_write_b32 a236, v184
v_accvgpr_write_b32 a237, v185
v_accvgpr_write_b32 a238, v186
v_accvgpr_write_b32 a239, v187
s_waitcnt vmcnt(4)
s_barrier
ds_read_b128 v[188:191], v16 offset:0
ds_read_b128 v[192:195], v17 offset:0
ds_read_b128 v[196:199], v18 offset:0
ds_read_b128 v[200:203], v19 offset:0
s_waitcnt lgkmcnt(2)
v_mfma_f32_16x16x32_bf16 v[48:51], v[188:191], a[160:163], 0
ds_read_b128 v[204:207], v16 offset:4096
v_mfma_f32_16x16x32_bf16 v[52:55], v[188:191], a[164:167], 0
v_mfma_f32_16x16x32_bf16 v[56:59], v[188:191], a[168:171], 0
v_mfma_f32_16x16x32_bf16 v[60:63], v[188:191], a[172:175], 0
v_mfma_f32_16x16x32_bf16 v[64:67], v[188:191], a[176:179], 0
v_mfma_f32_16x16x32_bf16 v[48:51], v[192:195], a[180:183], v[48:51]
ds_read_b128 v[208:211], v17 offset:4096
s_add_u32 m0, s97, 24576
v_mfma_f32_16x16x32_bf16 v[52:55], v[192:195], a[184:187], v[52:55]
buffer_load_dwordx4 v28, s[8:11], s95 offen nt lds
v_mfma_f32_16x16x32_bf16 v[56:59], v[192:195], a[188:191], v[56:59]
v_mfma_f32_16x16x32_bf16 v[60:63], v[192:195], a[192:195], v[60:63]
buffer_load_dwordx4 v29, s[8:11], s95 offen offset:1024 nt lds
v_mfma_f32_16x16x32_bf16 v[64:67], v[192:195], a[196:199], v[64:67]
s_add_u32 s95, s95, 8192
s_waitcnt lgkmcnt(2)
v_mfma_f32_16x16x32_bf16 v[48:51], v[196:199], a[200:203], v[48:51]
ds_read_b128 v[212:215], v18 offset:4096
v_mfma_f32_16x16x32_bf16 v[52:55], v[196:199], a[204:207], v[52:55]
v_mfma_f32_16x16x32_bf16 v[56:59], v[196:199], a[208:211], v[56:59]
v_mfma_f32_16x16x32_bf16 v[60:63], v[196:199], a[212:215], v[60:63]
v_mfma_f32_16x16x32_bf16 v[64:67], v[196:199], a[216:219], v[64:67]
v_mfma_f32_16x16x32_bf16 v[48:51], v[200:203], a[220:223], v[48:51]
ds_read_b128 v[216:219], v19 offset:4096
s_add_u32 m0, s97, 40960
v_mfma_f32_16x16x32_bf16 v[52:55], v[200:203], a[224:227], v[52:55]
buffer_load_dwordx4 v32, s[12:15], s96 offen nt lds
v_mfma_f32_16x16x32_bf16 v[56:59], v[200:203], a[228:231], v[56:59]
v_mfma_f32_16x16x32_bf16 v[60:63], v[200:203], a[232:235], v[60:63]
buffer_load_dwordx4 v33, s[12:15], s96 offen offset:1024 nt lds
v_mfma_f32_16x16x32_bf16 v[64:67], v[200:203], a[236:239], v[64:67]
s_add_u32 s96, s96, 8192
s_waitcnt lgkmcnt(2)
v_mfma_f32_16x16x32_bf16 v[68:71], v[204:207], a[160:163], 0
v_mfma_f32_16x16x32_bf16 v[72:75], v[204:207], a[164:167], 0
v_mfma_f32_16x16x32_bf16 v[76:79], v[204:207], a[168:171], 0
v_mfma_f32_16x16x32_bf16 v[80:83], v[204:207], a[172:175], 0
v_mfma_f32_16x16x32_bf16 v[84:87], v[204:207], a[176:179], 0
v_mfma_f32_16x16x32_bf16 v[68:71], v[208:211], a[180:183], v[68:71]
v_mfma_f32_16x16x32_bf16 v[72:75], v[208:211], a[184:187], v[72:75]
v_mfma_f32_16x16x32_bf16 v[76:79], v[208:211], a[188:191], v[76:79]
v_mfma_f32_16x16x32_bf16 v[80:83], v[208:211], a[192:195], v[80:83]
v_mfma_f32_16x16x32_bf16 v[84:87], v[208:211], a[196:199], v[84:87]
s_waitcnt lgkmcnt(0)
v_mfma_f32_16x16x32_bf16 v[68:71], v[212:215], a[200:203], v[68:71]
v_mfma_f32_16x16x32_bf16 v[72:75], v[212:215], a[204:207], v[72:75]
v_mfma_f32_16x16x32_bf16 v[76:79], v[212:215], a[208:211], v[76:79]
v_mfma_f32_16x16x32_bf16 v[80:83], v[212:215], a[212:215], v[80:83]
v_mfma_f32_16x16x32_bf16 v[84:87], v[212:215], a[216:219], v[84:87]
v_mfma_f32_16x16x32_bf16 v[68:71], v[216:219], a[220:223], v[68:71]
v_mfma_f32_16x16x32_bf16 v[72:75], v[216:219], a[224:227], v[72:75]
v_mfma_f32_16x16x32_bf16 v[76:79], v[216:219], a[228:231], v[76:79]
v_mfma_f32_16x16x32_bf16 v[80:83], v[216:219], a[232:235], v[80:83]
v_mfma_f32_16x16x32_bf16 v[84:87], v[216:219], a[236:239], v[84:87]
s_nop 7
v_max3_f32 v36, v48, v49, v50
v_max3_f32 v36, v36, v51, v68
v_max3_f32 v36, v36, v69, v70
v_max_f32 v36, v36, v71
v_mov_b32 v37, v36
s_nop 1
v_permlane32_swap_b32 v36, v37
s_nop 1
v_max_f32 v36, v36, v37
v_mov_b32 v37, v36
s_nop 1
v_permlane16_swap_b32 v36, v37
s_nop 1
v_max_f32 v36, v36, v37
v_add_f32 v36, 0x41000000, v36
v_sub_f32 v168, 0, v36
v_sub_f32 v169, 0, v36
v_sub_f32 v170, 0, v36
v_sub_f32 v171, 0, v36
v_sub_f32 v48, v48, v36
v_sub_f32 v49, v49, v36
v_sub_f32 v50, v50, v36
v_sub_f32 v51, v51, v36
v_sub_f32 v68, v68, v36
v_sub_f32 v69, v69, v36
v_sub_f32 v70, v70, v36
v_sub_f32 v71, v71, v36
v_max3_f32 v36, v52, v53, v54
v_max3_f32 v36, v36, v55, v72
v_max3_f32 v36, v36, v73, v74
v_max_f32 v36, v36, v75
v_mov_b32 v37, v36
s_nop 1
v_permlane32_swap_b32 v36, v37
s_nop 1
v_max_f32 v36, v36, v37
v_mov_b32 v37, v36
s_nop 1
v_permlane16_swap_b32 v36, v37
s_nop 1
v_max_f32 v36, v36, v37
v_add_f32 v36, 0x41000000, v36
v_sub_f32 v172, 0, v36
v_sub_f32 v173, 0, v36
v_sub_f32 v174, 0, v36
v_sub_f32 v175, 0, v36
v_sub_f32 v52, v52, v36
v_sub_f32 v53, v53, v36
v_sub_f32 v54, v54, v36
v_sub_f32 v55, v55, v36
v_sub_f32 v72, v72, v36
v_sub_f32 v73, v73, v36
v_sub_f32 v74, v74, v36
v_sub_f32 v75, v75, v36
v_max3_f32 v36, v56, v57, v58
v_max3_f32 v36, v36, v59, v76
v_max3_f32 v36, v36, v77, v78
v_max_f32 v36, v36, v79
v_mov_b32 v37, v36
s_nop 1
v_permlane32_swap_b32 v36, v37
s_nop 1
v_max_f32 v36, v36, v37
v_mov_b32 v37, v36
s_nop 1
v_permlane16_swap_b32 v36, v37
s_nop 1
v_max_f32 v36, v36, v37
v_add_f32 v36, 0x41000000, v36
v_sub_f32 v176, 0, v36
v_sub_f32 v177, 0, v36
v_sub_f32 v178, 0, v36
v_sub_f32 v179, 0, v36
v_sub_f32 v56, v56, v36
v_sub_f32 v57, v57, v36
v_sub_f32 v58, v58, v36
v_sub_f32 v59, v59, v36
v_sub_f32 v76, v76, v36
v_sub_f32 v77, v77, v36
v_sub_f32 v78, v78, v36
v_sub_f32 v79, v79, v36
v_max3_f32 v36, v60, v61, v62
v_max3_f32 v36, v36, v63, v80
v_max3_f32 v36, v36, v81, v82
v_max_f32 v36, v36, v83
v_mov_b32 v37, v36
s_nop 1
v_permlane32_swap_b32 v36, v37
s_nop 1
v_max_f32 v36, v36, v37
v_mov_b32 v37, v36
s_nop 1
v_permlane16_swap_b32 v36, v37
s_nop 1
v_max_f32 v36, v36, v37
v_add_f32 v36, 0x41000000, v36
v_sub_f32 v180, 0, v36
v_sub_f32 v181, 0, v36
v_sub_f32 v182, 0, v36
v_sub_f32 v183, 0, v36
v_sub_f32 v60, v60, v36
v_sub_f32 v61, v61, v36
v_sub_f32 v62, v62, v36
v_sub_f32 v63, v63, v36
v_sub_f32 v80, v80, v36
v_sub_f32 v81, v81, v36
v_sub_f32 v82, v82, v36
v_sub_f32 v83, v83, v36
v_max3_f32 v36, v64, v65, v66
v_max3_f32 v36, v36, v67, v84
v_max3_f32 v36, v36, v85, v86
v_max_f32 v36, v36, v87
v_mov_b32 v37, v36
s_nop 1
v_permlane32_swap_b32 v36, v37
s_nop 1
v_max_f32 v36, v36, v37
v_mov_b32 v37, v36
s_nop 1
v_permlane16_swap_b32 v36, v37
s_nop 1
v_max_f32 v36, v36, v37
v_add_f32 v36, 0x41000000, v36
v_sub_f32 v184, 0, v36
v_sub_f32 v185, 0, v36
v_sub_f32 v186, 0, v36
v_sub_f32 v187, 0, v36
v_sub_f32 v64, v64, v36
v_sub_f32 v65, v65, v36
v_sub_f32 v66, v66, v36
v_sub_f32 v67, v67, v36
v_sub_f32 v84, v84, v36
v_sub_f32 v85, v85, v36
v_sub_f32 v86, v86, v36
v_sub_f32 v87, v87, v36
s_waitcnt vmcnt(4)
s_barrier
ds_read_b128 v[188:191], v16 offset:8192
ds_read_b128 v[192:195], v17 offset:8192
ds_read_b128 v[196:199], v18 offset:8192
ds_read_b128 v[200:203], v19 offset:8192
s_waitcnt lgkmcnt(2)
v_mfma_f32_16x16x32_bf16 v[88:91], v[188:191], a[160:163], v[168:171]
ds_read_b128 v[204:207], v16 offset:12288
v_exp_f32 v36, v48
v_mfma_f32_16x16x32_bf16 v[92:95], v[188:191], a[164:167], v[172:175]
v_exp_f32 v37, v49
v_mfma_f32_16x16x32_bf16 v[96:99], v[188:191], a[168:171], v[176:179]
v_exp_f32 v38, v50
v_mfma_f32_16x16x32_bf16 v[100:103], v[188:191], a[172:175], v[180:183]
v_exp_f32 v39, v51
v_mfma_f32_16x16x32_bf16 v[104:107], v[188:191], a[176:179], v[184:187]
v_cvt_pk_bf16_f32 v128, v36, v37
v_mfma_f32_16x16x32_bf16 v[88:91], v[192:195], a[180:183], v[88:91]
ds_read_b128 v[208:211], v17 offset:12288
s_add_u32 m0, s97, 0
v_mfma_f32_16x16x32_bf16 v[92:95], v[192:195], a[184:187], v[92:95]
buffer_load_dwordx4 v28, s[8:11], s95 offen nt lds
v_mfma_f32_16x16x32_bf16 v[96:99], v[192:195], a[188:191], v[96:99]
v_cvt_pk_bf16_f32 v129, v38, v39
v_exp_f32 v40, v68
v_mfma_f32_16x16x32_bf16 v[100:103], v[192:195], a[192:195], v[100:103]
buffer_load_dwordx4 v29, s[8:11], s95 offen offset:1024 nt lds
v_mfma_f32_16x16x32_bf16 v[104:107], v[192:195], a[196:199], v[104:107]
s_add_u32 s95, s95, 8192
s_waitcnt lgkmcnt(2)
v_mfma_f32_16x16x32_bf16 v[88:91], v[196:199], a[200:203], v[88:91]
ds_read_b128 v[212:215], v18 offset:12288
v_exp_f32 v41, v69
v_mfma_f32_16x16x32_bf16 v[92:95], v[196:199], a[204:207], v[92:95]
v_exp_f32 v42, v70
v_mfma_f32_16x16x32_bf16 v[96:99], v[196:199], a[208:211], v[96:99]
v_exp_f32 v43, v71
v_mfma_f32_16x16x32_bf16 v[100:103], v[196:199], a[212:215], v[100:103]
v_cvt_pk_bf16_f32 v130, v40, v41
v_cvt_pk_bf16_f32 v131, v42, v43
v_mfma_f32_16x16x32_bf16 v[104:107], v[196:199], a[216:219], v[104:107]
v_or_b32 v44, v128, v129
v_or3_b32 v44, v44, v130, v131
v_mfma_f32_16x16x32_bf16 v[88:91], v[200:203], a[220:223], v[88:91]
ds_read_b128 v[216:219], v19 offset:12288
s_add_u32 m0, s97, 49152
v_mfma_f32_16x16x32_bf16 v[92:95], v[200:203], a[224:227], v[92:95]
buffer_load_dwordx4 v32, s[12:15], s96 offen nt lds
v_mfma_f32_16x16x32_bf16 v[96:99], v[200:203], a[228:231], v[96:99]
v_exp_f32 v36, v52
v_mfma_f32_16x16x32_bf16 v[100:103], v[200:203], a[232:235], v[100:103]
buffer_load_dwordx4 v33, s[12:15], s96 offen offset:1024 nt lds
v_mfma_f32_16x16x32_bf16 v[104:107], v[200:203], a[236:239], v[104:107]
s_add_u32 s96, s96, 8192
s_waitcnt lgkmcnt(2)
v_mfma_f32_16x16x32_bf16 v[108:111], v[204:207], a[160:163], v[168:171]
v_exp_f32 v37, v53
v_mfma_f32_16x16x32_bf16 v[112:115], v[204:207], a[164:167], v[172:175]
v_exp_f32 v38, v54
v_mfma_f32_16x16x32_bf16 v[116:119], v[204:207], a[168:171], v[176:179]
v_exp_f32 v39, v55
v_cvt_pk_bf16_f32 v132, v36, v37
v_mfma_f32_16x16x32_bf16 v[120:123], v[204:207], a[172:175], v[180:183]
v_cvt_pk_bf16_f32 v133, v38, v39
v_exp_f32 v40, v72
v_mfma_f32_16x16x32_bf16 v[124:127], v[204:207], a[176:179], v[184:187]
v_exp_f32 v41, v73
v_mfma_f32_16x16x32_bf16 v[108:111], v[208:211], a[180:183], v[108:111]
v_exp_f32 v42, v74
v_mfma_f32_16x16x32_bf16 v[112:115], v[208:211], a[184:187], v[112:115]
v_exp_f32 v43, v75
v_mfma_f32_16x16x32_bf16 v[116:119], v[208:211], a[188:191], v[116:119]
v_cvt_pk_bf16_f32 v134, v40, v41
v_mfma_f32_16x16x32_bf16 v[120:123], v[208:211], a[192:195], v[120:123]
v_cvt_pk_bf16_f32 v135, v42, v43
v_or3_b32 v44, v44, v132, v133
v_mfma_f32_16x16x32_bf16 v[124:127], v[208:211], a[196:199], v[124:127]
v_or3_b32 v44, v44, v134, v135
v_exp_f32 v36, v56
s_waitcnt lgkmcnt(0)
v_mfma_f32_16x16x32_bf16 v[108:111], v[212:215], a[200:203], v[108:111]
v_exp_f32 v37, v57
v_mfma_f32_16x16x32_bf16 v[112:115], v[212:215], a[204:207], v[112:115]
v_exp_f32 v38, v58
v_mfma_f32_16x16x32_bf16 v[116:119], v[212:215], a[208:211], v[116:119]
v_exp_f32 v39, v59
v_mfma_f32_16x16x32_bf16 v[120:123], v[212:215], a[212:215], v[120:123]
v_cvt_pk_bf16_f32 v136, v36, v37
v_cvt_pk_bf16_f32 v137, v38, v39
v_mfma_f32_16x16x32_bf16 v[124:127], v[212:215], a[216:219], v[124:127]
v_exp_f32 v40, v76
v_mfma_f32_16x16x32_bf16 v[108:111], v[216:219], a[220:223], v[108:111]
v_exp_f32 v41, v77
v_mfma_f32_16x16x32_bf16 v[112:115], v[216:219], a[224:227], v[112:115]
v_exp_f32 v42, v78
v_mfma_f32_16x16x32_bf16 v[116:119], v[216:219], a[228:231], v[116:119]
v_exp_f32 v43, v79
v_mfma_f32_16x16x32_bf16 v[120:123], v[216:219], a[232:235], v[120:123]
v_mfma_f32_16x16x32_bf16 v[124:127], v[216:219], a[236:239], v[124:127]
v_cvt_pk_bf16_f32 v138, v40, v41
v_cvt_pk_bf16_f32 v139, v42, v43
v_or3_b32 v44, v44, v136, v137
v_or3_b32 v44, v44, v138, v139
v_exp_f32 v36, v60
v_exp_f32 v37, v61
v_exp_f32 v38, v62
v_exp_f32 v39, v63
v_cvt_pk_bf16_f32 v140, v36, v37
v_cvt_pk_bf16_f32 v141, v38, v39
v_exp_f32 v40, v80
v_exp_f32 v41, v81
v_exp_f32 v42, v82
v_exp_f32 v43, v83
v_cvt_pk_bf16_f32 v142, v40, v41
v_cvt_pk_bf16_f32 v143, v42, v43
v_or3_b32 v44, v44, v140, v141
v_or3_b32 v44, v44, v142, v143
v_exp_f32 v36, v64
v_exp_f32 v37, v65
v_exp_f32 v38, v66
v_exp_f32 v39, v67
v_cvt_pk_bf16_f32 v144, v36, v37
v_cvt_pk_bf16_f32 v145, v38, v39
v_exp_f32 v40, v84
v_exp_f32 v41, v85
v_exp_f32 v42, v86
v_exp_f32 v43, v87
v_cvt_pk_bf16_f32 v146, v40, v41
v_cvt_pk_bf16_f32 v147, v42, v43
v_or3_b32 v44, v44, v144, v145
v_or3_b32 v44, v44, v146, v147
v_and_b32 v44, 0x40004000, v44
v_cmp_ne_u32 vcc, 0, v44
s_nop 1
s_cbranch_vccnz L_rare_14
L_rare_14_ret:
s_waitcnt vmcnt(4)
s_barrier
ds_read_b128 v[188:191], v16 offset:16384
ds_read_b128 v[192:195], v17 offset:16384
ds_read_b128 v[196:199], v18 offset:16384
ds_read_b128 v[200:203], v19 offset:16384
s_waitcnt lgkmcnt(2)
v_mfma_f32_16x16x32_bf16 v[48:51], v[188:191], a[160:163], v[168:171]
ds_read_b128 v[204:207], v16 offset:20480
v_mfma_f32_16x16x32_bf16 v[52:55], v[188:191], a[164:167], v[172:175]
v_exp_f32 v36, v88
v_mfma_f32_16x16x32_bf16 v[56:59], v[188:191], a[168:171], v[176:179]
v_mfma_f32_16x16x32_bf16 v[60:63], v[188:191], a[172:175], v[180:183]
v_exp_f32 v37, v89
v_mfma_f32_16x16x32_bf16 v[64:67], v[188:191], a[176:179], v[184:187]
v_mfma_f32_16x16x32_bf16 v[48:51], v[192:195], a[180:183], v[48:51]
ds_read_b128 v[208:211], v17 offset:20480
s_add_u32 m0, s97, 8192
v_mfma_f32_16x16x32_bf16 v[52:55], v[192:195], a[184:187], v[52:55]
buffer_load_dwordx4 v28, s[8:11], s95 offen nt lds
v_mfma_f32_16x16x32_bf16 v[56:59], v[192:195], a[188:191], v[56:59]
v_exp_f32 v38, v90
v_mfma_f32_16x16x32_bf16 v[60:63], v[192:195], a[192:195], v[60:63]
buffer_load_dwordx4 v29, s[8:11], s95 offen offset:1024 nt lds
v_mfma_f32_16x16x32_bf16 v[64:67], v[192:195], a[196:199], v[64:67]
s_add_u32 s95, s95, 8192
s_waitcnt lgkmcnt(2)
v_mfma_f32_16x16x32_bf16 v[48:51], v[196:199], a[200:203], v[48:51]
ds_read_b128 v[212:215], v18 offset:20480
v_mfma_f32_16x16x32_bf16 v[52:55], v[196:199], a[204:207], v[52:55]
v_mfma_f32_16x16x32_bf16 v[56:59], v[196:199], a[208:211], v[56:59]
v_exp_f32 v39, v91
v_mfma_f32_16x16x32_bf16 v[60:63], v[196:199], a[212:215], v[60:63]
v_cvt_pk_bf16_f32 v148, v36, v37
v_mfma_f32_16x16x32_bf16 v[64:67], v[196:199], a[216:219], v[64:67]
v_cvt_pk_bf16_f32 v149, v38, v39
v_mfma_f32_16x16x32_bf16 v[48:51], v[200:203], a[220:223], v[48:51]
ds_read_b128 v[216:219], v19 offset:20480
s_add_u32 m0, s97, 57344
v_mfma_f32_16x16x32_bf16 v[52:55], v[200:203], a[224:227], v[52:55]
buffer_load_dwordx4 v32, s[12:15], s96 offen nt lds
v_mfma_f32_16x16x32_bf16 v[56:59], v[200:203], a[228:231], v[56:59]
v_mfma_f32_16x16x32_bf16 v[60:63], v[200:203], a[232:235], v[60:63]
buffer_load_dwordx4 v33, s[12:15], s96 offen offset:1024 nt lds
v_mfma_f32_16x16x32_bf16 v[64:67], v[200:203], a[236:239], v[64:67]
s_add_u32 s96, s96, 8192
v_exp_f32 v40, v108
s_waitcnt lgkmcnt(2)
v_mfma_f32_16x16x32_bf16 v[68:71], v[204:207], a[160:163], v[168:171]
ds_read_b64_tr_b16 v[188:189], v20 offset:32768
v_mfma_f32_16x16x32_bf16 v[72:75], v[204:207], a[164:167], v[172:175]
ds_read_b64_tr_b16 v[190:191], v20 offset:36864
v_mfma_f32_16x16x32_bf16 v[76:79], v[204:207], a[168:171], v[176:179]
v_mfma_f32_16x16x32_bf16 v[80:83], v[204:207], a[172:175], v[180:183]
v_exp_f32 v41, v109
v_mfma_f32_16x16x32_bf16 v[84:87], v[204:207], a[176:179], v[184:187]
v_mfma_f32_16x16x32_bf16 v[68:71], v[208:211], a[180:183], v[68:71]
ds_read_b64_tr_b16 v[192:193], v21 offset:32768
v_exp_f32 v42, v110
v_mfma_f32_16x16x32_bf16 v[72:75], v[208:211], a[184:187], v[72:75]
ds_read_b64_tr_b16 v[194:195], v21 offset:36864
v_mfma_f32_16x16x32_bf16 v[76:79], v[208:211], a[188:191], v[76:79]
v_mfma_f32_16x16x32_bf16 v[80:83], v[208:211], a[192:195], v[80:83]
v_exp_f32 v43, v111
v_mfma_f32_16x16x32_bf16 v[84:87], v[208:211], a[196:199], v[84:87]
v_cvt_pk_bf16_f32 v150, v40, v41
s_waitcnt lgkmcnt(4)
v_mfma_f32_16x16x32_bf16 v[68:71], v[212:215], a[200:203], v[68:71]
ds_read_b64_tr_b16 v[196:197], v22 offset:32768
v_mfma_f32_16x16x32_bf16 v[72:75], v[212:215], a[204:207], v[72:75]
ds_read_b64_tr_b16 v[198:199], v22 offset:36864
v_mfma_f32_16x16x32_bf16 v[76:79], v[212:215], a[208:211], v[76:79]
v_cvt_pk_bf16_f32 v151, v42, v43
v_mfma_f32_16x16x32_bf16 v[80:83], v[212:215], a[212:215], v[80:83]
v_or_b32 v44, v148, v149
v_mfma_f32_16x16x32_bf16 v[84:87], v[212:215], a[216:219], v[84:87]
v_or3_b32 v44, v44, v150, v151
v_mfma_f32_16x16x32_bf16 v[68:71], v[216:219], a[220:223], v[68:71]
ds_read_b64_tr_b16 v[200:201], v23 offset:32768
v_mfma_f32_16x16x32_bf16 v[72:75], v[216:219], a[224:227], v[72:75]
ds_read_b64_tr_b16 v[202:203], v23 offset:36864
v_exp_f32 v36, v92
v_mfma_f32_16x16x32_bf16 v[76:79], v[216:219], a[228:231], v[76:79]
v_mfma_f32_16x16x32_bf16 v[80:83], v[216:219], a[232:235], v[80:83]
v_mfma_f32_16x16x32_bf16 v[84:87], v[216:219], a[236:239], v[84:87]
v_exp_f32 v37, v93
s_waitcnt lgkmcnt(4)
v_mfma_f32_16x16x32_bf16 a[0:3], v[188:191], v[128:131], 0
ds_read_b64_tr_b16 v[204:205], v24 offset:32768
v_mfma_f32_16x16x32_bf16 a[4:7], v[188:191], v[132:135], 0
ds_read_b64_tr_b16 v[206:207], v24 offset:36864
v_mfma_f32_16x16x32_bf16 a[8:11], v[188:191], v[136:139], 0
v_exp_f32 v38, v94
v_mfma_f32_16x16x32_bf16 a[12:15], v[188:191], v[140:143], 0
v_mfma_f32_16x16x32_bf16 a[16:19], v[188:191], v[144:147], 0
v_exp_f32 v39, v95
v_mfma_f32_16x16x32_bf16 a[20:23], v[192:195], v[128:131], 0
ds_read_b64_tr_b16 v[208:209], v25 offset:32768
v_mfma_f32_16x16x32_bf16 a[24:27], v[192:195], v[132:135], 0
ds_read_b64_tr_b16 v[210:211], v25 offset:36864
v_cvt_pk_bf16_f32 v152, v36, v37
v_mfma_f32_16x16x32_bf16 a[28:31], v[192:195], v[136:139], 0
v_mfma_f32_16x16x32_bf16 a[32:35], v[192:195], v[140:143], 0
v_cvt_pk_bf16_f32 v153, v38, v39
v_mfma_f32_16x16x32_bf16 a[36:39], v[192:195], v[144:147], 0
v_exp_f32 v40, v112
s_waitcnt lgkmcnt(4)
v_mfma_f32_16x16x32_bf16 a[40:43], v[196:199], v[128:131], 0
ds_read_b64_tr_b16 v[212:213], v26 offset:32768
v_mfma_f32_16x16x32_bf16 a[44:47], v[196:199], v[132:135], 0
ds_read_b64_tr_b16 v[214:215], v26 offset:36864
v_mfma_f32_16x16x32_bf16 a[48:51], v[196:199], v[136:139], 0
v_exp_f32 v41, v113
v_mfma_f32_16x16x32_bf16 a[52:55], v[196:199], v[140:143], 0
v_mfma_f32_16x16x32_bf16 a[56:59], v[196:199], v[144:147], 0
v_exp_f32 v42, v114
v_mfma_f32_16x16x32_bf16 a[60:63], v[200:203], v[128:131], 0
ds_read_b64_tr_b16 v[216:217], v27 offset:32768
v_mfma_f32_16x16x32_bf16 a[64:67], v[200:203], v[132:135], 0
ds_read_b64_tr_b16 v[218:219], v27 offset:36864
v_mfma_f32_16x16x32_bf16 a[68:71], v[200:203], v[136:139], 0
v_mfma_f32_16x16x32_bf16 a[72:75], v[200:203], v[140:143], 0
v_exp_f32 v43, v115
v_mfma_f32_16x16x32_bf16 a[76:79], v[200:203], v[144:147], 0
v_cvt_pk_bf16_f32 v154, v40, v41
s_waitcnt lgkmcnt(4)
v_mfma_f32_16x16x32_bf16 a[80:83], v[204:207], v[128:131], 0
v_cvt_pk_bf16_f32 v155, v42, v43
v_mfma_f32_16x16x32_bf16 a[84:87], v[204:207], v[132:135], 0
v_or3_b32 v44, v44, v152, v153
v_mfma_f32_16x16x32_bf16 a[88:91], v[204:207], v[136:139], 0
v_mfma_f32_16x16x32_bf16 a[92:95], v[204:207], v[140:143], 0
v_or3_b32 v44, v44, v154, v155
v_mfma_f32_16x16x32_bf16 a[96:99], v[204:207], v[144:147], 0
v_exp_f32 v36, v96
v_mfma_f32_16x16x32_bf16 a[100:103], v[208:211], v[128:131], 0
v_mfma_f32_16x16x32_bf16 a[104:107], v[208:211], v[132:135], 0
v_exp_f32 v37, v97
v_mfma_f32_16x16x32_bf16 a[108:111], v[208:211], v[136:139], 0
v_mfma_f32_16x16x32_bf16 a[112:115], v[208:211], v[140:143], 0
v_exp_f32 v38, v98
v_mfma_f32_16x16x32_bf16 a[116:119], v[208:211], v[144:147], 0
s_waitcnt lgkmcnt(0)
v_mfma_f32_16x16x32_bf16 a[120:123], v[212:215], v[128:131], 0
v_mfma_f32_16x16x32_bf16 a[124:127], v[212:215], v[132:135], 0
v_exp_f32 v39, v99
v_mfma_f32_16x16x32_bf16 a[128:131], v[212:215], v[136:139], 0
v_cvt_pk_bf16_f32 v156, v36, v37
v_mfma_f32_16x16x32_bf16 a[132:135], v[212:215], v[140:143], 0
v_cvt_pk_bf16_f32 v157, v38, v39
v_mfma_f32_16x16x32_bf16 a[136:139], v[212:215], v[144:147], 0
v_mfma_f32_16x16x32_bf16 a[140:143], v[216:219], v[128:131], 0
v_exp_f32 v40, v116
v_mfma_f32_16x16x32_bf16 a[144:147], v[216:219], v[132:135], 0
v_mfma_f32_16x16x32_bf16 a[148:151], v[216:219], v[136:139], 0
v_exp_f32 v41, v117
v_mfma_f32_16x16x32_bf16 a[152:155], v[216:219], v[140:143], 0
v_mfma_f32_16x16x32_bf16 a[156:159], v[216:219], v[144:147], 0
v_exp_f32 v42, v118
v_mfma_f32_16x16x32_bf16 v[220:223], v[240:243], v[128:131], 0
v_mfma_f32_16x16x32_bf16 v[224:227], v[240:243], v[132:135], 0
v_exp_f32 v43, v119
v_mfma_f32_16x16x32_bf16 v[228:231], v[240:243], v[136:139], 0
v_mfma_f32_16x16x32_bf16 v[232:235], v[240:243], v[140:143], 0
v_mfma_f32_16x16x32_bf16 v[236:239], v[240:243], v[144:147], 0
v_cvt_pk_bf16_f32 v158, v40, v41
v_cvt_pk_bf16_f32 v159, v42, v43
v_or3_b32 v44, v44, v156, v157
v_or3_b32 v44, v44, v158, v159
v_exp_f32 v36, v100
v_exp_f32 v37, v101
v_exp_f32 v38, v102
v_exp_f32 v39, v103
v_cvt_pk_bf16_f32 v160, v36, v37
v_cvt_pk_bf16_f32 v161, v38, v39
v_exp_f32 v40, v120
v_exp_f32 v41, v121
v_exp_f32 v42, v122
v_exp_f32 v43, v123
v_cvt_pk_bf16_f32 v162, v40, v41
v_cvt_pk_bf16_f32 v163, v42, v43
v_or3_b32 v44, v44, v160, v161
v_or3_b32 v44, v44, v162, v163
v_exp_f32 v36, v104
v_exp_f32 v37, v105
v_exp_f32 v38, v106
v_exp_f32 v39, v107
v_cvt_pk_bf16_f32 v164, v36, v37
v_cvt_pk_bf16_f32 v165, v38, v39
v_exp_f32 v40, v124
v_exp_f32 v41, v125
v_exp_f32 v42, v126
v_exp_f32 v43, v127
v_cvt_pk_bf16_f32 v166, v40, v41
v_cvt_pk_bf16_f32 v167, v42, v43
v_or3_b32 v44, v44, v164, v165
v_or3_b32 v44, v44, v166, v167
v_and_b32 v44, 0x40004000, v44
v_cmp_ne_u32 vcc, 0, v44
s_nop 1
s_cbranch_vccnz L_rare_15
L_rare_15_ret:
s_waitcnt vmcnt(4)
s_barrier
s_mov_b32 s94, 7
L_A_loop:
ds_read_b128 v[188:191], v16 offset:24576
ds_read_b128 v[192:195], v17 offset:24576
ds_read_b128 v[196:199], v18 offset:24576
ds_read_b128 v[200:203], v19 offset:24576
s_waitcnt lgkmcnt(2)
v_mfma_f32_16x16x32_bf16 v[88:91], v[188:191], a[160:163], v[168:171]
ds_read_b128 v[204:207], v16 offset:28672
v_mfma_f32_16x16x32_bf16 v[92:95], v[188:191], a[164:167], v[172:175]
v_exp_f32 v36, v48
v_mfma_f32_16x16x32_bf16 v[96:99], v[188:191], a[168:171], v[176:179]
v_mfma_f32_16x16x32_bf16 v[100:103], v[188:191], a[172:175], v[180:183]
v_exp_f32 v37, v49
v_mfma_f32_16x16x32_bf16 v[104:107], v[188:191], a[176:179], v[184:187]
v_mfma_f32_16x16x32_bf16 v[88:91], v[192:195], a[180:183], v[88:91]
ds_read_b128 v[208:211], v17 offset:28672
s_add_u32 m0, s97, 16384
v_mfma_f32_16x16x32_bf16 v[92:95], v[192:195], a[184:187], v[92:95]
buffer_load_dwordx4 v28, s[8:11], s95 offen nt lds
v_mfma_f32_16x16x32_bf16 v[96:99], v[192:195], a[188:191], v[96:99]
v_exp_f32 v38, v50
v_mfma_f32_16x16x32_bf16 v[100:103], v[192:195], a[192:195], v[100:103]
buffer_load_dwordx4 v29, s[8:11], s95 offen offset:1024 nt lds
v_mfma_f32_16x16x32_bf16 v[104:107], v[192:195], a[196:199], v[104:107]
s_add_u32 s95, s95, 8192
s_waitcnt lgkmcnt(2)
v_mfma_f32_16x16x32_bf16 v[88:91], v[196:199], a[200:203], v[88:91]
ds_read_b128 v[212:215], v18 offset:28672
v_mfma_f32_16x16x32_bf16 v[92:95], v[196:199], a[204:207], v[92:95]
v_mfma_f32_16x16x32_bf16 v[96:99], v[196:199], a[208:211], v[96:99]
v_exp_f32 v39, v51
v_mfma_f32_16x16x32_bf16 v[100:103], v[196:199], a[212:215], v[100:103]
v_cvt_pk_bf16_f32 v128, v36, v37
v_mfma_f32_16x16x32_bf16 v[104:107], v[196:199], a[216:219], v[104:107]
v_cvt_pk_bf16_f32 v129, v38, v39
v_mfma_f32_16x16x32_bf16 v[88:91], v[200:203], a[220:223], v[88:91]
ds_read_b128 v[216:219], v19 offset:28672
s_add_u32 m0, s97, 32768
v_mfma_f32_16x16x32_bf16 v[92:95], v[200:203], a[224:227], v[92:95]
buffer_load_dwordx4 v32, s[12:15], s96 offen nt lds
v_mfma_f32_16x16x32_bf16 v[96:99], v[200:203], a[228:231], v[96:99]
v_mfma_f32_16x16x32_bf16 v[100:103], v[200:203], a[232:235], v[100:103]
buffer_load_dwordx4 v33, s[12:15], s96 offen offset:1024 nt lds
v_mfma_f32_16x16x32_bf16 v[104:107], v[200:203], a[236:239], v[104:107]
s_add_u32 s96, s96, 8192
v_exp_f32 v40, v68
s_waitcnt lgkmcnt(2)
v_mfma_f32_16x16x32_bf16 v[108:111], v[204:207], a[160:163], v[168:171]
ds_read_b64_tr_b16 v[188:189], v20 offset:40960
v_mfma_f32_16x16x32_bf16 v[112:115], v[204:207], a[164:167], v[172:175]
ds_read_b64_tr_b16 v[190:191], v20 offset:45056
v_mfma_f32_16x16x32_bf16 v[116:119], v[204:207], a[168:171], v[176:179]
v_mfma_f32_16x16x32_bf16 v[120:123], v[204:207], a[172:175], v[180:183]
v_exp_f32 v41, v69
v_mfma_f32_16x16x32_bf16 v[124:127], v[204:207], a[176:179], v[184:187]
v_mfma_f32_16x16x32_bf16 v[108:111], v[208:211], a[180:183], v[108:111]
ds_read_b64_tr_b16 v[192:193], v21 offset:40960
v_exp_f32 v42, v70
v_mfma_f32_16x16x32_bf16 v[112:115], v[208:211], a[184:187], v[112:115]
ds_read_b64_tr_b16 v[194:195], v21 offset:45056
v_mfma_f32_16x16x32_bf16 v[116:119], v[208:211], a[188:191], v[116:119]
v_mfma_f32_16x16x32_bf16 v[120:123], v[208:211], a[192:195], v[120:123]
v_exp_f32 v43, v71
v_mfma_f32_16x16x32_bf16 v[124:127], v[208:211], a[196:199], v[124:127]
v_cvt_pk_bf16_f32 v130, v40, v41
s_waitcnt lgkmcnt(4)
v_mfma_f32_16x16x32_bf16 v[108:111], v[212:215], a[200:203], v[108:111]
ds_read_b64_tr_b16 v[196:197], v22 offset:40960
v_mfma_f32_16x16x32_bf16 v[112:115], v[212:215], a[204:207], v[112:115]
ds_read_b64_tr_b16 v[198:199], v22 offset:45056
v_mfma_f32_16x16x32_bf16 v[116:119], v[212:215], a[208:211], v[116:119]
v_cvt_pk_bf16_f32 v131, v42, v43
v_mfma_f32_16x16x32_bf16 v[120:123], v[212:215], a[212:215], v[120:123]
v_or_b32 v44, v128, v129
v_mfma_f32_16x16x32_bf16 v[124:127], v[212:215], a[216:219], v[124:127]
v_or3_b32 v44, v44, v130, v131
v_mfma_f32_16x16x32_bf16 v[108:111], v[216:219], a[220:223], v[108:111]
ds_read_b64_tr_b16 v[200:201], v23 offset:40960
v_mfma_f32_16x16x32_bf16 v[112:115], v[216:219], a[224:227], v[112:115]
ds_read_b64_tr_b16 v[202:203], v23 offset:45056
v_exp_f32 v36, v52
v_mfma_f32_16x16x32_bf16 v[116:119], v[216:219], a[228:231], v[116:119]
v_mfma_f32_16x16x32_bf16 v[120:123], v[216:219], a[232:235], v[120:123]
v_mfma_f32_16x16x32_bf16 v[124:127], v[216:219], a[236:239], v[124:127]
v_exp_f32 v37, v53
s_waitcnt lgkmcnt(4)
v_mfma_f32_16x16x32_bf16 a[0:3], v[188:191], v[148:151], a[0:3]
ds_read_b64_tr_b16 v[204:205], v24 offset:40960
v_mfma_f32_16x16x32_bf16 a[4:7], v[188:191], v[152:155], a[4:7]
ds_read_b64_tr_b16 v[206:207], v24 offset:45056
v_mfma_f32_16x16x32_bf16 a[8:11], v[188:191], v[156:159], a[8:11]
v_exp_f32 v38, v54
v_mfma_f32_16x16x32_bf16 a[12:15], v[188:191], v[160:163], a[12:15]
v_mfma_f32_16x16x32_bf16 a[16:19], v[188:191], v[164:167], a[16:19]
v_exp_f32 v39, v55
v_mfma_f32_16x16x32_bf16 a[20:23], v[192:195], v[148:151], a[20:23]
ds_read_b64_tr_b16 v[208:209], v25 offset:40960
v_mfma_f32_16x16x32_bf16 a[24:27], v[192:195], v[152:155], a[24:27]
ds_read_b64_tr_b16 v[210:211], v25 offset:45056
v_cvt_pk_bf16_f32 v132, v36, v37
v_mfma_f32_16x16x32_bf16 a[28:31], v[192:195], v[156:159], a[28:31]
v_mfma_f32_16x16x32_bf16 a[32:35], v[192:195], v[160:163], a[32:35]
v_cvt_pk_bf16_f32 v133, v38, v39
v_mfma_f32_16x16x32_bf16 a[36:39], v[192:195], v[164:167], a[36:39]
v_exp_f32 v40, v72
s_waitcnt lgkmcnt(4)
v_mfma_f32_16x16x32_bf16 a[40:43], v[196:199], v[148:151], a[40:43]
ds_read_b64_tr_b16 v[212:213], v26 offset:40960
v_mfma_f32_16x16x32_bf16 a[44:47], v[196:199], v[152:155], a[44:47]
ds_read_b64_tr_b16 v[214:215], v26 offset:45056
v_mfma_f32_16x16x32_bf16 a[48:51], v[196:199], v[156:159], a[48:51]
v_exp_f32 v41, v73
v_mfma_f32_16x16x32_bf16 a[52:55], v[196:199], v[160:163], a[52:55]
v_mfma_f32_16x16x32_bf16 a[56:59], v[196:199], v[164:167], a[56:59]
v_exp_f32 v42, v74
v_mfma_f32_16x16x32_bf16 a[60:63], v[200:203], v[148:151], a[60:63]
ds_read_b64_tr_b16 v[216:217], v27 offset:40960
v_mfma_f32_16x16x32_bf16 a[64:67], v[200:203], v[152:155], a[64:67]
ds_read_b64_tr_b16 v[218:219], v27 offset:45056
v_mfma_f32_16x16x32_bf16 a[68:71], v[200:203], v[156:159], a[68:71]
v_mfma_f32_16x16x32_bf16 a[72:75], v[200:203], v[160:163], a[72:75]
v_exp_f32 v43, v75
v_mfma_f32_16x16x32_bf16 a[76:79], v[200:203], v[164:167], a[76:79]
v_cvt_pk_bf16_f32 v134, v40, v41
s_waitcnt lgkmcnt(4)
v_mfma_f32_16x16x32_bf16 a[80:83], v[204:207], v[148:151], a[80:83]
v_cvt_pk_bf16_f32 v135, v42, v43
v_mfma_f32_16x16x32_bf16 a[84:87], v[204:207], v[152:155], a[84:87]
v_or3_b32 v44, v44, v132, v133
v_mfma_f32_16x16x32_bf16 a[88:91], v[204:207], v[156:159], a[88:91]
v_mfma_f32_16x16x32_bf16 a[92:95], v[204:207], v[160:163], a[92:95]
v_or3_b32 v44, v44, v134, v135
v_mfma_f32_16x16x32_bf16 a[96:99], v[204:207], v[164:167], a[96:99]
v_exp_f32 v36, v56
v_mfma_f32_16x16x32_bf16 a[100:103], v[208:211], v[148:151], a[100:103]
v_mfma_f32_16x16x32_bf16 a[104:107], v[208:211], v[152:155], a[104:107]
v_exp_f32 v37, v57
v_mfma_f32_16x16x32_bf16 a[108:111], v[208:211], v[156:159], a[108:111]
v_mfma_f32_16x16x32_bf16 a[112:115], v[208:211], v[160:163], a[112:115]
v_exp_f32 v38, v58
v_mfma_f32_16x16x32_bf16 a[116:119], v[208:211], v[164:167], a[116:119]
s_waitcnt lgkmcnt(0)
v_mfma_f32_16x16x32_bf16 a[120:123], v[212:215], v[148:151], a[120:123]
v_mfma_f32_16x16x32_bf16 a[124:127], v[212:215], v[152:155], a[124:127]
v_exp_f32 v39, v59
v_mfma_f32_16x16x32_bf16 a[128:131], v[212:215], v[156:159], a[128:131]
v_cvt_pk_bf16_f32 v136, v36, v37
v_mfma_f32_16x16x32_bf16 a[132:135], v[212:215], v[160:163], a[132:135]
v_cvt_pk_bf16_f32 v137, v38, v39
v_mfma_f32_16x16x32_bf16 a[136:139], v[212:215], v[164:167], a[136:139]
v_mfma_f32_16x16x32_bf16 a[140:143], v[216:219], v[148:151], a[140:143]
v_exp_f32 v40, v76
v_mfma_f32_16x16x32_bf16 a[144:147], v[216:219], v[152:155], a[144:147]
v_mfma_f32_16x16x32_bf16 a[148:151], v[216:219], v[156:159], a[148:151]
v_exp_f32 v41, v77
v_mfma_f32_16x16x32_bf16 a[152:155], v[216:219], v[160:163], a[152:155]
v_mfma_f32_16x16x32_bf16 a[156:159], v[216:219], v[164:167], a[156:159]
v_exp_f32 v42, v78
v_mfma_f32_16x16x32_bf16 v[220:223], v[240:243], v[148:151], v[220:223]
v_mfma_f32_16x16x32_bf16 v[224:227], v[240:243], v[152:155], v[224:227]
v_exp_f32 v43, v79
v_mfma_f32_16x16x32_bf16 v[228:231], v[240:243], v[156:159], v[228:231]
v_mfma_f32_16x16x32_bf16 v[232:235], v[240:243], v[160:163], v[232:235]
v_mfma_f32_16x16x32_bf16 v[236:239], v[240:243], v[164:167], v[236:239]
v_cvt_pk_bf16_f32 v138, v40, v41
v_cvt_pk_bf16_f32 v139, v42, v43
v_or3_b32 v44, v44, v136, v137
v_or3_b32 v44, v44, v138, v139
v_exp_f32 v36, v60
v_exp_f32 v37, v61
v_exp_f32 v38, v62
v_exp_f32 v39, v63
v_cvt_pk_bf16_f32 v140, v36, v37
v_cvt_pk_bf16_f32 v141, v38, v39
v_exp_f32 v40, v80
v_exp_f32 v41, v81
v_exp_f32 v42, v82
v_exp_f32 v43, v83
v_cvt_pk_bf16_f32 v142, v40, v41
v_cvt_pk_bf16_f32 v143, v42, v43
v_or3_b32 v44, v44, v140, v141
v_or3_b32 v44, v44, v142, v143
v_exp_f32 v36, v64
v_exp_f32 v37, v65
v_exp_f32 v38, v66
v_exp_f32 v39, v67
v_cvt_pk_bf16_f32 v144, v36, v37
v_cvt_pk_bf16_f32 v145, v38, v39
v_exp_f32 v40, v84
v_exp_f32 v41, v85
v_exp_f32 v42, v86
v_exp_f32 v43, v87
v_cvt_pk_bf16_f32 v146, v40, v41
v_cvt_pk_bf16_f32 v147, v42, v43
v_or3_b32 v44, v44, v144, v145
v_or3_b32 v44, v44, v146, v147
v_and_b32 v44, 0x40004000, v44
v_cmp_ne_u32 vcc, 0, v44
s_nop 1
s_cbranch_vccnz L_rare_16
L_rare_16_ret:
s_waitcnt vmcnt(4)
s_barrier
ds_read_b128 v[188:191], v16 offset:0
ds_read_b128 v[192:195], v17 offset:0
ds_read_b128 v[196:199], v18 offset:0
ds_read_b128 v[200:203], v19 offset:0
s_waitcnt lgkmcnt(2)
v_mfma_f32_16x16x32_bf16 v[48:51], v[188:191], a[160:163], v[168:171]
ds_read_b128 v[204:207], v16 offset:4096
v_mfma_f32_16x16x32_bf16 v[52:55], v[188:191], a[164:167], v[172:175]
v_exp_f32 v36, v88
v_mfma_f32_16x16x32_bf16 v[56:59], v[188:191], a[168:171], v[176:179]
v_mfma_f32_16x16x32_bf16 v[60:63], v[188:191], a[172:175], v[180:183]
v_exp_f32 v37, v89
v_mfma_f32_16x16x32_bf16 v[64:67], v[188:191], a[176:179], v[184:187]
v_mfma_f32_16x16x32_bf16 v[48:51], v[192:195], a[180:183], v[48:51]
ds_read_b128 v[208:211], v17 offset:4096
s_add_u32 m0, s97, 24576
v_mfma_f32_16x16x32_bf16 v[52:55], v[192:195], a[184:187], v[52:55]
buffer_load_dwordx4 v28, s[8:11], s95 offen nt lds
v_mfma_f32_16x16x32_bf16 v[56:59], v[192:195], a[188:191], v[56:59]
v_exp_f32 v38, v90
v_mfma_f32_16x16x32_bf16 v[60:63], v[192:195], a[192:195], v[60:63]
buffer_load_dwordx4 v29, s[8:11], s95 offen offset:1024 nt lds
v_mfma_f32_16x16x32_bf16 v[64:67], v[192:195], a[196:199], v[64:67]
s_add_u32 s95, s95, 8192
s_waitcnt lgkmcnt(2)
v_mfma_f32_16x16x32_bf16 v[48:51], v[196:199], a[200:203], v[48:51]
ds_read_b128 v[212:215], v18 offset:4096
v_mfma_f32_16x16x32_bf16 v[52:55], v[196:199], a[204:207], v[52:55]
v_mfma_f32_16x16x32_bf16 v[56:59], v[196:199], a[208:211], v[56:59]
v_exp_f32 v39, v91
v_mfma_f32_16x16x32_bf16 v[60:63], v[196:199], a[212:215], v[60:63]
v_cvt_pk_bf16_f32 v148, v36, v37
v_mfma_f32_16x16x32_bf16 v[64:67], v[196:199], a[216:219], v[64:67]
v_cvt_pk_bf16_f32 v149, v38, v39
v_mfma_f32_16x16x32_bf16 v[48:51], v[200:203], a[220:223], v[48:51]
ds_read_b128 v[216:219], v19 offset:4096
s_add_u32 m0, s97, 40960
v_mfma_f32_16x16x32_bf16 v[52:55], v[200:203], a[224:227], v[52:55]
buffer_load_dwordx4 v32, s[12:15], s96 offen nt lds
v_mfma_f32_16x16x32_bf16 v[56:59], v[200:203], a[228:231], v[56:59]
v_mfma_f32_16x16x32_bf16 v[60:63], v[200:203], a[232:235], v[60:63]
buffer_load_dwordx4 v33, s[12:15], s96 offen offset:1024 nt lds
v_mfma_f32_16x16x32_bf16 v[64:67], v[200:203], a[236:239], v[64:67]
s_add_u32 s96, s96, 8192
v_exp_f32 v40, v108
s_waitcnt lgkmcnt(2)
v_mfma_f32_16x16x32_bf16 v[68:71], v[204:207], a[160:163], v[168:171]
ds_read_b64_tr_b16 v[188:189], v20 offset:49152
v_mfma_f32_16x16x32_bf16 v[72:75], v[204:207], a[164:167], v[172:175]
ds_read_b64_tr_b16 v[190:191], v20 offset:53248
v_mfma_f32_16x16x32_bf16 v[76:79], v[204:207], a[168:171], v[176:179]
v_mfma_f32_16x16x32_bf16 v[80:83], v[204:207], a[172:175], v[180:183]
v_exp_f32 v41, v109
v_mfma_f32_16x16x32_bf16 v[84:87], v[204:207], a[176:179], v[184:187]
v_mfma_f32_16x16x32_bf16 v[68:71], v[208:211], a[180:183], v[68:71]
ds_read_b64_tr_b16 v[192:193], v21 offset:49152
v_exp_f32 v42, v110
v_mfma_f32_16x16x32_bf16 v[72:75], v[208:211], a[184:187], v[72:75]
ds_read_b64_tr_b16 v[194:195], v21 offset:53248
v_mfma_f32_16x16x32_bf16 v[76:79], v[208:211], a[188:191], v[76:79]
v_mfma_f32_16x16x32_bf16 v[80:83], v[208:211], a[192:195], v[80:83]
v_exp_f32 v43, v111
v_mfma_f32_16x16x32_bf16 v[84:87], v[208:211], a[196:199], v[84:87]
v_cvt_pk_bf16_f32 v150, v40, v41
s_waitcnt lgkmcnt(4)
v_mfma_f32_16x16x32_bf16 v[68:71], v[212:215], a[200:203], v[68:71]
ds_read_b64_tr_b16 v[196:197], v22 offset:49152
v_mfma_f32_16x16x32_bf16 v[72:75], v[212:215], a[204:207], v[72:75]
ds_read_b64_tr_b16 v[198:199], v22 offset:53248
v_mfma_f32_16x16x32_bf16 v[76:79], v[212:215], a[208:211], v[76:79]
v_cvt_pk_bf16_f32 v151, v42, v43
v_mfma_f32_16x16x32_bf16 v[80:83], v[212:215], a[212:215], v[80:83]
v_or_b32 v44, v148, v149
v_mfma_f32_16x16x32_bf16 v[84:87], v[212:215], a[216:219], v[84:87]
v_or3_b32 v44, v44, v150, v151
v_mfma_f32_16x16x32_bf16 v[68:71], v[216:219], a[220:223], v[68:71]
ds_read_b64_tr_b16 v[200:201], v23 offset:49152
v_mfma_f32_16x16x32_bf16 v[72:75], v[216:219], a[224:227], v[72:75]
ds_read_b64_tr_b16 v[202:203], v23 offset:53248
v_exp_f32 v36, v92
v_mfma_f32_16x16x32_bf16 v[76:79], v[216:219], a[228:231], v[76:79]
v_mfma_f32_16x16x32_bf16 v[80:83], v[216:219], a[232:235], v[80:83]
v_mfma_f32_16x16x32_bf16 v[84:87], v[216:219], a[236:239], v[84:87]
v_exp_f32 v37, v93
s_waitcnt lgkmcnt(4)
v_mfma_f32_16x16x32_bf16 a[0:3], v[188:191], v[128:131], a[0:3]
ds_read_b64_tr_b16 v[204:205], v24 offset:49152
v_mfma_f32_16x16x32_bf16 a[4:7], v[188:191], v[132:135], a[4:7]
ds_read_b64_tr_b16 v[206:207], v24 offset:53248
v_mfma_f32_16x16x32_bf16 a[8:11], v[188:191], v[136:139], a[8:11]
v_exp_f32 v38, v94
v_mfma_f32_16x16x32_bf16 a[12:15], v[188:191], v[140:143], a[12:15]
v_mfma_f32_16x16x32_bf16 a[16:19], v[188:191], v[144:147], a[16:19]
v_exp_f32 v39, v95
v_mfma_f32_16x16x32_bf16 a[20:23], v[192:195], v[128:131], a[20:23]
ds_read_b64_tr_b16 v[208:209], v25 offset:49152
v_mfma_f32_16x16x32_bf16 a[24:27], v[192:195], v[132:135], a[24:27]
ds_read_b64_tr_b16 v[210:211], v25 offset:53248
v_cvt_pk_bf16_f32 v152, v36, v37
v_mfma_f32_16x16x32_bf16 a[28:31], v[192:195], v[136:139], a[28:31]
v_mfma_f32_16x16x32_bf16 a[32:35], v[192:195], v[140:143], a[32:35]
v_cvt_pk_bf16_f32 v153, v38, v39
v_mfma_f32_16x16x32_bf16 a[36:39], v[192:195], v[144:147], a[36:39]
v_exp_f32 v40, v112
s_waitcnt lgkmcnt(4)
v_mfma_f32_16x16x32_bf16 a[40:43], v[196:199], v[128:131], a[40:43]
ds_read_b64_tr_b16 v[212:213], v26 offset:49152
v_mfma_f32_16x16x32_bf16 a[44:47], v[196:199], v[132:135], a[44:47]
ds_read_b64_tr_b16 v[214:215], v26 offset:53248
v_mfma_f32_16x16x32_bf16 a[48:51], v[196:199], v[136:139], a[48:51]
v_exp_f32 v41, v113
v_mfma_f32_16x16x32_bf16 a[52:55], v[196:199], v[140:143], a[52:55]
v_mfma_f32_16x16x32_bf16 a[56:59], v[196:199], v[144:147], a[56:59]
v_exp_f32 v42, v114
v_mfma_f32_16x16x32_bf16 a[60:63], v[200:203], v[128:131], a[60:63]
ds_read_b64_tr_b16 v[216:217], v27 offset:49152
v_mfma_f32_16x16x32_bf16 a[64:67], v[200:203], v[132:135], a[64:67]
ds_read_b64_tr_b16 v[218:219], v27 offset:53248
v_mfma_f32_16x16x32_bf16 a[68:71], v[200:203], v[136:139], a[68:71]
v_mfma_f32_16x16x32_bf16 a[72:75], v[200:203], v[140:143], a[72:75]
v_exp_f32 v43, v115
v_mfma_f32_16x16x32_bf16 a[76:79], v[200:203], v[144:147], a[76:79]
v_cvt_pk_bf16_f32 v154, v40, v41
s_waitcnt lgkmcnt(4)
v_mfma_f32_16x16x32_bf16 a[80:83], v[204:207], v[128:131], a[80:83]
v_cvt_pk_bf16_f32 v155, v42, v43
v_mfma_f32_16x16x32_bf16 a[84:87], v[204:207], v[132:135], a[84:87]
v_or3_b32 v44, v44, v152, v153
v_mfma_f32_16x16x32_bf16 a[88:91], v[204:207], v[136:139], a[88:91]
v_mfma_f32_16x16x32_bf16 a[92:95], v[204:207], v[140:143], a[92:95]
v_or3_b32 v44, v44, v154, v155
v_mfma_f32_16x16x32_bf16 a[96:99], v[204:207], v[144:147], a[96:99]
v_exp_f32 v36, v96
v_mfma_f32_16x16x32_bf16 a[100:103], v[208:211], v[128:131], a[100:103]
v_mfma_f32_16x16x32_bf16 a[104:107], v[208:211], v[132:135], a[104:107]
v_exp_f32 v37, v97
v_mfma_f32_16x16x32_bf16 a[108:111], v[208:211], v[136:139], a[108:111]
v_mfma_f32_16x16x32_bf16 a[112:115], v[208:211], v[140:143], a[112:115]
v_exp_f32 v38, v98
v_mfma_f32_16x16x32_bf16 a[116:119], v[208:211], v[144:147], a[116:119]
s_waitcnt lgkmcnt(0)
v_mfma_f32_16x16x32_bf16 a[120:123], v[212:215], v[128:131], a[120:123]
v_mfma_f32_16x16x32_bf16 a[124:127], v[212:215], v[132:135], a[124:127]
v_exp_f32 v39, v99
v_mfma_f32_16x16x32_bf16 a[128:131], v[212:215], v[136:139], a[128:131]
v_cvt_pk_bf16_f32 v156, v36, v37
v_mfma_f32_16x16x32_bf16 a[132:135], v[212:215], v[140:143], a[132:135]
v_cvt_pk_bf16_f32 v157, v38, v39
v_mfma_f32_16x16x32_bf16 a[136:139], v[212:215], v[144:147], a[136:139]
v_mfma_f32_16x16x32_bf16 a[140:143], v[216:219], v[128:131], a[140:143]
v_exp_f32 v40, v116
v_mfma_f32_16x16x32_bf16 a[144:147], v[216:219], v[132:135], a[144:147]
v_mfma_f32_16x16x32_bf16 a[148:151], v[216:219], v[136:139], a[148:151]
v_exp_f32 v41, v117
v_mfma_f32_16x16x32_bf16 a[152:155], v[216:219], v[140:143], a[152:155]
v_mfma_f32_16x16x32_bf16 a[156:159], v[216:219], v[144:147], a[156:159]
v_exp_f32 v42, v118
v_mfma_f32_16x16x32_bf16 v[220:223], v[240:243], v[128:131], v[220:223]
v_mfma_f32_16x16x32_bf16 v[224:227], v[240:243], v[132:135], v[224:227]
v_exp_f32 v43, v119
v_mfma_f32_16x16x32_bf16 v[228:231], v[240:243], v[136:139], v[228:231]
v_mfma_f32_16x16x32_bf16 v[232:235], v[240:243], v[140:143], v[232:235]
v_mfma_f32_16x16x32_bf16 v[236:239], v[240:243], v[144:147], v[236:239]
v_cvt_pk_bf16_f32 v158, v40, v41
v_cvt_pk_bf16_f32 v159, v42, v43
v_or3_b32 v44, v44, v156, v157
v_or3_b32 v44, v44, v158, v159
v_exp_f32 v36, v100
v_exp_f32 v37, v101
v_exp_f32 v38, v102
v_exp_f32 v39, v103
v_cvt_pk_bf16_f32 v160, v36, v37
v_cvt_pk_bf16_f32 v161, v38, v39
v_exp_f32 v40, v120
v_exp_f32 v41, v121
v_exp_f32 v42, v122
v_exp_f32 v43, v123
v_cvt_pk_bf16_f32 v162, v40, v41
v_cvt_pk_bf16_f32 v163, v42, v43
v_or3_b32 v44, v44, v160, v161
v_or3_b32 v44, v44, v162, v163
v_exp_f32 v36, v104
v_exp_f32 v37, v105
v_exp_f32 v38, v106
v_exp_f32 v39, v107
v_cvt_pk_bf16_f32 v164, v36, v37
v_cvt_pk_bf16_f32 v165, v38, v39
v_exp_f32 v40, v124
v_exp_f32 v41, v125
v_exp_f32 v42, v126
v_exp_f32 v43, v127
v_cvt_pk_bf16_f32 v166, v40, v41
v_cvt_pk_bf16_f32 v167, v42, v43
v_or3_b32 v44, v44, v164, v165
v_or3_b32 v44, v44, v166, v167
v_and_b32 v44, 0x40004000, v44
v_cmp_ne_u32 vcc, 0, v44
s_nop 1
s_cbranch_vccnz L_rare_17
L_rare_17_ret:
s_waitcnt vmcnt(4)
s_barrier
ds_read_b128 v[188:191], v16 offset:8192
ds_read_b128 v[192:195], v17 offset:8192
ds_read_b128 v[196:199], v18 offset:8192
ds_read_b128 v[200:203], v19 offset:8192
s_waitcnt lgkmcnt(2)
v_mfma_f32_16x16x32_bf16 v[88:91], v[188:191], a[160:163], v[168:171]
ds_read_b128 v[204:207], v16 offset:12288
v_mfma_f32_16x16x32_bf16 v[92:95], v[188:191], a[164:167], v[172:175]
v_exp_f32 v36, v48
v_mfma_f32_16x16x32_bf16 v[96:99], v[188:191], a[168:171], v[176:179]
v_mfma_f32_16x16x32_bf16 v[100:103], v[188:191], a[172:175], v[180:183]
v_exp_f32 v37, v49
v_mfma_f32_16x16x32_bf16 v[104:107], v[188:191], a[176:179], v[184:187]
v_mfma_f32_16x16x32_bf16 v[88:91], v[192:195], a[180:183], v[88:91]
ds_read_b128 v[208:211], v17 offset:12288
s_add_u32 m0, s97, 0
v_mfma_f32_16x16x32_bf16 v[92:95], v[192:195], a[184:187], v[92:95]
buffer_load_dwordx4 v28, s[8:11], s95 offen nt lds
v_mfma_f32_16x16x32_bf16 v[96:99], v[192:195], a[188:191], v[96:99]
v_exp_f32 v38, v50
v_mfma_f32_16x16x32_bf16 v[100:103], v[192:195], a[192:195], v[100:103]
buffer_load_dwordx4 v29, s[8:11], s95 offen offset:1024 nt lds
v_mfma_f32_16x16x32_bf16 v[104:107], v[192:195], a[196:199], v[104:107]
s_add_u32 s95, s95, 8192
s_waitcnt lgkmcnt(2)
v_mfma_f32_16x16x32_bf16 v[88:91], v[196:199], a[200:203], v[88:91]
ds_read_b128 v[212:215], v18 offset:12288
v_mfma_f32_16x16x32_bf16 v[92:95], v[196:199], a[204:207], v[92:95]
v_mfma_f32_16x16x32_bf16 v[96:99], v[196:199], a[208:211], v[96:99]
v_exp_f32 v39, v51
v_mfma_f32_16x16x32_bf16 v[100:103], v[196:199], a[212:215], v[100:103]
v_cvt_pk_bf16_f32 v128, v36, v37
v_mfma_f32_16x16x32_bf16 v[104:107], v[196:199], a[216:219], v[104:107]
v_cvt_pk_bf16_f32 v129, v38, v39
v_mfma_f32_16x16x32_bf16 v[88:91], v[200:203], a[220:223], v[88:91]
ds_read_b128 v[216:219], v19 offset:12288
s_add_u32 m0, s97, 49152
v_mfma_f32_16x16x32_bf16 v[92:95], v[200:203], a[224:227], v[92:95]
buffer_load_dwordx4 v32, s[12:15], s96 offen nt lds
v_mfma_f32_16x16x32_bf16 v[96:99], v[200:203], a[228:231], v[96:99]
v_mfma_f32_16x16x32_bf16 v[100:103], v[200:203], a[232:235], v[100:103]
buffer_load_dwordx4 v33, s[12:15], s96 offen offset:1024 nt lds
v_mfma_f32_16x16x32_bf16 v[104:107], v[200:203], a[236:239], v[104:107]
s_add_u32 s96, s96, 8192
v_exp_f32 v40, v68
s_waitcnt lgkmcnt(2)
v_mfma_f32_16x16x32_bf16 v[108:111], v[204:207], a[160:163], v[168:171]
ds_read_b64_tr_b16 v[188:189], v20 offset:57344
v_mfma_f32_16x16x32_bf16 v[112:115], v[204:207], a[164:167], v[172:175]
ds_read_b64_tr_b16 v[190:191], v20 offset:61440
v_mfma_f32_16x16x32_bf16 v[116:119], v[204:207], a[168:171], v[176:179]
v_mfma_f32_16x16x32_bf16 v[120:123], v[204:207], a[172:175], v[180:183]
v_exp_f32 v41, v69
v_mfma_f32_16x16x32_bf16 v[124:127], v[204:207], a[176:179], v[184:187]
v_mfma_f32_16x16x32_bf16 v[108:111], v[208:211], a[180:183], v[108:111]
ds_read_b64_tr_b16 v[192:193], v21 offset:57344
v_exp_f32 v42, v70
v_mfma_f32_16x16x32_bf16 v[112:115], v[208:211], a[184:187], v[112:115]
ds_read_b64_tr_b16 v[194:195], v21 offset:61440
v_mfma_f32_16x16x32_bf16 v[116:119], v[208:211], a[188:191], v[116:119]
v_mfma_f32_16x16x32_bf16 v[120:123], v[208:211], a[192:195], v[120:123]
v_exp_f32 v43, v71
v_mfma_f32_16x16x32_bf16 v[124:127], v[208:211], a[196:199], v[124:127]
v_cvt_pk_bf16_f32 v130, v40, v41
s_waitcnt lgkmcnt(4)
v_mfma_f32_16x16x32_bf16 v[108:111], v[212:215], a[200:203], v[108:111]
ds_read_b64_tr_b16 v[196:197], v22 offset:57344
v_mfma_f32_16x16x32_bf16 v[112:115], v[212:215], a[204:207], v[112:115]
ds_read_b64_tr_b16 v[198:199], v22 offset:61440
v_mfma_f32_16x16x32_bf16 v[116:119], v[212:215], a[208:211], v[116:119]
v_cvt_pk_bf16_f32 v131, v42, v43
v_mfma_f32_16x16x32_bf16 v[120:123], v[212:215], a[212:215], v[120:123]
v_or_b32 v44, v128, v129
v_mfma_f32_16x16x32_bf16 v[124:127], v[212:215], a[216:219], v[124:127]
v_or3_b32 v44, v44, v130, v131
v_mfma_f32_16x16x32_bf16 v[108:111], v[216:219], a[220:223], v[108:111]
ds_read_b64_tr_b16 v[200:201], v23 offset:57344
v_mfma_f32_16x16x32_bf16 v[112:115], v[216:219], a[224:227], v[112:115]
ds_read_b64_tr_b16 v[202:203], v23 offset:61440
v_exp_f32 v36, v52
v_mfma_f32_16x16x32_bf16 v[116:119], v[216:219], a[228:231], v[116:119]
v_mfma_f32_16x16x32_bf16 v[120:123], v[216:219], a[232:235], v[120:123]
v_mfma_f32_16x16x32_bf16 v[124:127], v[216:219], a[236:239], v[124:127]
v_exp_f32 v37, v53
s_waitcnt lgkmcnt(4)
v_mfma_f32_16x16x32_bf16 a[0:3], v[188:191], v[148:151], a[0:3]
ds_read_b64_tr_b16 v[204:205], v24 offset:57344
v_mfma_f32_16x16x32_bf16 a[4:7], v[188:191], v[152:155], a[4:7]
ds_read_b64_tr_b16 v[206:207], v24 offset:61440
v_mfma_f32_16x16x32_bf16 a[8:11], v[188:191], v[156:159], a[8:11]
v_exp_f32 v38, v54
v_mfma_f32_16x16x32_bf16 a[12:15], v[188:191], v[160:163], a[12:15]
v_mfma_f32_16x16x32_bf16 a[16:19], v[188:191], v[164:167], a[16:19]
v_exp_f32 v39, v55
v_mfma_f32_16x16x32_bf16 a[20:23], v[192:195], v[148:151], a[20:23]
ds_read_b64_tr_b16 v[208:209], v25 offset:57344
v_mfma_f32_16x16x32_bf16 a[24:27], v[192:195], v[152:155], a[24:27]
ds_read_b64_tr_b16 v[210:211], v25 offset:61440
v_cvt_pk_bf16_f32 v132, v36, v37
v_mfma_f32_16x16x32_bf16 a[28:31], v[192:195], v[156:159], a[28:31]
v_mfma_f32_16x16x32_bf16 a[32:35], v[192:195], v[160:163], a[32:35]
v_cvt_pk_bf16_f32 v133, v38, v39
v_mfma_f32_16x16x32_bf16 a[36:39], v[192:195], v[164:167], a[36:39]
v_exp_f32 v40, v72
s_waitcnt lgkmcnt(4)
v_mfma_f32_16x16x32_bf16 a[40:43], v[196:199], v[148:151], a[40:43]
ds_read_b64_tr_b16 v[212:213], v26 offset:57344
v_mfma_f32_16x16x32_bf16 a[44:47], v[196:199], v[152:155], a[44:47]
ds_read_b64_tr_b16 v[214:215], v26 offset:61440
v_mfma_f32_16x16x32_bf16 a[48:51], v[196:199], v[156:159], a[48:51]
v_exp_f32 v41, v73
v_mfma_f32_16x16x32_bf16 a[52:55], v[196:199], v[160:163], a[52:55]
v_mfma_f32_16x16x32_bf16 a[56:59], v[196:199], v[164:167], a[56:59]
v_exp_f32 v42, v74
v_mfma_f32_16x16x32_bf16 a[60:63], v[200:203], v[148:151], a[60:63]
ds_read_b64_tr_b16 v[216:217], v27 offset:57344
v_mfma_f32_16x16x32_bf16 a[64:67], v[200:203], v[152:155], a[64:67]
ds_read_b64_tr_b16 v[218:219], v27 offset:61440
v_mfma_f32_16x16x32_bf16 a[68:71], v[200:203], v[156:159], a[68:71]
v_mfma_f32_16x16x32_bf16 a[72:75], v[200:203], v[160:163], a[72:75]
v_exp_f32 v43, v75
v_mfma_f32_16x16x32_bf16 a[76:79], v[200:203], v[164:167], a[76:79]
v_cvt_pk_bf16_f32 v134, v40, v41
s_waitcnt lgkmcnt(4)
v_mfma_f32_16x16x32_bf16 a[80:83], v[204:207], v[148:151], a[80:83]
v_cvt_pk_bf16_f32 v135, v42, v43
v_mfma_f32_16x16x32_bf16 a[84:87], v[204:207], v[152:155], a[84:87]
v_or3_b32 v44, v44, v132, v133
v_mfma_f32_16x16x32_bf16 a[88:91], v[204:207], v[156:159], a[88:91]
v_mfma_f32_16x16x32_bf16 a[92:95], v[204:207], v[160:163], a[92:95]
v_or3_b32 v44, v44, v134, v135
v_mfma_f32_16x16x32_bf16 a[96:99], v[204:207], v[164:167], a[96:99]
v_exp_f32 v36, v56
v_mfma_f32_16x16x32_bf16 a[100:103], v[208:211], v[148:151], a[100:103]
v_mfma_f32_16x16x32_bf16 a[104:107], v[208:211], v[152:155], a[104:107]
v_exp_f32 v37, v57
v_mfma_f32_16x16x32_bf16 a[108:111], v[208:211], v[156:159], a[108:111]
v_mfma_f32_16x16x32_bf16 a[112:115], v[208:211], v[160:163], a[112:115]
v_exp_f32 v38, v58
v_mfma_f32_16x16x32_bf16 a[116:119], v[208:211], v[164:167], a[116:119]
s_waitcnt lgkmcnt(0)
v_mfma_f32_16x16x32_bf16 a[120:123], v[212:215], v[148:151], a[120:123]
v_mfma_f32_16x16x32_bf16 a[124:127], v[212:215], v[152:155], a[124:127]
v_exp_f32 v39, v59
v_mfma_f32_16x16x32_bf16 a[128:131], v[212:215], v[156:159], a[128:131]
v_cvt_pk_bf16_f32 v136, v36, v37
v_mfma_f32_16x16x32_bf16 a[132:135], v[212:215], v[160:163], a[132:135]
v_cvt_pk_bf16_f32 v137, v38, v39
v_mfma_f32_16x16x32_bf16 a[136:139], v[212:215], v[164:167], a[136:139]
v_mfma_f32_16x16x32_bf16 a[140:143], v[216:219], v[148:151], a[140:143]
v_exp_f32 v40, v76
v_mfma_f32_16x16x32_bf16 a[144:147], v[216:219], v[152:155], a[144:147]
v_mfma_f32_16x16x32_bf16 a[148:151], v[216:219], v[156:159], a[148:151]
v_exp_f32 v41, v77
v_mfma_f32_16x16x32_bf16 a[152:155], v[216:219], v[160:163], a[152:155]
v_mfma_f32_16x16x32_bf16 a[156:159], v[216:219], v[164:167], a[156:159]
v_exp_f32 v42, v78
v_mfma_f32_16x16x32_bf16 v[220:223], v[240:243], v[148:151], v[220:223]
v_mfma_f32_16x16x32_bf16 v[224:227], v[240:243], v[152:155], v[224:227]
v_exp_f32 v43, v79
v_mfma_f32_16x16x32_bf16 v[228:231], v[240:243], v[156:159], v[228:231]
v_mfma_f32_16x16x32_bf16 v[232:235], v[240:243], v[160:163], v[232:235]
v_mfma_f32_16x16x32_bf16 v[236:239], v[240:243], v[164:167], v[236:239]
v_cvt_pk_bf16_f32 v138, v40, v41
v_cvt_pk_bf16_f32 v139, v42, v43
v_or3_b32 v44, v44, v136, v137
v_or3_b32 v44, v44, v138, v139
v_exp_f32 v36, v60
v_exp_f32 v37, v61
v_exp_f32 v38, v62
v_exp_f32 v39, v63
v_cvt_pk_bf16_f32 v140, v36, v37
v_cvt_pk_bf16_f32 v141, v38, v39
v_exp_f32 v40, v80
v_exp_f32 v41, v81
v_exp_f32 v42, v82
v_exp_f32 v43, v83
v_cvt_pk_bf16_f32 v142, v40, v41
v_cvt_pk_bf16_f32 v143, v42, v43
v_or3_b32 v44, v44, v140, v141
v_or3_b32 v44, v44, v142, v143
v_exp_f32 v36, v64
v_exp_f32 v37, v65
v_exp_f32 v38, v66
v_exp_f32 v39, v67
v_cvt_pk_bf16_f32 v144, v36, v37
v_cvt_pk_bf16_f32 v145, v38, v39
v_exp_f32 v40, v84
v_exp_f32 v41, v85
v_exp_f32 v42, v86
v_exp_f32 v43, v87
v_cvt_pk_bf16_f32 v146, v40, v41
v_cvt_pk_bf16_f32 v147, v42, v43
v_or3_b32 v44, v44, v144, v145
v_or3_b32 v44, v44, v146, v147
v_and_b32 v44, 0x40004000, v44
v_cmp_ne_u32 vcc, 0, v44
s_nop 1
s_cbranch_vccnz L_rare_18
L_rare_18_ret:
s_waitcnt vmcnt(4)
s_barrier
ds_read_b128 v[188:191], v16 offset:16384
ds_read_b128 v[192:195], v17 offset:16384
ds_read_b128 v[196:199], v18 offset:16384
ds_read_b128 v[200:203], v19 offset:16384
s_waitcnt lgkmcnt(2)
v_mfma_f32_16x16x32_bf16 v[48:51], v[188:191], a[160:163], v[168:171]
ds_read_b128 v[204:207], v16 offset:20480
v_mfma_f32_16x16x32_bf16 v[52:55], v[188:191], a[164:167], v[172:175]
v_exp_f32 v36, v88
v_mfma_f32_16x16x32_bf16 v[56:59], v[188:191], a[168:171], v[176:179]
v_mfma_f32_16x16x32_bf16 v[60:63], v[188:191], a[172:175], v[180:183]
v_exp_f32 v37, v89
v_mfma_f32_16x16x32_bf16 v[64:67], v[188:191], a[176:179], v[184:187]
v_mfma_f32_16x16x32_bf16 v[48:51], v[192:195], a[180:183], v[48:51]
ds_read_b128 v[208:211], v17 offset:20480
s_add_u32 m0, s97, 8192
v_mfma_f32_16x16x32_bf16 v[52:55], v[192:195], a[184:187], v[52:55]
buffer_load_dwordx4 v28, s[8:11], s95 offen nt lds
v_mfma_f32_16x16x32_bf16 v[56:59], v[192:195], a[188:191], v[56:59]
v_exp_f32 v38, v90
v_mfma_f32_16x16x32_bf16 v[60:63], v[192:195], a[192:195], v[60:63]
buffer_load_dwordx4 v29, s[8:11], s95 offen offset:1024 nt lds
v_mfma_f32_16x16x32_bf16 v[64:67], v[192:195], a[196:199], v[64:67]
s_add_u32 s95, s95, 8192
s_waitcnt lgkmcnt(2)
v_mfma_f32_16x16x32_bf16 v[48:51], v[196:199], a[200:203], v[48:51]
ds_read_b128 v[212:215], v18 offset:20480
v_mfma_f32_16x16x32_bf16 v[52:55], v[196:199], a[204:207], v[52:55]
v_mfma_f32_16x16x32_bf16 v[56:59], v[196:199], a[208:211], v[56:59]
v_exp_f32 v39, v91
v_mfma_f32_16x16x32_bf16 v[60:63], v[196:199], a[212:215], v[60:63]
v_cvt_pk_bf16_f32 v148, v36, v37
v_mfma_f32_16x16x32_bf16 v[64:67], v[196:199], a[216:219], v[64:67]
v_cvt_pk_bf16_f32 v149, v38, v39
v_mfma_f32_16x16x32_bf16 v[48:51], v[200:203], a[220:223], v[48:51]
ds_read_b128 v[216:219], v19 offset:20480
s_add_u32 m0, s97, 57344
v_mfma_f32_16x16x32_bf16 v[52:55], v[200:203], a[224:227], v[52:55]
buffer_load_dwordx4 v32, s[12:15], s96 offen nt lds
v_mfma_f32_16x16x32_bf16 v[56:59], v[200:203], a[228:231], v[56:59]
v_mfma_f32_16x16x32_bf16 v[60:63], v[200:203], a[232:235], v[60:63]
buffer_load_dwordx4 v33, s[12:15], s96 offen offset:1024 nt lds
v_mfma_f32_16x16x32_bf16 v[64:67], v[200:203], a[236:239], v[64:67]
s_add_u32 s96, s96, 8192
v_exp_f32 v40, v108
s_waitcnt lgkmcnt(2)
v_mfma_f32_16x16x32_bf16 v[68:71], v[204:207], a[160:163], v[168:171]
ds_read_b64_tr_b16 v[188:189], v20 offset:32768
v_mfma_f32_16x16x32_bf16 v[72:75], v[204:207], a[164:167], v[172:175]
ds_read_b64_tr_b16 v[190:191], v20 offset:36864
v_mfma_f32_16x16x32_bf16 v[76:79], v[204:207], a[168:171], v[176:179]
v_mfma_f32_16x16x32_bf16 v[80:83], v[204:207], a[172:175], v[180:183]
v_exp_f32 v41, v109
v_mfma_f32_16x16x32_bf16 v[84:87], v[204:207], a[176:179], v[184:187]
v_mfma_f32_16x16x32_bf16 v[68:71], v[208:211], a[180:183], v[68:71]
ds_read_b64_tr_b16 v[192:193], v21 offset:32768
v_exp_f32 v42, v110
v_mfma_f32_16x16x32_bf16 v[72:75], v[208:211], a[184:187], v[72:75]
ds_read_b64_tr_b16 v[194:195], v21 offset:36864
v_mfma_f32_16x16x32_bf16 v[76:79], v[208:211], a[188:191], v[76:79]
v_mfma_f32_16x16x32_bf16 v[80:83], v[208:211], a[192:195], v[80:83]
v_exp_f32 v43, v111
v_mfma_f32_16x16x32_bf16 v[84:87], v[208:211], a[196:199], v[84:87]
v_cvt_pk_bf16_f32 v150, v40, v41
s_waitcnt lgkmcnt(4)
v_mfma_f32_16x16x32_bf16 v[68:71], v[212:215], a[200:203], v[68:71]
ds_read_b64_tr_b16 v[196:197], v22 offset:32768
v_mfma_f32_16x16x32_bf16 v[72:75], v[212:215], a[204:207], v[72:75]
ds_read_b64_tr_b16 v[198:199], v22 offset:36864
v_mfma_f32_16x16x32_bf16 v[76:79], v[212:215], a[208:211], v[76:79]
v_cvt_pk_bf16_f32 v151, v42, v43
v_mfma_f32_16x16x32_bf16 v[80:83], v[212:215], a[212:215], v[80:83]
v_or_b32 v44, v148, v149
v_mfma_f32_16x16x32_bf16 v[84:87], v[212:215], a[216:219], v[84:87]
v_or3_b32 v44, v44, v150, v151
v_mfma_f32_16x16x32_bf16 v[68:71], v[216:219], a[220:223], v[68:71]
ds_read_b64_tr_b16 v[200:201], v23 offset:32768
v_mfma_f32_16x16x32_bf16 v[72:75], v[216:219], a[224:227], v[72:75]
ds_read_b64_tr_b16 v[202:203], v23 offset:36864
v_exp_f32 v36, v92
v_mfma_f32_16x16x32_bf16 v[76:79], v[216:219], a[228:231], v[76:79]
v_mfma_f32_16x16x32_bf16 v[80:83], v[216:219], a[232:235], v[80:83]
v_mfma_f32_16x16x32_bf16 v[84:87], v[216:219], a[236:239], v[84:87]
v_exp_f32 v37, v93
s_waitcnt lgkmcnt(4)
v_mfma_f32_16x16x32_bf16 a[0:3], v[188:191], v[128:131], a[0:3]
ds_read_b64_tr_b16 v[204:205], v24 offset:32768
v_mfma_f32_16x16x32_bf16 a[4:7], v[188:191], v[132:135], a[4:7]
ds_read_b64_tr_b16 v[206:207], v24 offset:36864
v_mfma_f32_16x16x32_bf16 a[8:11], v[188:191], v[136:139], a[8:11]
v_exp_f32 v38, v94
v_mfma_f32_16x16x32_bf16 a[12:15], v[188:191], v[140:143], a[12:15]
v_mfma_f32_16x16x32_bf16 a[16:19], v[188:191], v[144:147], a[16:19]
v_exp_f32 v39, v95
v_mfma_f32_16x16x32_bf16 a[20:23], v[192:195], v[128:131], a[20:23]
ds_read_b64_tr_b16 v[208:209], v25 offset:32768
v_mfma_f32_16x16x32_bf16 a[24:27], v[192:195], v[132:135], a[24:27]
ds_read_b64_tr_b16 v[210:211], v25 offset:36864
v_cvt_pk_bf16_f32 v152, v36, v37
v_mfma_f32_16x16x32_bf16 a[28:31], v[192:195], v[136:139], a[28:31]
v_mfma_f32_16x16x32_bf16 a[32:35], v[192:195], v[140:143], a[32:35]
v_cvt_pk_bf16_f32 v153, v38, v39
v_mfma_f32_16x16x32_bf16 a[36:39], v[192:195], v[144:147], a[36:39]
v_exp_f32 v40, v112
s_waitcnt lgkmcnt(4)
v_mfma_f32_16x16x32_bf16 a[40:43], v[196:199], v[128:131], a[40:43]
ds_read_b64_tr_b16 v[212:213], v26 offset:32768
v_mfma_f32_16x16x32_bf16 a[44:47], v[196:199], v[132:135], a[44:47]
ds_read_b64_tr_b16 v[214:215], v26 offset:36864
v_mfma_f32_16x16x32_bf16 a[48:51], v[196:199], v[136:139], a[48:51]
v_exp_f32 v41, v113
v_mfma_f32_16x16x32_bf16 a[52:55], v[196:199], v[140:143], a[52:55]
v_mfma_f32_16x16x32_bf16 a[56:59], v[196:199], v[144:147], a[56:59]
v_exp_f32 v42, v114
v_mfma_f32_16x16x32_bf16 a[60:63], v[200:203], v[128:131], a[60:63]
ds_read_b64_tr_b16 v[216:217], v27 offset:32768
v_mfma_f32_16x16x32_bf16 a[64:67], v[200:203], v[132:135], a[64:67]
ds_read_b64_tr_b16 v[218:219], v27 offset:36864
v_mfma_f32_16x16x32_bf16 a[68:71], v[200:203], v[136:139], a[68:71]
v_mfma_f32_16x16x32_bf16 a[72:75], v[200:203], v[140:143], a[72:75]
v_exp_f32 v43, v115
v_mfma_f32_16x16x32_bf16 a[76:79], v[200:203], v[144:147], a[76:79]
v_cvt_pk_bf16_f32 v154, v40, v41
s_waitcnt lgkmcnt(4)
v_mfma_f32_16x16x32_bf16 a[80:83], v[204:207], v[128:131], a[80:83]
v_cvt_pk_bf16_f32 v155, v42, v43
v_mfma_f32_16x16x32_bf16 a[84:87], v[204:207], v[132:135], a[84:87]
v_or3_b32 v44, v44, v152, v153
v_mfma_f32_16x16x32_bf16 a[88:91], v[204:207], v[136:139], a[88:91]
v_mfma_f32_16x16x32_bf16 a[92:95], v[204:207], v[140:143], a[92:95]
v_or3_b32 v44, v44, v154, v155
v_mfma_f32_16x16x32_bf16 a[96:99], v[204:207], v[144:147], a[96:99]
v_exp_f32 v36, v96
v_mfma_f32_16x16x32_bf16 a[100:103], v[208:211], v[128:131], a[100:103]
v_mfma_f32_16x16x32_bf16 a[104:107], v[208:211], v[132:135], a[104:107]
v_exp_f32 v37, v97
v_mfma_f32_16x16x32_bf16 a[108:111], v[208:211], v[136:139], a[108:111]
v_mfma_f32_16x16x32_bf16 a[112:115], v[208:211], v[140:143], a[112:115]
v_exp_f32 v38, v98
v_mfma_f32_16x16x32_bf16 a[116:119], v[208:211], v[144:147], a[116:119]
s_waitcnt lgkmcnt(0)
v_mfma_f32_16x16x32_bf16 a[120:123], v[212:215], v[128:131], a[120:123]
v_mfma_f32_16x16x32_bf16 a[124:127], v[212:215], v[132:135], a[124:127]
v_exp_f32 v39, v99
v_mfma_f32_16x16x32_bf16 a[128:131], v[212:215], v[136:139], a[128:131]
v_cvt_pk_bf16_f32 v156, v36, v37
v_mfma_f32_16x16x32_bf16 a[132:135], v[212:215], v[140:143], a[132:135]
v_cvt_pk_bf16_f32 v157, v38, v39
v_mfma_f32_16x16x32_bf16 a[136:139], v[212:215], v[144:147], a[136:139]
v_mfma_f32_16x16x32_bf16 a[140:143], v[216:219], v[128:131], a[140:143]
v_exp_f32 v40, v116
v_mfma_f32_16x16x32_bf16 a[144:147], v[216:219], v[132:135], a[144:147]
v_mfma_f32_16x16x32_bf16 a[148:151], v[216:219], v[136:139], a[148:151]
v_exp_f32 v41, v117
v_mfma_f32_16x16x32_bf16 a[152:155], v[216:219], v[140:143], a[152:155]
v_mfma_f32_16x16x32_bf16 a[156:159], v[216:219], v[144:147], a[156:159]
v_exp_f32 v42, v118
v_mfma_f32_16x16x32_bf16 v[220:223], v[240:243], v[128:131], v[220:223]
v_mfma_f32_16x16x32_bf16 v[224:227], v[240:243], v[132:135], v[224:227]
v_exp_f32 v43, v119
v_mfma_f32_16x16x32_bf16 v[228:231], v[240:243], v[136:139], v[228:231]
v_mfma_f32_16x16x32_bf16 v[232:235], v[240:243], v[140:143], v[232:235]
v_mfma_f32_16x16x32_bf16 v[236:239], v[240:243], v[144:147], v[236:239]
v_cvt_pk_bf16_f32 v158, v40, v41
v_cvt_pk_bf16_f32 v159, v42, v43
v_or3_b32 v44, v44, v156, v157
v_or3_b32 v44, v44, v158, v159
v_exp_f32 v36, v100
v_exp_f32 v37, v101
v_exp_f32 v38, v102
v_exp_f32 v39, v103
v_cvt_pk_bf16_f32 v160, v36, v37
v_cvt_pk_bf16_f32 v161, v38, v39
v_exp_f32 v40, v120
v_exp_f32 v41, v121
v_exp_f32 v42, v122
v_exp_f32 v43, v123
v_cvt_pk_bf16_f32 v162, v40, v41
v_cvt_pk_bf16_f32 v163, v42, v43
v_or3_b32 v44, v44, v160, v161
v_or3_b32 v44, v44, v162, v163
v_exp_f32 v36, v104
v_exp_f32 v37, v105
v_exp_f32 v38, v106
v_exp_f32 v39, v107
v_cvt_pk_bf16_f32 v164, v36, v37
v_cvt_pk_bf16_f32 v165, v38, v39
v_exp_f32 v40, v124
v_exp_f32 v41, v125
v_exp_f32 v42, v126
v_exp_f32 v43, v127
v_cvt_pk_bf16_f32 v166, v40, v41
v_cvt_pk_bf16_f32 v167, v42, v43
v_or3_b32 v44, v44, v164, v165
v_or3_b32 v44, v44, v166, v167
v_and_b32 v44, 0x40004000, v44
v_cmp_ne_u32 vcc, 0, v44
s_nop 1
s_cbranch_vccnz L_rare_19
L_rare_19_ret:
s_waitcnt vmcnt(4)
s_barrier
s_sub_u32 s94, s94, 1
s_cmp_lg_u32 s94, 0
s_cbranch_scc1 L_A_loop
ds_read_b128 v[188:191], v16 offset:24576
ds_read_b128 v[192:195], v17 offset:24576
ds_read_b128 v[196:199], v18 offset:24576
ds_read_b128 v[200:203], v19 offset:24576
s_waitcnt lgkmcnt(2)
v_mfma_f32_16x16x32_bf16 v[88:91], v[188:191], a[160:163], v[168:171]
ds_read_b128 v[204:207], v16 offset:28672
v_mfma_f32_16x16x32_bf16 v[92:95], v[188:191], a[164:167], v[172:175]
v_exp_f32 v36, v48
v_mfma_f32_16x16x32_bf16 v[96:99], v[188:191], a[168:171], v[176:179]
v_mfma_f32_16x16x32_bf16 v[100:103], v[188:191], a[172:175], v[180:183]
v_exp_f32 v37, v49
v_mfma_f32_16x16x32_bf16 v[104:107], v[188:191], a[176:179], v[184:187]
v_mfma_f32_16x16x32_bf16 v[88:91], v[192:195], a[180:183], v[88:91]
ds_read_b128 v[208:211], v17 offset:28672
s_cmp_gt_i32 s91, 0
s_cselect_b32 s92, s88, 0x7f000000
s_sub_u32 s91, s91, 1
s_add_u32 s88, s88, s89
s_and_b32 s88, s88, s90
s_add_u32 m0, s93, 0
v_mfma_f32_16x16x32_bf16 v[92:95], v[192:195], a[184:187], v[92:95]
buffer_load_dwordx4 v244, s[16:19], s92 offen offset:0 lds
v_mfma_f32_16x16x32_bf16 v[96:99], v[192:195], a[188:191], v[96:99]
v_exp_f32 v38, v50
v_mfma_f32_16x16x32_bf16 v[100:103], v[192:195], a[192:195], v[100:103]
v_mfma_f32_16x16x32_bf16 v[104:107], v[192:195], a[196:199], v[104:107]
buffer_load_dwordx4 v245, s[16:19], s92 offen offset:1024 lds
s_waitcnt lgkmcnt(2)
v_mfma_f32_16x16x32_bf16 v[88:91], v[196:199], a[200:203], v[88:91]
ds_read_b128 v[212:215], v18 offset:28672
v_mfma_f32_16x16x32_bf16 v[92:95], v[196:199], a[204:207], v[92:95]
v_exp_f32 v39, v51
v_mfma_f32_16x16x32_bf16 v[96:99], v[196:199], a[208:211], v[96:99]
buffer_load_dwordx4 v246, s[16:19], s92 offen offset:2048 lds
v_mfma_f32_16x16x32_bf16 v[100:103], v[196:199], a[212:215], v[100:103]
v_cvt_pk_bf16_f32 v128, v36, v37
v_mfma_f32_16x16x32_bf16 v[104:107], v[196:199], a[216:219], v[104:107]
v_cvt_pk_bf16_f32 v129, v38, v39
v_mfma_f32_16x16x32_bf16 v[88:91], v[200:203], a[220:223], v[88:91]
ds_read_b128 v[216:219], v19 offset:28672
buffer_load_dwordx4 v247, s[16:19], s92 offen offset:3072 lds
v_mfma_f32_16x16x32_bf16 v[92:95], v[200:203], a[224:227], v[92:95]
v_mfma_f32_16x16x32_bf16 v[96:99], v[200:203], a[228:231], v[96:99]
s_add_u32 m0, s93, 4096
v_mfma_f32_16x16x32_bf16 v[100:103], v[200:203], a[232:235], v[100:103]
buffer_load_dwordx4 v248, s[16:19], s92 offen offset:0 lds
v_mfma_f32_16x16x32_bf16 v[104:107], v[200:203], a[236:239], v[104:107]
v_exp_f32 v40, v68
s_waitcnt lgkmcnt(2)
v_mfma_f32_16x16x32_bf16 v[108:111], v[204:207], a[160:163], v[168:171]
ds_read_b64_tr_b16 v[188:189], v20 offset:40960
v_mfma_f32_16x16x32_bf16 v[112:115], v[204:207], a[164:167], v[172:175]
ds_read_b64_tr_b16 v[190:191], v20 offset:45056
buffer_load_dwordx4 v249, s[16:19], s92 offen offset:1024 lds
v_mfma_f32_16x16x32_bf16 v[116:119], v[204:207], a[168:171], v[176:179]
v_exp_f32 v41, v69
v_mfma_f32_16x16x32_bf16 v[120:123], v[204:207], a[172:175], v[180:183]
v_mfma_f32_16x16x32_bf16 v[124:127], v[204:207], a[176:179], v[184:187]
buffer_load_dwordx4 v250, s[16:19], s92 offen offset:2048 lds
v_mfma_f32_16x16x32_bf16 v[108:111], v[208:211], a[180:183], v[108:111]
ds_read_b64_tr_b16 v[192:193], v21 offset:40960
v_mfma_f32_16x16x32_bf16 v[112:115], v[208:211], a[184:187], v[112:115]
ds_read_b64_tr_b16 v[194:195], v21 offset:45056
v_exp_f32 v42, v70
v_mfma_f32_16x16x32_bf16 v[116:119], v[208:211], a[188:191], v[116:119]
buffer_load_dwordx4 v251, s[16:19], s92 offen offset:3072 lds
v_mfma_f32_16x16x32_bf16 v[120:123], v[208:211], a[192:195], v[120:123]
v_mfma_f32_16x16x32_bf16 v[124:127], v[208:211], a[196:199], v[124:127]
v_exp_f32 v43, v71
s_waitcnt lgkmcnt(4)
v_mfma_f32_16x16x32_bf16 v[108:111], v[212:215], a[200:203], v[108:111]
ds_read_b64_tr_b16 v[196:197], v22 offset:40960
v_mfma_f32_16x16x32_bf16 v[112:115], v[212:215], a[204:207], v[112:115]
ds_read_b64_tr_b16 v[198:199], v22 offset:45056
v_mfma_f32_16x16x32_bf16 v[116:119], v[212:215], a[208:211], v[116:119]
v_cvt_pk_bf16_f32 v130, v40, v41
v_mfma_f32_16x16x32_bf16 v[120:123], v[212:215], a[212:215], v[120:123]
v_cvt_pk_bf16_f32 v131, v42, v43
v_mfma_f32_16x16x32_bf16 v[124:127], v[212:215], a[216:219], v[124:127]
v_or_b32 v44, v128, v129
v_mfma_f32_16x16x32_bf16 v[108:111], v[216:219], a[220:223], v[108:111]
ds_read_b64_tr_b16 v[200:201], v23 offset:40960
v_mfma_f32_16x16x32_bf16 v[112:115], v[216:219], a[224:227], v[112:115]
ds_read_b64_tr_b16 v[202:203], v23 offset:45056
v_or3_b32 v44, v44, v130, v131
v_mfma_f32_16x16x32_bf16 v[116:119], v[216:219], a[228:231], v[116:119]
v_mfma_f32_16x16x32_bf16 v[120:123], v[216:219], a[232:235], v[120:123]
v_exp_f32 v36, v52
v_mfma_f32_16x16x32_bf16 v[124:127], v[216:219], a[236:239], v[124:127]
s_waitcnt lgkmcnt(4)
v_mfma_f32_16x16x32_bf16 a[0:3], v[188:191], v[148:151], a[0:3]
ds_read_b64_tr_b16 v[204:205], v24 offset:40960
v_exp_f32 v37, v53
v_mfma_f32_16x16x32_bf16 a[4:7], v[188:191], v[152:155], a[4:7]
ds_read_b64_tr_b16 v[206:207], v24 offset:45056
v_mfma_f32_16x16x32_bf16 a[8:11], v[188:191], v[156:159], a[8:11]
v_mfma_f32_16x16x32_bf16 a[12:15], v[188:191], v[160:163], a[12:15]
v_exp_f32 v38, v54
v_mfma_f32_16x16x32_bf16 a[16:19], v[188:191], v[164:167], a[16:19]
v_mfma_f32_16x16x32_bf16 a[20:23], v[192:195], v[148:151], a[20:23]
ds_read_b64_tr_b16 v[208:209], v25 offset:40960
v_exp_f32 v39, v55
v_mfma_f32_16x16x32_bf16 a[24:27], v[192:195], v[152:155], a[24:27]
ds_read_b64_tr_b16 v[210:211], v25 offset:45056
v_mfma_f32_16x16x32_bf16 a[28:31], v[192:195], v[156:159], a[28:31]
v_cvt_pk_bf16_f32 v132, v36, v37
v_mfma_f32_16x16x32_bf16 a[32:35], v[192:195], v[160:163], a[32:35]
v_mfma_f32_16x16x32_bf16 a[36:39], v[192:195], v[164:167], a[36:39]
v_cvt_pk_bf16_f32 v133, v38, v39
s_waitcnt lgkmcnt(4)
v_mfma_f32_16x16x32_bf16 a[40:43], v[196:199], v[148:151], a[40:43]
ds_read_b64_tr_b16 v[212:213], v26 offset:40960
v_mfma_f32_16x16x32_bf16 a[44:47], v[196:199], v[152:155], a[44:47]
ds_read_b64_tr_b16 v[214:215], v26 offset:45056
v_exp_f32 v40, v72
v_mfma_f32_16x16x32_bf16 a[48:51], v[196:199], v[156:159], a[48:51]
v_mfma_f32_16x16x32_bf16 a[52:55], v[196:199], v[160:163], a[52:55]
v_exp_f32 v41, v73
v_mfma_f32_16x16x32_bf16 a[56:59], v[196:199], v[164:167], a[56:59]
v_mfma_f32_16x16x32_bf16 a[60:63], v[200:203], v[148:151], a[60:63]
ds_read_b64_tr_b16 v[216:217], v27 offset:40960
v_mfma_f32_16x16x32_bf16 a[64:67], v[200:203], v[152:155], a[64:67]
ds_read_b64_tr_b16 v[218:219], v27 offset:45056
v_exp_f32 v42, v74
v_mfma_f32_16x16x32_bf16 a[68:71], v[200:203], v[156:159], a[68:71]
v_mfma_f32_16x16x32_bf16 a[72:75], v[200:203], v[160:163], a[72:75]
v_exp_f32 v43, v75
v_mfma_f32_16x16x32_bf16 a[76:79], v[200:203], v[164:167], a[76:79]
s_waitcnt lgkmcnt(4)
v_mfma_f32_16x16x32_bf16 a[80:83], v[204:207], v[148:151], a[80:83]
v_cvt_pk_bf16_f32 v134, v40, v41
v_mfma_f32_16x16x32_bf16 a[84:87], v[204:207], v[152:155], a[84:87]
v_cvt_pk_bf16_f32 v135, v42, v43
v_mfma_f32_16x16x32_bf16 a[88:91], v[204:207], v[156:159], a[88:91]
v_or3_b32 v44, v44, v132, v133
v_mfma_f32_16x16x32_bf16 a[92:95], v[204:207], v[160:163], a[92:95]
v_or3_b32 v44, v44, v134, v135
v_mfma_f32_16x16x32_bf16 a[96:99], v[204:207], v[164:167], a[96:99]
v_mfma_f32_16x16x32_bf16 a[100:103], v[208:211], v[148:151], a[100:103]
v_exp_f32 v36, v56
v_mfma_f32_16x16x32_bf16 a[104:107], v[208:211], v[152:155], a[104:107]
v_mfma_f32_16x16x32_bf16 a[108:111], v[208:211], v[156:159], a[108:111]
v_exp_f32 v37, v57
v_mfma_f32_16x16x32_bf16 a[112:115], v[208:211], v[160:163], a[112:115]
v_mfma_f32_16x16x32_bf16 a[116:119], v[208:211], v[164:167], a[116:119]
v_exp_f32 v38, v58
s_waitcnt lgkmcnt(0)
v_mfma_f32_16x16x32_bf16 a[120:123], v[212:215], v[148:151], a[120:123]
v_mfma_f32_16x16x32_bf16 a[124:127], v[212:215], v[152:155], a[124:127]
v_exp_f32 v39, v59
v_mfma_f32_16x16x32_bf16 a[128:131], v[212:215], v[156:159], a[128:131]
v_mfma_f32_16x16x32_bf16 a[132:135], v[212:215], v[160:163], a[132:135]
v_cvt_pk_bf16_f32 v136, v36, v37
v_mfma_f32_16x16x32_bf16 a[136:139], v[212:215], v[164:167], a[136:139]
v_cvt_pk_bf16_f32 v137, v38, v39
v_mfma_f32_16x16x32_bf16 a[140:143], v[216:219], v[148:151], a[140:143]
v_exp_f32 v40, v76
v_mfma_f32_16x16x32_bf16 a[144:147], v[216:219], v[152:155], a[144:147]
v_mfma_f32_16x16x32_bf16 a[148:151], v[216:219], v[156:159], a[148:151]
v_exp_f32 v41, v77
v_mfma_f32_16x16x32_bf16 a[152:155], v[216:219], v[160:163], a[152:155]
v_mfma_f32_16x16x32_bf16 a[156:159], v[216:219], v[164:167], a[156:159]
v_exp_f32 v42, v78
v_mfma_f32_16x16x32_bf16 v[220:223], v[240:243], v[148:151], v[220:223]
v_mfma_f32_16x16x32_bf16 v[224:227], v[240:243], v[152:155], v[224:227]
v_exp_f32 v43, v79
v_mfma_f32_16x16x32_bf16 v[228:231], v[240:243], v[156:159], v[228:231]
v_mfma_f32_16x16x32_bf16 v[232:235], v[240:243], v[160:163], v[232:235]
v_mfma_f32_16x16x32_bf16 v[236:239], v[240:243], v[164:167], v[236:239]
v_cvt_pk_bf16_f32 v138, v40, v41
v_cvt_pk_bf16_f32 v139, v42, v43
v_or3_b32 v44, v44, v136, v137
v_or3_b32 v44, v44, v138, v139
v_exp_f32 v36, v60
v_exp_f32 v37, v61
v_exp_f32 v38, v62
v_exp_f32 v39, v63
v_cvt_pk_bf16_f32 v140, v36, v37
v_cvt_pk_bf16_f32 v141, v38, v39
v_exp_f32 v40, v80
v_exp_f32 v41, v81
v_exp_f32 v42, v82
v_exp_f32 v43, v83
v_cvt_pk_bf16_f32 v142, v40, v41
v_cvt_pk_bf16_f32 v143, v42, v43
v_or3_b32 v44, v44, v140, v141
v_or3_b32 v44, v44, v142, v143
v_exp_f32 v36, v64
v_exp_f32 v37, v65
v_exp_f32 v38, v66
v_exp_f32 v39, v67
v_cvt_pk_bf16_f32 v144, v36, v37
v_cvt_pk_bf16_f32 v145, v38, v39
v_exp_f32 v40, v84
v_exp_f32 v41, v85
v_exp_f32 v42, v86
v_exp_f32 v43, v87
v_cvt_pk_bf16_f32 v146, v40, v41
v_cvt_pk_bf16_f32 v147, v42, v43
v_or3_b32 v44, v44, v144, v145
v_or3_b32 v44, v44, v146, v147
v_and_b32 v44, 0x40004000, v44
v_cmp_ne_u32 vcc, 0, v44
s_nop 1
s_cbranch_vccnz L_rare_20
L_rare_20_ret:
s_waitcnt vmcnt(8)
s_barrier
ds_read_b64_tr_b16 v[188:189], v20 offset:49152
ds_read_b64_tr_b16 v[190:191], v20 offset:53248
ds_read_b64_tr_b16 v[192:193], v21 offset:49152
ds_read_b64_tr_b16 v[194:195], v21 offset:53248
ds_read_b64_tr_b16 v[196:197], v22 offset:49152
ds_read_b64_tr_b16 v[198:199], v22 offset:53248
ds_read_b64_tr_b16 v[200:201], v23 offset:49152
ds_read_b64_tr_b16 v[202:203], v23 offset:53248
s_waitcnt lgkmcnt(4)
v_mfma_f32_16x16x32_bf16 a[0:3], v[188:191], v[128:131], a[0:3]
ds_read_b64_tr_b16 v[204:205], v24 offset:49152
v_exp_f32 v36, v88
v_mfma_f32_16x16x32_bf16 a[4:7], v[188:191], v[132:135], a[4:7]
ds_read_b64_tr_b16 v[206:207], v24 offset:53248
v_mfma_f32_16x16x32_bf16 a[8:11], v[188:191], v[136:139], a[8:11]
v_exp_f32 v37, v89
v_mfma_f32_16x16x32_bf16 a[12:15], v[188:191], v[140:143], a[12:15]
v_exp_f32 v38, v90
v_mfma_f32_16x16x32_bf16 a[16:19], v[188:191], v[144:147], a[16:19]
v_exp_f32 v39, v91
v_mfma_f32_16x16x32_bf16 a[20:23], v[192:195], v[128:131], a[20:23]
ds_read_b64_tr_b16 v[208:209], v25 offset:49152
s_cmp_gt_i32 s91, 0
s_cselect_b32 s92, s88, 0x7f000000
s_sub_u32 s91, s91, 1
s_add_u32 s88, s88, s89
s_and_b32 s88, s88, s90
s_add_u32 m0, s93, 8192
v_mfma_f32_16x16x32_bf16 a[24:27], v[192:195], v[132:135], a[24:27]
ds_read_b64_tr_b16 v[210:211], v25 offset:53248
buffer_load_dwordx4 v244, s[16:19], s92 offen offset:0 lds
v_mfma_f32_16x16x32_bf16 a[28:31], v[192:195], v[136:139], a[28:31]
v_cvt_pk_bf16_f32 v148, v36, v37
v_cvt_pk_bf16_f32 v149, v38, v39
v_mfma_f32_16x16x32_bf16 a[32:35], v[192:195], v[140:143], a[32:35]
v_exp_f32 v40, v108
v_mfma_f32_16x16x32_bf16 a[36:39], v[192:195], v[144:147], a[36:39]
buffer_load_dwordx4 v245, s[16:19], s92 offen offset:1024 lds
s_waitcnt lgkmcnt(4)
v_mfma_f32_16x16x32_bf16 a[40:43], v[196:199], v[128:131], a[40:43]
ds_read_b64_tr_b16 v[212:213], v26 offset:49152
v_exp_f32 v41, v109
v_mfma_f32_16x16x32_bf16 a[44:47], v[196:199], v[132:135], a[44:47]
ds_read_b64_tr_b16 v[214:215], v26 offset:53248
v_mfma_f32_16x16x32_bf16 a[48:51], v[196:199], v[136:139], a[48:51]
buffer_load_dwordx4 v246, s[16:19], s92 offen offset:2048 lds
v_mfma_f32_16x16x32_bf16 a[52:55], v[196:199], v[140:143], a[52:55]
v_exp_f32 v42, v110
v_mfma_f32_16x16x32_bf16 a[56:59], v[196:199], v[144:147], a[56:59]
v_exp_f32 v43, v111
v_mfma_f32_16x16x32_bf16 a[60:63], v[200:203], v[128:131], a[60:63]
ds_read_b64_tr_b16 v[216:217], v27 offset:49152
buffer_load_dwordx4 v247, s[16:19], s92 offen offset:3072 lds
v_mfma_f32_16x16x32_bf16 a[64:67], v[200:203], v[132:135], a[64:67]
ds_read_b64_tr_b16 v[218:219], v27 offset:53248
v_cvt_pk_bf16_f32 v150, v40, v41
v_mfma_f32_16x16x32_bf16 a[68:71], v[200:203], v[136:139], a[68:71]
s_add_u32 m0, s93, 12288
v_cvt_pk_bf16_f32 v151, v42, v43
v_mfma_f32_16x16x32_bf16 a[72:75], v[200:203], v[140:143], a[72:75]
buffer_load_dwordx4 v248, s[16:19], s92 offen offset:0 lds
v_mfma_f32_16x16x32_bf16 a[76:79], v[200:203], v[144:147], a[76:79]
v_or_b32 v44, v148, v149
v_or3_b32 v44, v44, v150, v151
s_waitcnt lgkmcnt(4)
v_mfma_f32_16x16x32_bf16 a[80:83], v[204:207], v[128:131], a[80:83]
v_exp_f32 v36, v92
v_mfma_f32_16x16x32_bf16 a[84:87], v[204:207], v[132:135], a[84:87]
buffer_load_dwordx4 v249, s[16:19], s92 offen offset:1024 lds
v_mfma_f32_16x16x32_bf16 a[88:91], v[204:207], v[136:139], a[88:91]
v_exp_f32 v37, v93
v_mfma_f32_16x16x32_bf16 a[92:95], v[204:207], v[140:143], a[92:95]
v_exp_f32 v38, v94
v_mfma_f32_16x16x32_bf16 a[96:99], v[204:207], v[144:147], a[96:99]
buffer_load_dwordx4 v250, s[16:19], s92 offen offset:2048 lds
v_mfma_f32_16x16x32_bf16 a[100:103], v[208:211], v[128:131], a[100:103]
v_exp_f32 v39, v95
v_mfma_f32_16x16x32_bf16 a[104:107], v[208:211], v[132:135], a[104:107]
v_cvt_pk_bf16_f32 v152, v36, v37
v_cvt_pk_bf16_f32 v153, v38, v39
v_mfma_f32_16x16x32_bf16 a[108:111], v[208:211], v[136:139], a[108:111]
buffer_load_dwordx4 v251, s[16:19], s92 offen offset:3072 lds
v_mfma_f32_16x16x32_bf16 a[112:115], v[208:211], v[140:143], a[112:115]
v_exp_f32 v40, v112
v_mfma_f32_16x16x32_bf16 a[116:119], v[208:211], v[144:147], a[116:119]
v_exp_f32 v41, v113
s_waitcnt lgkmcnt(0)
v_mfma_f32_16x16x32_bf16 a[120:123], v[212:215], v[128:131], a[120:123]
v_exp_f32 v42, v114
v_mfma_f32_16x16x32_bf16 a[124:127], v[212:215], v[132:135], a[124:127]
v_exp_f32 v43, v115
v_mfma_f32_16x16x32_bf16 a[128:131], v[212:215], v[136:139], a[128:131]
v_cvt_pk_bf16_f32 v154, v40, v41
v_cvt_pk_bf16_f32 v155, v42, v43
v_mfma_f32_16x16x32_bf16 a[132:135], v[212:215], v[140:143], a[132:135]
v_or3_b32 v44, v44, v152, v153
v_or3_b32 v44, v44, v154, v155
v_mfma_f32_16x16x32_bf16 a[136:139], v[212:215], v[144:147], a[136:139]
v_exp_f32 v36, v96
v_mfma_f32_16x16x32_bf16 a[140:143], v[216:219], v[128:131], a[140:143]
v_exp_f32 v37, v97
v_mfma_f32_16x16x32_bf16 a[144:147], v[216:219], v[132:135], a[144:147]
v_exp_f32 v38, v98
v_mfma_f32_16x16x32_bf16 a[148:151], v[216:219], v[136:139], a[148:151]
v_exp_f32 v39, v99
v_mfma_f32_16x16x32_bf16 a[152:155], v[216:219], v[140:143], a[152:155]
v_cvt_pk_bf16_f32 v156, v36, v37
v_cvt_pk_bf16_f32 v157, v38, v39
v_mfma_f32_16x16x32_bf16 a[156:159], v[216:219], v[144:147], a[156:159]
v_exp_f32 v40, v116
v_mfma_f32_16x16x32_bf16 v[220:223], v[240:243], v[128:131], v[220:223]
v_exp_f32 v41, v117
v_mfma_f32_16x16x32_bf16 v[224:227], v[240:243], v[132:135], v[224:227]
v_exp_f32 v42, v118
v_mfma_f32_16x16x32_bf16 v[228:231], v[240:243], v[136:139], v[228:231]
v_exp_f32 v43, v119
v_mfma_f32_16x16x32_bf16 v[232:235], v[240:243], v[140:143], v[232:235]
v_mfma_f32_16x16x32_bf16 v[236:239], v[240:243], v[144:147], v[236:239]
v_cvt_pk_bf16_f32 v158, v40, v41
v_cvt_pk_bf16_f32 v159, v42, v43
v_or3_b32 v44, v44, v156, v157
v_or3_b32 v44, v44, v158, v159
v_exp_f32 v36, v100
v_exp_f32 v37, v101
v_exp_f32 v38, v102
v_exp_f32 v39, v103
v_cvt_pk_bf16_f32 v160, v36, v37
v_cvt_pk_bf16_f32 v161, v38, v39
v_exp_f32 v40, v120
v_exp_f32 v41, v121
v_exp_f32 v42, v122
v_exp_f32 v43, v123
v_cvt_pk_bf16_f32 v162, v40, v41
v_cvt_pk_bf16_f32 v163, v42, v43
v_or3_b32 v44, v44, v160, v161
v_or3_b32 v44, v44, v162, v163
v_exp_f32 v36, v104
v_exp_f32 v37, v105
v_exp_f32 v38, v106
v_exp_f32 v39, v107
v_cvt_pk_bf16_f32 v164, v36, v37
v_cvt_pk_bf16_f32 v165, v38, v39
v_exp_f32 v40, v124
v_exp_f32 v41, v125
v_exp_f32 v42, v126
v_exp_f32 v43, v127
v_cvt_pk_bf16_f32 v166, v40, v41
v_cvt_pk_bf16_f32 v167, v42, v43
v_or3_b32 v44, v44, v164, v165
v_or3_b32 v44, v44, v166, v167
v_and_b32 v44, 0x40004000, v44
v_cmp_ne_u32 vcc, 0, v44
s_nop 1
s_cbranch_vccnz L_rare_21
L_rare_21_ret:
ds_read_b64_tr_b16 v[188:189], v20 offset:57344
ds_read_b64_tr_b16 v[190:191], v20 offset:61440
ds_read_b64_tr_b16 v[192:193], v21 offset:57344
ds_read_b64_tr_b16 v[194:195], v21 offset:61440
ds_read_b64_tr_b16 v[196:197], v22 offset:57344
ds_read_b64_tr_b16 v[198:199], v22 offset:61440
ds_read_b64_tr_b16 v[200:201], v23 offset:57344
ds_read_b64_tr_b16 v[202:203], v23 offset:61440
s_waitcnt lgkmcnt(4)
v_mfma_f32_16x16x32_bf16 a[0:3], v[188:191], v[148:151], a[0:3]
ds_read_b64_tr_b16 v[204:205], v24 offset:57344
v_add_u32 v5, 0, v2
v_xor_b32 v5, v5, v3
v_mfma_f32_16x16x32_bf16 a[4:7], v[188:191], v[152:155], a[4:7]
ds_read_b64_tr_b16 v[206:207], v24 offset:61440
v_lshlrev_b32 v5, 4, v5
v_lshl_add_u32 v16, v3, 8, v5
v_mfma_f32_16x16x32_bf16 a[8:11], v[188:191], v[156:159], a[8:11]
v_add_u32 v16, 81920, v16
v_add_u32 v5, 4, v2
v_mfma_f32_16x16x32_bf16 a[12:15], v[188:191], v[160:163], a[12:15]
v_xor_b32 v5, v5, v3
v_lshlrev_b32 v5, 4, v5
v_mfma_f32_16x16x32_bf16 a[16:19], v[188:191], v[164:167], a[16:19]
v_lshl_add_u32 v17, v3, 8, v5
v_add_u32 v17, 81920, v17
v_mfma_f32_16x16x32_bf16 a[20:23], v[192:195], v[148:151], a[20:23]
ds_read_b64_tr_b16 v[208:209], v25 offset:57344
v_add_u32 v5, 8, v2
v_xor_b32 v5, v5, v3
v_mfma_f32_16x16x32_bf16 a[24:27], v[192:195], v[152:155], a[24:27]
ds_read_b64_tr_b16 v[210:211], v25 offset:61440
v_lshlrev_b32 v5, 4, v5
v_lshl_add_u32 v18, v3, 8, v5
v_mfma_f32_16x16x32_bf16 a[28:31], v[192:195], v[156:159], a[28:31]
v_add_u32 v18, 81920, v18
v_add_u32 v5, 12, v2
v_mfma_f32_16x16x32_bf16 a[32:35], v[192:195], v[160:163], a[32:35]
v_xor_b32 v5, v5, v3
v_lshlrev_b32 v5, 4, v5
v_mfma_f32_16x16x32_bf16 a[36:39], v[192:195], v[164:167], a[36:39]
v_lshl_add_u32 v19, v3, 8, v5
v_add_u32 v19, 81920, v19
s_waitcnt lgkmcnt(4)
v_mfma_f32_16x16x32_bf16 a[40:43], v[196:199], v[148:151], a[40:43]
ds_read_b64_tr_b16 v[212:213], v26 offset:57344
s_and_b32 s56, s4, 3
s_sub_u32 s54, s3, s56
v_mfma_f32_16x16x32_bf16 a[44:47], v[196:199], v[152:155], a[44:47]
ds_read_b64_tr_b16 v[214:215], v26 offset:61440
s_and_b32 s54, s54, 3
s_mul_i32 s54, s54, 20480
v_mfma_f32_16x16x32_bf16 a[48:51], v[196:199], v[156:159], a[48:51]
v_add_u32 v28, s54, v16
v_add_u32 v29, s54, v17
v_mfma_f32_16x16x32_bf16 a[52:55], v[196:199], v[160:163], a[52:55]
v_add_u32 v30, s54, v18
v_add_u32 v31, s54, v19
v_mfma_f32_16x16x32_bf16 a[56:59], v[196:199], v[164:167], a[56:59]
v_mfma_f32_16x16x32_bf16 a[60:63], v[200:203], v[148:151], a[60:63]
ds_read_b64_tr_b16 v[216:217], v27 offset:57344
v_mfma_f32_16x16x32_bf16 a[64:67], v[200:203], v[152:155], a[64:67]
ds_read_b64_tr_b16 v[218:219], v27 offset:61440
v_mfma_f32_16x16x32_bf16 a[68:71], v[200:203], v[156:159], a[68:71]
v_mfma_f32_16x16x32_bf16 a[72:75], v[200:203], v[160:163], a[72:75]
v_mfma_f32_16x16x32_bf16 a[76:79], v[200:203], v[164:167], a[76:79]
s_waitcnt lgkmcnt(4)
v_mfma_f32_16x16x32_bf16 a[80:83], v[204:207], v[148:151], a[80:83]
v_lshrrev_b32 v5, 2, v1
v_bfe_u32 v6, v1, 3, 2
v_mfma_f32_16x16x32_bf16 a[84:87], v[204:207], v[152:155], a[84:87]
v_and_b32 v7, 3, v1
v_lshlrev_b32 v7, 4, v7
v_mfma_f32_16x16x32_bf16 a[88:91], v[204:207], v[156:159], a[88:91]
v_lshl_add_u32 v7, v5, 8, v7
v_add_u32 v7, s93, v7
v_mfma_f32_16x16x32_bf16 a[92:95], v[204:207], v[160:163], a[92:95]
v_xor_b32 v8, 0, v6
v_lshl_add_u32 v20, v8, 6, v7
v_mfma_f32_16x16x32_bf16 a[96:99], v[204:207], v[164:167], a[96:99]
v_xor_b32 v8, 0, v6
v_lshl_add_u32 v21, v8, 6, v7
v_mfma_f32_16x16x32_bf16 a[100:103], v[208:211], v[148:151], a[100:103]
v_add_u32 v21, 8, v21
v_xor_b32 v8, 1, v6
v_mfma_f32_16x16x32_bf16 a[104:107], v[208:211], v[152:155], a[104:107]
v_lshl_add_u32 v22, v8, 6, v7
v_xor_b32 v8, 1, v6
v_mfma_f32_16x16x32_bf16 a[108:111], v[208:211], v[156:159], a[108:111]
v_lshl_add_u32 v23, v8, 6, v7
v_add_u32 v23, 8, v23
v_mfma_f32_16x16x32_bf16 a[112:115], v[208:211], v[160:163], a[112:115]
v_xor_b32 v8, 2, v6
v_lshl_add_u32 v24, v8, 6, v7
v_mfma_f32_16x16x32_bf16 a[116:119], v[208:211], v[164:167], a[116:119]
v_xor_b32 v8, 2, v6
v_lshl_add_u32 v25, v8, 6, v7
s_waitcnt lgkmcnt(0)
v_mfma_f32_16x16x32_bf16 a[120:123], v[212:215], v[148:151], a[120:123]
v_add_u32 v25, 8, v25
v_xor_b32 v8, 3, v6
v_mfma_f32_16x16x32_bf16 a[124:127], v[212:215], v[152:155], a[124:127]
v_lshl_add_u32 v26, v8, 6, v7
v_xor_b32 v8, 3, v6
v_mfma_f32_16x16x32_bf16 a[128:131], v[212:215], v[156:159], a[128:131]
v_lshl_add_u32 v27, v8, 6, v7
v_add_u32 v27, 8, v27
v_mfma_f32_16x16x32_bf16 a[132:135], v[212:215], v[160:163], a[132:135]
v_mfma_f32_16x16x32_bf16 a[136:139], v[212:215], v[164:167], a[136:139]
v_mfma_f32_16x16x32_bf16 a[140:143], v[216:219], v[148:151], a[140:143]
v_mfma_f32_16x16x32_bf16 a[144:147], v[216:219], v[152:155], a[144:147]
v_mfma_f32_16x16x32_bf16 a[148:151], v[216:219], v[156:159], a[148:151]
v_mfma_f32_16x16x32_bf16 a[152:155], v[216:219], v[160:163], a[152:155]
v_mfma_f32_16x16x32_bf16 a[156:159], v[216:219], v[164:167], a[156:159]
v_mfma_f32_16x16x32_bf16 v[220:223], v[240:243], v[148:151], v[220:223]
v_mfma_f32_16x16x32_bf16 v[224:227], v[240:243], v[152:155], v[224:227]
v_mfma_f32_16x16x32_bf16 v[228:231], v[240:243], v[156:159], v[228:231]
v_mfma_f32_16x16x32_bf16 v[232:235], v[240:243], v[160:163], v[232:235]
v_mfma_f32_16x16x32_bf16 v[236:239], v[240:243], v[164:167], v[236:239]
L_tail:
s_nop 6
v_rcp_f32 v168, v220
v_rcp_f32 v169, v220
v_rcp_f32 v170, v224
v_rcp_f32 v171, v224
v_rcp_f32 v172, v228
v_rcp_f32 v173, v228
v_rcp_f32 v174, v232
v_rcp_f32 v175, v232
v_rcp_f32 v176, v236
v_rcp_f32 v177, v236
s_barrier
v_accvgpr_read_b32 v48, a120
v_accvgpr_read_b32 v49, a121
v_accvgpr_read_b32 v50, a122
v_accvgpr_read_b32 v51, a123
v_accvgpr_read_b32 v52, a140
v_accvgpr_read_b32 v53, a141
v_accvgpr_read_b32 v54, a142
v_accvgpr_read_b32 v55, a143
v_pk_mul_f32 v[48:49], v[48:49], v[168:169]
v_pk_mul_f32 v[50:51], v[50:51], v[168:169]
v_pk_mul_f32 v[52:53], v[52:53], v[168:169]
v_pk_mul_f32 v[54:55], v[54:55], v[168:169]
v_cvt_pk_bf16_f32 v48, v48, v49
v_cvt_pk_bf16_f32 v49, v50, v51
v_cvt_pk_bf16_f32 v50, v52, v53
v_cvt_pk_bf16_f32 v51, v54, v55
ds_write_b128 v31, v[48:51] offset:0
v_accvgpr_read_b32 v56, a124
v_accvgpr_read_b32 v57, a125
v_accvgpr_read_b32 v58, a126
v_accvgpr_read_b32 v59, a127
v_accvgpr_read_b32 v60, a144
v_accvgpr_read_b32 v61, a145
v_accvgpr_read_b32 v62, a146
v_accvgpr_read_b32 v63, a147
v_pk_mul_f32 v[56:57], v[56:57], v[170:171]
v_pk_mul_f32 v[58:59], v[58:59], v[170:171]
v_pk_mul_f32 v[60:61], v[60:61], v[170:171]
v_pk_mul_f32 v[62:63], v[62:63], v[170:171]
v_cvt_pk_bf16_f32 v56, v56, v57
v_cvt_pk_bf16_f32 v57, v58, v59
v_cvt_pk_bf16_f32 v58, v60, v61
v_cvt_pk_bf16_f32 v59, v62, v63
ds_write_b128 v31, v[56:59] offset:4096
v_accvgpr_read_b32 v64, a128
v_accvgpr_read_b32 v65, a129
v_accvgpr_read_b32 v66, a130
v_accvgpr_read_b32 v67, a131
v_accvgpr_read_b32 v68, a148
v_accvgpr_read_b32 v69, a149
v_accvgpr_read_b32 v70, a150
v_accvgpr_read_b32 v71, a151
v_pk_mul_f32 v[64:65], v[64:65], v[172:173]
v_pk_mul_f32 v[66:67], v[66:67], v[172:173]
v_pk_mul_f32 v[68:69], v[68:69], v[172:173]
v_pk_mul_f32 v[70:71], v[70:71], v[172:173]
v_cvt_pk_bf16_f32 v64, v64, v65
v_cvt_pk_bf16_f32 v65, v66, v67
v_cvt_pk_bf16_f32 v66, v68, v69
v_cvt_pk_bf16_f32 v67, v70, v71
ds_write_b128 v31, v[64:67] offset:8192
v_accvgpr_read_b32 v72, a132
v_accvgpr_read_b32 v73, a133
v_accvgpr_read_b32 v74, a134
v_accvgpr_read_b32 v75, a135
v_accvgpr_read_b32 v76, a152
v_accvgpr_read_b32 v77, a153
v_accvgpr_read_b32 v78, a154
v_accvgpr_read_b32 v79, a155
v_pk_mul_f32 v[72:73], v[72:73], v[174:175]
v_pk_mul_f32 v[74:75], v[74:75], v[174:175]
v_pk_mul_f32 v[76:77], v[76:77], v[174:175]
v_pk_mul_f32 v[78:79], v[78:79], v[174:175]
v_cvt_pk_bf16_f32 v72, v72, v73
v_cvt_pk_bf16_f32 v73, v74, v75
v_cvt_pk_bf16_f32 v74, v76, v77
v_cvt_pk_bf16_f32 v75, v78, v79
ds_write_b128 v31, v[72:75] offset:12288
v_accvgpr_read_b32 v48, a136
v_accvgpr_read_b32 v49, a137
v_accvgpr_read_b32 v50, a138
v_accvgpr_read_b32 v51, a139
v_accvgpr_read_b32 v52, a156
v_accvgpr_read_b32 v53, a157
v_accvgpr_read_b32 v54, a158
v_accvgpr_read_b32 v55, a159
v_pk_mul_f32 v[48:49], v[48:49], v[176:177]
v_pk_mul_f32 v[50:51], v[50:51], v[176:177]
v_pk_mul_f32 v[52:53], v[52:53], v[176:177]
v_pk_mul_f32 v[54:55], v[54:55], v[176:177]
v_cvt_pk_bf16_f32 v48, v48, v49
v_cvt_pk_bf16_f32 v49, v50, v51
v_cvt_pk_bf16_f32 v50, v52, v53
v_cvt_pk_bf16_f32 v51, v54, v55
ds_write_b128 v31, v[48:51] offset:16384
v_accvgpr_read_b32 v56, a0
v_accvgpr_read_b32 v57, a1
v_accvgpr_read_b32 v58, a2
v_accvgpr_read_b32 v59, a3
v_accvgpr_read_b32 v60, a20
v_accvgpr_read_b32 v61, a21
v_accvgpr_read_b32 v62, a22
v_accvgpr_read_b32 v63, a23
v_pk_mul_f32 v[56:57], v[56:57], v[168:169]
v_pk_mul_f32 v[58:59], v[58:59], v[168:169]
v_pk_mul_f32 v[60:61], v[60:61], v[168:169]
v_pk_mul_f32 v[62:63], v[62:63], v[168:169]
v_cvt_pk_bf16_f32 v56, v56, v57
v_cvt_pk_bf16_f32 v57, v58, v59
v_cvt_pk_bf16_f32 v58, v60, v61
v_cvt_pk_bf16_f32 v59, v62, v63
ds_write_b128 v28, v[56:59] offset:0
s_waitcnt vmcnt(8)
ds_read_b64_tr_b16 a[152:153], v20 offset:0
ds_read_b64_tr_b16 a[154:155], v20 offset:4096
v_accvgpr_read_b32 v64, a4
v_accvgpr_read_b32 v65, a5
v_accvgpr_read_b32 v66, a6
v_accvgpr_read_b32 v67, a7
v_accvgpr_read_b32 v68, a24
v_accvgpr_read_b32 v69, a25
v_accvgpr_read_b32 v70, a26
v_accvgpr_read_b32 v71, a27
v_pk_mul_f32 v[64:65], v[64:65], v[170:171]
v_pk_mul_f32 v[66:67], v[66:67], v[170:171]
v_pk_mul_f32 v[68:69], v[68:69], v[170:171]
v_pk_mul_f32 v[70:71], v[70:71], v[170:171]
v_cvt_pk_bf16_f32 v64, v64, v65
v_cvt_pk_bf16_f32 v65, v66, v67
v_cvt_pk_bf16_f32 v66, v68, v69
v_cvt_pk_bf16_f32 v67, v70, v71
ds_write_b128 v28, v[64:67] offset:4096
ds_read_b64_tr_b16 a[156:157], v21 offset:0
ds_read_b64_tr_b16 a[158:159], v21 offset:4096
v_accvgpr_read_b32 v72, a8
v_accvgpr_read_b32 v73, a9
v_accvgpr_read_b32 v74, a10
v_accvgpr_read_b32 v75, a11
v_accvgpr_read_b32 v76, a28
v_accvgpr_read_b32 v77, a29
v_accvgpr_read_b32 v78, a30
v_accvgpr_read_b32 v79, a31
v_pk_mul_f32 v[72:73], v[72:73], v[172:173]
v_pk_mul_f32 v[74:75], v[74:75], v[172:173]
v_pk_mul_f32 v[76:77], v[76:77], v[172:173]
v_pk_mul_f32 v[78:79], v[78:79], v[172:173]
v_cvt_pk_bf16_f32 v72, v72, v73
v_cvt_pk_bf16_f32 v73, v74, v75
v_cvt_pk_bf16_f32 v74, v76, v77
v_cvt_pk_bf16_f32 v75, v78, v79
ds_write_b128 v28, v[72:75] offset:8192
ds_read_b64_tr_b16 a[160:161], v22 offset:0
ds_read_b64_tr_b16 a[162:163], v22 offset:4096
v_accvgpr_read_b32 v48, a12
v_accvgpr_read_b32 v49, a13
v_accvgpr_read_b32 v50, a14
v_accvgpr_read_b32 v51, a15
v_accvgpr_read_b32 v52, a32
v_accvgpr_read_b32 v53, a33
v_accvgpr_read_b32 v54, a34
v_accvgpr_read_b32 v55, a35
v_pk_mul_f32 v[48:49], v[48:49], v[174:175]
v_pk_mul_f32 v[50:51], v[50:51], v[174:175]
v_pk_mul_f32 v[52:53], v[52:53], v[174:175]
v_pk_mul_f32 v[54:55], v[54:55], v[174:175]
v_cvt_pk_bf16_f32 v48, v48, v49
v_cvt_pk_bf16_f32 v49, v50, v51
v_cvt_pk_bf16_f32 v50, v52, v53
v_cvt_pk_bf16_f32 v51, v54, v55
ds_write_b128 v28, v[48:51] offset:12288
ds_read_b64_tr_b16 a[164:165], v23 offset:0
ds_read_b64_tr_b16 a[166:167], v23 offset:4096
v_accvgpr_read_b32 v56, a16
v_accvgpr_read_b32 v57, a17
v_accvgpr_read_b32 v58, a18
v_accvgpr_read_b32 v59, a19
v_accvgpr_read_b32 v60, a36
v_accvgpr_read_b32 v61, a37
v_accvgpr_read_b32 v62, a38
v_accvgpr_read_b32 v63, a39
v_pk_mul_f32 v[56:57], v[56:57], v[176:177]
v_pk_mul_f32 v[58:59], v[58:59], v[176:177]
v_pk_mul_f32 v[60:61], v[60:61], v[176:177]
v_pk_mul_f32 v[62:63], v[62:63], v[176:177]
v_cvt_pk_bf16_f32 v56, v56, v57
v_cvt_pk_bf16_f32 v57, v58, v59
v_cvt_pk_bf16_f32 v58, v60, v61
v_cvt_pk_bf16_f32 v59, v62, v63
ds_write_b128 v28, v[56:59] offset:16384
ds_read_b64_tr_b16 a[168:169], v24 offset:0
ds_read_b64_tr_b16 a[170:171], v24 offset:4096
v_accvgpr_read_b32 v64, a40
v_accvgpr_read_b32 v65, a41
v_accvgpr_read_b32 v66, a42
v_accvgpr_read_b32 v67, a43
v_accvgpr_read_b32 v68, a60
v_accvgpr_read_b32 v69, a61
v_accvgpr_read_b32 v70, a62
v_accvgpr_read_b32 v71, a63
v_pk_mul_f32 v[64:65], v[64:65], v[168:169]
v_pk_mul_f32 v[66:67], v[66:67], v[168:169]
v_pk_mul_f32 v[68:69], v[68:69], v[168:169]
v_pk_mul_f32 v[70:71], v[70:71], v[168:169]
v_cvt_pk_bf16_f32 v64, v64, v65
v_cvt_pk_bf16_f32 v65, v66, v67
v_cvt_pk_bf16_f32 v66, v68, v69
v_cvt_pk_bf16_f32 v67, v70, v71
ds_write_b128 v29, v[64:67] offset:0
ds_read_b64_tr_b16 a[172:173], v25 offset:0
ds_read_b64_tr_b16 a[174:175], v25 offset:4096
v_accvgpr_read_b32 v72, a44
v_accvgpr_read_b32 v73, a45
v_accvgpr_read_b32 v74, a46
v_accvgpr_read_b32 v75, a47
v_accvgpr_read_b32 v76, a64
v_accvgpr_read_b32 v77, a65
v_accvgpr_read_b32 v78, a66
v_accvgpr_read_b32 v79, a67
v_pk_mul_f32 v[72:73], v[72:73], v[170:171]
v_pk_mul_f32 v[74:75], v[74:75], v[170:171]
v_pk_mul_f32 v[76:77], v[76:77], v[170:171]
v_pk_mul_f32 v[78:79], v[78:79], v[170:171]
v_cvt_pk_bf16_f32 v72, v72, v73
v_cvt_pk_bf16_f32 v73, v74, v75
v_cvt_pk_bf16_f32 v74, v76, v77
v_cvt_pk_bf16_f32 v75, v78, v79
ds_write_b128 v29, v[72:75] offset:4096
ds_read_b64_tr_b16 a[176:177], v26 offset:0
ds_read_b64_tr_b16 a[178:179], v26 offset:4096
v_accvgpr_read_b32 v48, a48
v_accvgpr_read_b32 v49, a49
v_accvgpr_read_b32 v50, a50
v_accvgpr_read_b32 v51, a51
v_accvgpr_read_b32 v52, a68
v_accvgpr_read_b32 v53, a69
v_accvgpr_read_b32 v54, a70
v_accvgpr_read_b32 v55, a71
v_pk_mul_f32 v[48:49], v[48:49], v[172:173]
v_pk_mul_f32 v[50:51], v[50:51], v[172:173]
v_pk_mul_f32 v[52:53], v[52:53], v[172:173]
v_pk_mul_f32 v[54:55], v[54:55], v[172:173]
v_cvt_pk_bf16_f32 v48, v48, v49
v_cvt_pk_bf16_f32 v49, v50, v51
v_cvt_pk_bf16_f32 v50, v52, v53
v_cvt_pk_bf16_f32 v51, v54, v55
ds_write_b128 v29, v[48:51] offset:8192
ds_read_b64_tr_b16 a[180:181], v27 offset:0
ds_read_b64_tr_b16 a[182:183], v27 offset:4096
v_accvgpr_read_b32 v56, a52
v_accvgpr_read_b32 v57, a53
v_accvgpr_read_b32 v58, a54
v_accvgpr_read_b32 v59, a55
v_accvgpr_read_b32 v60, a72
v_accvgpr_read_b32 v61, a73
v_accvgpr_read_b32 v62, a74
v_accvgpr_read_b32 v63, a75
v_pk_mul_f32 v[56:57], v[56:57], v[174:175]
v_pk_mul_f32 v[58:59], v[58:59], v[174:175]
v_pk_mul_f32 v[60:61], v[60:61], v[174:175]
v_pk_mul_f32 v[62:63], v[62:63], v[174:175]
v_cvt_pk_bf16_f32 v56, v56, v57
v_cvt_pk_bf16_f32 v57, v58, v59
v_cvt_pk_bf16_f32 v58, v60, v61
v_cvt_pk_bf16_f32 v59, v62, v63
ds_write_b128 v29, v[56:59] offset:12288
v_accvgpr_read_b32 v64, a56
v_accvgpr_read_b32 v65, a57
v_accvgpr_read_b32 v66, a58
v_accvgpr_read_b32 v67, a59
v_accvgpr_read_b32 v68, a76
v_accvgpr_read_b32 v69, a77
v_accvgpr_read_b32 v70, a78
v_accvgpr_read_b32 v71, a79
v_pk_mul_f32 v[64:65], v[64:65], v[176:177]
v_pk_mul_f32 v[66:67], v[66:67], v[176:177]
v_pk_mul_f32 v[68:69], v[68:69], v[176:177]
v_pk_mul_f32 v[70:71], v[70:71], v[176:177]
v_cvt_pk_bf16_f32 v64, v64, v65
v_cvt_pk_bf16_f32 v65, v66, v67
v_cvt_pk_bf16_f32 v66, v68, v69
v_cvt_pk_bf16_f32 v67, v70, v71
ds_write_b128 v29, v[64:67] offset:16384
v_accvgpr_read_b32 v72, a80
v_accvgpr_read_b32 v73, a81
v_accvgpr_read_b32 v74, a82
v_accvgpr_read_b32 v75, a83
v_accvgpr_read_b32 v76, a100
v_accvgpr_read_b32 v77, a101
v_accvgpr_read_b32 v78, a102
v_accvgpr_read_b32 v79, a103
v_pk_mul_f32 v[72:73], v[72:73], v[168:169]
v_pk_mul_f32 v[74:75], v[74:75], v[168:169]
v_pk_mul_f32 v[76:77], v[76:77], v[168:169]
v_pk_mul_f32 v[78:79], v[78:79], v[168:169]
v_cvt_pk_bf16_f32 v72, v72, v73
v_cvt_pk_bf16_f32 v73, v74, v75
v_cvt_pk_bf16_f32 v74, v76, v77
v_cvt_pk_bf16_f32 v75, v78, v79
ds_write_b128 v30, v[72:75] offset:0
s_waitcnt lgkmcnt(3)
v_accvgpr_read_b32 v48, a84
v_accvgpr_read_b32 v49, a85
v_accvgpr_read_b32 v50, a86
v_accvgpr_read_b32 v51, a87
v_accvgpr_read_b32 v52, a104
v_accvgpr_read_b32 v53, a105
v_accvgpr_read_b32 v54, a106
v_accvgpr_read_b32 v55, a107
v_pk_mul_f32 v[48:49], v[48:49], v[170:171]
v_pk_mul_f32 v[50:51], v[50:51], v[170:171]
v_pk_mul_f32 v[52:53], v[52:53], v[170:171]
v_pk_mul_f32 v[54:55], v[54:55], v[170:171]
v_cvt_pk_bf16_f32 v48, v48, v49
v_cvt_pk_bf16_f32 v49, v50, v51
v_cvt_pk_bf16_f32 v50, v52, v53
v_cvt_pk_bf16_f32 v51, v54, v55
ds_write_b128 v30, v[48:51] offset:4096
v_accvgpr_read_b32 v56, a88
v_accvgpr_read_b32 v57, a89
v_accvgpr_read_b32 v58, a90
v_accvgpr_read_b32 v59, a91
v_accvgpr_read_b32 v60, a108
v_accvgpr_read_b32 v61, a109
v_accvgpr_read_b32 v62, a110
v_accvgpr_read_b32 v63, a111
v_pk_mul_f32 v[56:57], v[56:57], v[172:173]
v_pk_mul_f32 v[58:59], v[58:59], v[172:173]
v_pk_mul_f32 v[60:61], v[60:61], v[172:173]
v_pk_mul_f32 v[62:63], v[62:63], v[172:173]
v_cvt_pk_bf16_f32 v56, v56, v57
v_cvt_pk_bf16_f32 v57, v58, v59
v_cvt_pk_bf16_f32 v58, v60, v61
v_cvt_pk_bf16_f32 v59, v62, v63
ds_write_b128 v30, v[56:59] offset:8192
v_accvgpr_read_b32 v64, a92
v_accvgpr_read_b32 v65, a93
v_accvgpr_read_b32 v66, a94
v_accvgpr_read_b32 v67, a95
v_accvgpr_read_b32 v68, a112
v_accvgpr_read_b32 v69, a113
v_accvgpr_read_b32 v70, a114
v_accvgpr_read_b32 v71, a115
v_pk_mul_f32 v[64:65], v[64:65], v[174:175]
v_pk_mul_f32 v[66:67], v[66:67], v[174:175]
v_pk_mul_f32 v[68:69], v[68:69], v[174:175]
v_pk_mul_f32 v[70:71], v[70:71], v[174:175]
v_cvt_pk_bf16_f32 v64, v64, v65
v_cvt_pk_bf16_f32 v65, v66, v67
v_cvt_pk_bf16_f32 v66, v68, v69
v_cvt_pk_bf16_f32 v67, v70, v71
ds_write_b128 v30, v[64:67] offset:12288
v_accvgpr_read_b32 v72, a96
v_accvgpr_read_b32 v73, a97
v_accvgpr_read_b32 v74, a98
v_accvgpr_read_b32 v75, a99
v_accvgpr_read_b32 v76, a116
v_accvgpr_read_b32 v77, a117
v_accvgpr_read_b32 v78, a118
v_accvgpr_read_b32 v79, a119
v_pk_mul_f32 v[72:73], v[72:73], v[176:177]
v_pk_mul_f32 v[74:75], v[74:75], v[176:177]
v_pk_mul_f32 v[76:77], v[76:77], v[176:177]
v_pk_mul_f32 v[78:79], v[78:79], v[176:177]
v_cvt_pk_bf16_f32 v72, v72, v73
v_cvt_pk_bf16_f32 v73, v74, v75
v_cvt_pk_bf16_f32 v74, v76, v77
v_cvt_pk_bf16_f32 v75, v78, v79
ds_write_b128 v30, v[72:75] offset:16384
s_mov_b32 s94, 3
s_lshl_b32 s54, s6, 4
s_add_u32 s54, s54, s4
s_lshl_b32 s54, s54, 3
s_add_u32 s54, s54, s5
s_lshl_b32 s54, s54, 2
s_add_u32 s54, s54, s3
s_mul_i32 s54, s54, 20480
s_add_u32 s54, s54, 0x2000000
s_add_u32 s24, s52, s54
s_addc_u32 s25, s53, 0
s_mov_b32 s26, 0x5000
s_mov_b32 s27, 0x20000
s_cmp_eq_u32 s6, 0
s_cselect_b64 vcc, -1, 0
s_waitcnt lgkmcnt(0)
s_barrier
ds_read_b128 a[216:219], v16 offset:0
ds_read_b128 a[220:223], v16 offset:4096
ds_read_b128 a[224:227], v16 offset:8192
ds_read_b128 a[228:231], v16 offset:12288
ds_read_b128 a[232:235], v16 offset:16384
s_waitcnt lgkmcnt(0)
s_waitcnt vmcnt(0)
v_mfma_f32_16x16x32_bf16 v[48:51], a[152:155], a[216:219], 0
ds_read_b64_tr_b16 a[184:185], v20 offset:8192
s_cmp_gt_i32 s91, 0
s_cselect_b32 s92, s88, 0x7f000000
s_sub_u32 s91, s91, 1
s_add_u32 s88, s88, s89
s_and_b32 s88, s88, s90
s_add_u32 m0, s93, 0
v_mfma_f32_16x16x32_bf16 v[52:55], a[152:155], a[220:223], 0
ds_read_b64_tr_b16 a[186:187], v20 offset:12288
buffer_load_dwordx4 v244, s[16:19], s92 offen offset:0 lds
v_mfma_f32_16x16x32_bf16 v[56:59], a[152:155], a[224:227], 0
ds_read_b64_tr_b16 a[188:189], v21 offset:8192
v_mfma_f32_16x16x32_bf16 v[60:63], a[152:155], a[228:231], 0
ds_read_b64_tr_b16 a[190:191], v21 offset:12288
buffer_load_dwordx4 v245, s[16:19], s92 offen offset:1024 lds
v_mfma_f32_16x16x32_bf16 v[64:67], a[152:155], a[232:235], 0
ds_read_b64_tr_b16 a[192:193], v22 offset:8192
v_mfma_f32_16x16x32_bf16 v[68:71], a[156:159], a[216:219], 0
ds_read_b64_tr_b16 a[194:195], v22 offset:12288
buffer_load_dwordx4 v246, s[16:19], s92 offen offset:2048 lds
v_mfma_f32_16x16x32_bf16 v[72:75], a[156:159], a[220:223], 0
ds_read_b64_tr_b16 a[196:197], v23 offset:8192
v_mfma_f32_16x16x32_bf16 v[76:79], a[156:159], a[224:227], 0
ds_read_b64_tr_b16 a[198:199], v23 offset:12288
buffer_load_dwordx4 v247, s[16:19], s92 offen offset:3072 lds
v_mfma_f32_16x16x32_bf16 v[80:83], a[156:159], a[228:231], 0
ds_read_b64_tr_b16 a[200:201], v24 offset:8192
s_add_u32 m0, s93, 4096
v_mfma_f32_16x16x32_bf16 v[84:87], a[156:159], a[232:235], 0
ds_read_b64_tr_b16 a[202:203], v24 offset:12288
buffer_load_dwordx4 v248, s[16:19], s92 offen offset:0 lds
v_mfma_f32_16x16x32_bf16 v[88:91], a[160:163], a[216:219], 0
ds_read_b64_tr_b16 a[204:205], v25 offset:8192
v_mfma_f32_16x16x32_bf16 v[92:95], a[160:163], a[220:223], 0
ds_read_b64_tr_b16 a[206:207], v25 offset:12288
buffer_load_dwordx4 v249, s[16:19], s92 offen offset:1024 lds
v_mfma_f32_16x16x32_bf16 v[96:99], a[160:163], a[224:227], 0
ds_read_b64_tr_b16 a[208:209], v26 offset:8192
v_mfma_f32_16x16x32_bf16 v[100:103], a[160:163], a[228:231], 0
ds_read_b64_tr_b16 a[210:211], v26 offset:12288
buffer_load_dwordx4 v250, s[16:19], s92 offen offset:2048 lds
v_mfma_f32_16x16x32_bf16 v[104:107], a[160:163], a[232:235], 0
ds_read_b64_tr_b16 a[212:213], v27 offset:8192
v_mfma_f32_16x16x32_bf16 v[108:111], a[164:167], a[216:219], 0
ds_read_b64_tr_b16 a[214:215], v27 offset:12288
buffer_load_dwordx4 v251, s[16:19], s92 offen offset:3072 lds
v_mfma_f32_16x16x32_bf16 v[112:115], a[164:167], a[220:223], 0
ds_read_b128 a[236:239], v17 offset:0
v_mfma_f32_16x16x32_bf16 v[116:119], a[164:167], a[224:227], 0
ds_read_b128 a[240:243], v17 offset:4096
v_mfma_f32_16x16x32_bf16 v[120:123], a[164:167], a[228:231], 0
ds_read_b128 a[244:247], v17 offset:8192
v_mfma_f32_16x16x32_bf16 v[124:127], a[164:167], a[232:235], 0
ds_read_b128 a[248:251], v17 offset:12288
v_mfma_f32_16x16x32_bf16 v[128:131], a[168:171], a[216:219], 0
ds_read_b128 a[252:255], v17 offset:16384
v_mfma_f32_16x16x32_bf16 v[132:135], a[168:171], a[220:223], 0
s_cmp_gt_i32 s91, 0
s_cselect_b32 s92, s88, 0x7f000000
v_mfma_f32_16x16x32_bf16 v[136:139], a[168:171], a[224:227], 0
s_sub_u32 s91, s91, 1
s_add_u32 s88, s88, s89
v_mfma_f32_16x16x32_bf16 v[140:143], a[168:171], a[228:231], 0
s_and_b32 s88, s88, s90
s_add_u32 m0, s93, 8192
v_mfma_f32_16x16x32_bf16 v[144:147], a[168:171], a[232:235], 0
s_waitcnt lgkmcnt(5)
buffer_load_dwordx4 v244, s[16:19], s92 offen offset:0 lds
v_mfma_f32_16x16x32_bf16 v[148:151], a[172:175], a[216:219], 0
v_mfma_f32_16x16x32_bf16 v[152:155], a[172:175], a[220:223], 0
buffer_load_dwordx4 v245, s[16:19], s92 offen offset:1024 lds
v_mfma_f32_16x16x32_bf16 v[156:159], a[172:175], a[224:227], 0
v_mfma_f32_16x16x32_bf16 v[160:163], a[172:175], a[228:231], 0
buffer_load_dwordx4 v246, s[16:19], s92 offen offset:2048 lds
v_mfma_f32_16x16x32_bf16 v[164:167], a[172:175], a[232:235], 0
v_mfma_f32_16x16x32_bf16 v[168:171], a[176:179], a[216:219], 0
buffer_load_dwordx4 v247, s[16:19], s92 offen offset:3072 lds
v_mfma_f32_16x16x32_bf16 v[172:175], a[176:179], a[220:223], 0
s_add_u32 m0, s93, 12288
v_mfma_f32_16x16x32_bf16 v[176:179], a[176:179], a[224:227], 0
buffer_load_dwordx4 v248, s[16:19], s92 offen offset:0 lds
v_mfma_f32_16x16x32_bf16 v[180:183], a[176:179], a[228:231], 0
v_mfma_f32_16x16x32_bf16 v[184:187], a[176:179], a[232:235], 0
buffer_load_dwordx4 v249, s[16:19], s92 offen offset:1024 lds
v_mfma_f32_16x16x32_bf16 v[188:191], a[180:183], a[216:219], 0
v_mfma_f32_16x16x32_bf16 v[192:195], a[180:183], a[220:223], 0
buffer_load_dwordx4 v250, s[16:19], s92 offen offset:2048 lds
v_mfma_f32_16x16x32_bf16 v[196:199], a[180:183], a[224:227], 0
v_mfma_f32_16x16x32_bf16 v[200:203], a[180:183], a[228:231], 0
v_mfma_f32_16x16x32_bf16 v[204:207], a[180:183], a[232:235], 0
s_waitcnt lgkmcnt(0)
buffer_load_dwordx4 v251, s[16:19], s92 offen offset:3072 lds
s_call_b64 s[60:61], F_gemm1
s_cmp_eq_u32 s6, 1
s_cbranch_scc1 L_nowarm
s_xor_b32 s54, s5, 1
s_lshl_b32 s54, s54, 19
s_lshl_b32 s55, s4, 15
s_add_u32 s54, s54, s55
s_lshl_b32 s55, s3, 13
s_add_u32 s54, s54, s55
s_add_u32 s20, s46, s54
s_addc_u32 s21, s47, 0
s_mov_b32 s22, 0x2000
s_mov_b32 s23, 0x20000
v_lshlrev_b32 v5, 7, v1
buffer_load_dword v12, v5, s[20:23], 0 offen
L_nowarm:
s_waitcnt vmcnt(8)
v_mfma_f32_16x16x32_bf16 v[48:51], a[152:155], a[216:219], v[48:51]
ds_read_b64_tr_b16 a[184:185], v20 offset:8192
v_mfma_f32_16x16x32_bf16 v[52:55], a[152:155], a[220:223], v[52:55]
ds_read_b64_tr_b16 a[186:187], v20 offset:12288
v_mfma_f32_16x16x32_bf16 v[56:59], a[152:155], a[224:227], v[56:59]
ds_read_b64_tr_b16 a[188:189], v21 offset:8192
v_mfma_f32_16x16x32_bf16 v[60:63], a[152:155], a[228:231], v[60:63]
ds_read_b64_tr_b16 a[190:191], v21 offset:12288
v_mfma_f32_16x16x32_bf16 v[64:67], a[152:155], a[232:235], v[64:67]
ds_read_b64_tr_b16 a[192:193], v22 offset:8192
v_mfma_f32_16x16x32_bf16 v[68:71], a[156:159], a[216:219], v[68:71]
ds_read_b64_tr_b16 a[194:195], v22 offset:12288
v_mfma_f32_16x16x32_bf16 v[72:75], a[156:159], a[220:223], v[72:75]
ds_read_b64_tr_b16 a[196:197], v23 offset:8192
v_mfma_f32_16x16x32_bf16 v[76:79], a[156:159], a[224:227], v[76:79]
ds_read_b64_tr_b16 a[198:199], v23 offset:12288
v_mfma_f32_16x16x32_bf16 v[80:83], a[156:159], a[228:231], v[80:83]
ds_read_b64_tr_b16 a[200:201], v24 offset:8192
v_mfma_f32_16x16x32_bf16 v[84:87], a[156:159], a[232:235], v[84:87]
ds_read_b64_tr_b16 a[202:203], v24 offset:12288
v_mfma_f32_16x16x32_bf16 v[88:91], a[160:163], a[216:219], v[88:91]
ds_read_b64_tr_b16 a[204:205], v25 offset:8192
v_mfma_f32_16x16x32_bf16 v[92:95], a[160:163], a[220:223], v[92:95]
ds_read_b64_tr_b16 a[206:207], v25 offset:12288
v_mfma_f32_16x16x32_bf16 v[96:99], a[160:163], a[224:227], v[96:99]
ds_read_b64_tr_b16 a[208:209], v26 offset:8192
v_mfma_f32_16x16x32_bf16 v[100:103], a[160:163], a[228:231], v[100:103]
ds_read_b64_tr_b16 a[210:211], v26 offset:12288
v_mfma_f32_16x16x32_bf16 v[104:107], a[160:163], a[232:235], v[104:107]
ds_read_b64_tr_b16 a[212:213], v27 offset:8192
v_mfma_f32_16x16x32_bf16 v[108:111], a[164:167], a[216:219], v[108:111]
ds_read_b64_tr_b16 a[214:215], v27 offset:12288
v_mfma_f32_16x16x32_bf16 v[112:115], a[164:167], a[220:223], v[112:115]
ds_read_b128 a[236:239], v17 offset:0
v_mfma_f32_16x16x32_bf16 v[116:119], a[164:167], a[224:227], v[116:119]
ds_read_b128 a[240:243], v17 offset:4096
v_mfma_f32_16x16x32_bf16 v[120:123], a[164:167], a[228:231], v[120:123]
ds_read_b128 a[244:247], v17 offset:8192
v_mfma_f32_16x16x32_bf16 v[124:127], a[164:167], a[232:235], v[124:127]
ds_read_b128 a[248:251], v17 offset:12288
v_mfma_f32_16x16x32_bf16 v[128:131], a[168:171], a[216:219], v[128:131]
ds_read_b128 a[252:255], v17 offset:16384
v_mfma_f32_16x16x32_bf16 v[132:135], a[168:171], a[220:223], v[132:135]
s_cmp_gt_i32 s91, 0
s_cselect_b32 s92, s88, 0x7f000000
v_mfma_f32_16x16x32_bf16 v[136:139], a[168:171], a[224:227], v[136:139]
s_sub_u32 s91, s91, 1
s_add_u32 s88, s88, s89
v_mfma_f32_16x16x32_bf16 v[140:143], a[168:171], a[228:231], v[140:143]
s_and_b32 s88, s88, s90
s_add_u32 m0, s93, 8192
v_mfma_f32_16x16x32_bf16 v[144:147], a[168:171], a[232:235], v[144:147]
s_waitcnt lgkmcnt(5)
buffer_load_dwordx4 v244, s[16:19], s92 offen offset:0 lds
v_mfma_f32_16x16x32_bf16 v[148:151], a[172:175], a[216:219], v[148:151]
v_mfma_f32_16x16x32_bf16 v[152:155], a[172:175], a[220:223], v[152:155]
buffer_load_dwordx4 v245, s[16:19], s92 offen offset:1024 lds
v_mfma_f32_16x16x32_bf16 v[156:159], a[172:175], a[224:227], v[156:159]
v_mfma_f32_16x16x32_bf16 v[160:163], a[172:175], a[228:231], v[160:163]
buffer_load_dwordx4 v246, s[16:19], s92 offen offset:2048 lds
v_mfma_f32_16x16x32_bf16 v[164:167], a[172:175], a[232:235], v[164:167]
v_mfma_f32_16x16x32_bf16 v[168:171], a[176:179], a[216:219], v[168:171]
buffer_load_dwordx4 v247, s[16:19], s92 offen offset:3072 lds
v_mfma_f32_16x16x32_bf16 v[172:175], a[176:179], a[220:223], v[172:175]
s_add_u32 m0, s93, 12288
v_mfma_f32_16x16x32_bf16 v[176:179], a[176:179], a[224:227], v[176:179]
buffer_load_dwordx4 v248, s[16:19], s92 offen offset:0 lds
v_mfma_f32_16x16x32_bf16 v[180:183], a[176:179], a[228:231], v[180:183]
v_mfma_f32_16x16x32_bf16 v[184:187], a[176:179], a[232:235], v[184:187]
buffer_load_dwordx4 v249, s[16:19], s92 offen offset:1024 lds
v_mfma_f32_16x16x32_bf16 v[188:191], a[180:183], a[216:219], v[188:191]
v_mfma_f32_16x16x32_bf16 v[192:195], a[180:183], a[220:223], v[192:195]
buffer_load_dwordx4 v250, s[16:19], s92 offen offset:2048 lds
v_mfma_f32_16x16x32_bf16 v[196:199], a[180:183], a[224:227], v[196:199]
v_mfma_f32_16x16x32_bf16 v[200:203], a[180:183], a[228:231], v[200:203]
v_mfma_f32_16x16x32_bf16 v[204:207], a[180:183], a[232:235], v[204:207]
s_waitcnt lgkmcnt(0)
buffer_load_dwordx4 v251, s[16:19], s92 offen offset:3072 lds
s_waitcnt vmcnt(8)
v_mfma_f32_16x16x32_bf16 v[48:51], a[184:187], a[236:239], v[48:51]
ds_read_b64_tr_b16 a[152:153], v20 offset:0
v_mfma_f32_16x16x32_bf16 v[52:55], a[184:187], a[240:243], v[52:55]
ds_read_b64_tr_b16 a[154:155], v20 offset:4096
v_mfma_f32_16x16x32_bf16 v[56:59], a[184:187], a[244:247], v[56:59]
ds_read_b64_tr_b16 a[156:157], v21 offset:0
v_mfma_f32_16x16x32_bf16 v[60:63], a[184:187], a[248:251], v[60:63]
ds_read_b64_tr_b16 a[158:159], v21 offset:4096
v_mfma_f32_16x16x32_bf16 v[64:67], a[184:187], a[252:255], v[64:67]
ds_read_b64_tr_b16 a[160:161], v22 offset:0
v_mfma_f32_16x16x32_bf16 v[68:71], a[188:191], a[236:239], v[68:71]
ds_read_b64_tr_b16 a[162:163], v22 offset:4096
v_mfma_f32_16x16x32_bf16 v[72:75], a[188:191], a[240:243], v[72:75]
ds_read_b64_tr_b16 a[164:165], v23 offset:0
v_mfma_f32_16x16x32_bf16 v[76:79], a[188:191], a[244:247], v[76:79]
ds_read_b64_tr_b16 a[166:167], v23 offset:4096
v_mfma_f32_16x16x32_bf16 v[80:83], a[188:191], a[248:251], v[80:83]
ds_read_b64_tr_b16 a[168:169], v24 offset:0
v_mfma_f32_16x16x32_bf16 v[84:87], a[188:191], a[252:255], v[84:87]
ds_read_b64_tr_b16 a[170:171], v24 offset:4096
v_mfma_f32_16x16x32_bf16 v[88:91], a[192:195], a[236:239], v[88:91]
ds_read_b64_tr_b16 a[172:173], v25 offset:0
v_mfma_f32_16x16x32_bf16 v[92:95], a[192:195], a[240:243], v[92:95]
ds_read_b64_tr_b16 a[174:175], v25 offset:4096
v_mfma_f32_16x16x32_bf16 v[96:99], a[192:195], a[244:247], v[96:99]
ds_read_b64_tr_b16 a[176:177], v26 offset:0
v_mfma_f32_16x16x32_bf16 v[100:103], a[192:195], a[248:251], v[100:103]
ds_read_b64_tr_b16 a[178:179], v26 offset:4096
v_mfma_f32_16x16x32_bf16 v[104:107], a[192:195], a[252:255], v[104:107]
ds_read_b64_tr_b16 a[180:181], v27 offset:0
v_mfma_f32_16x16x32_bf16 v[108:111], a[196:199], a[236:239], v[108:111]
ds_read_b64_tr_b16 a[182:183], v27 offset:4096
v_mfma_f32_16x16x32_bf16 v[112:115], a[196:199], a[240:243], v[112:115]
ds_read_b128 a[216:219], v18 offset:0
v_mfma_f32_16x16x32_bf16 v[116:119], a[196:199], a[244:247], v[116:119]
ds_read_b128 a[220:223], v18 offset:4096
v_mfma_f32_16x16x32_bf16 v[120:123], a[196:199], a[248:251], v[120:123]
ds_read_b128 a[224:227], v18 offset:8192
v_mfma_f32_16x16x32_bf16 v[124:127], a[196:199], a[252:255], v[124:127]
ds_read_b128 a[228:231], v18 offset:12288
v_mfma_f32_16x16x32_bf16 v[128:131], a[200:203], a[236:239], v[128:131]
ds_read_b128 a[232:235], v18 offset:16384
v_mfma_f32_16x16x32_bf16 v[132:135], a[200:203], a[240:243], v[132:135]
v_mfma_f32_16x16x32_bf16 v[136:139], a[200:203], a[244:247], v[136:139]
v_mfma_f32_16x16x32_bf16 v[140:143], a[200:203], a[248:251], v[140:143]
v_mfma_f32_16x16x32_bf16 v[144:147], a[200:203], a[252:255], v[144:147]
s_waitcnt lgkmcnt(5)
v_mfma_f32_16x16x32_bf16 v[148:151], a[204:207], a[236:239], v[148:151]
v_mfma_f32_16x16x32_bf16 v[152:155], a[204:207], a[240:243], v[152:155]
v_mfma_f32_16x16x32_bf16 v[156:159], a[204:207], a[244:247], v[156:159]
v_mfma_f32_16x16x32_bf16 v[160:163], a[204:207], a[248:251], v[160:163]
v_mfma_f32_16x16x32_bf16 v[164:167], a[204:207], a[252:255], v[164:167]
v_mfma_f32_16x16x32_bf16 v[168:171], a[208:211], a[236:239], v[168:171]
v_mfma_f32_16x16x32_bf16 v[172:175], a[208:211], a[240:243], v[172:175]
v_mfma_f32_16x16x32_bf16 v[176:179], a[208:211], a[244:247], v[176:179]
v_mfma_f32_16x16x32_bf16 v[180:183], a[208:211], a[248:251], v[180:183]
v_mfma_f32_16x16x32_bf16 v[184:187], a[208:211], a[252:255], v[184:187]
v_mfma_f32_16x16x32_bf16 v[188:191], a[212:215], a[236:239], v[188:191]
v_mfma_f32_16x16x32_bf16 v[192:195], a[212:215], a[240:243], v[192:195]
v_mfma_f32_16x16x32_bf16 v[196:199], a[212:215], a[244:247], v[196:199]
v_mfma_f32_16x16x32_bf16 v[200:203], a[212:215], a[248:251], v[200:203]
v_mfma_f32_16x16x32_bf16 v[204:207], a[212:215], a[252:255], v[204:207]
s_waitcnt lgkmcnt(0)
s_waitcnt vmcnt(0)
v_mfma_f32_16x16x32_bf16 v[48:51], a[152:155], a[216:219], v[48:51]
ds_read_b64_tr_b16 a[184:185], v20 offset:8192
v_mfma_f32_16x16x32_bf16 v[52:55], a[152:155], a[220:223], v[52:55]
ds_read_b64_tr_b16 a[186:187], v20 offset:12288
v_mfma_f32_16x16x32_bf16 v[56:59], a[152:155], a[224:227], v[56:59]
ds_read_b64_tr_b16 a[188:189], v21 offset:8192
v_mfma_f32_16x16x32_bf16 v[60:63], a[152:155], a[228:231], v[60:63]
ds_read_b64_tr_b16 a[190:191], v21 offset:12288
v_mfma_f32_16x16x32_bf16 v[64:67], a[152:155], a[232:235], v[64:67]
ds_read_b64_tr_b16 a[192:193], v22 offset:8192
v_mfma_f32_16x16x32_bf16 v[68:71], a[156:159], a[216:219], v[68:71]
ds_read_b64_tr_b16 a[194:195], v22 offset:12288
v_mfma_f32_16x16x32_bf16 v[72:75], a[156:159], a[220:223], v[72:75]
ds_read_b64_tr_b16 a[196:197], v23 offset:8192
v_mfma_f32_16x16x32_bf16 v[76:79], a[156:159], a[224:227], v[76:79]
ds_read_b64_tr_b16 a[198:199], v23 offset:12288
v_mfma_f32_16x16x32_bf16 v[80:83], a[156:159], a[228:231], v[80:83]
ds_read_b64_tr_b16 a[200:201], v24 offset:8192
v_mfma_f32_16x16x32_bf16 v[84:87], a[156:159], a[232:235], v[84:87]
ds_read_b64_tr_b16 a[202:203], v24 offset:12288
v_mfma_f32_16x16x32_bf16 v[88:91], a[160:163], a[216:219], v[88:91]
ds_read_b64_tr_b16 a[204:205], v25 offset:8192
v_mfma_f32_16x16x32_bf16 v[92:95], a[160:163], a[220:223], v[92:95]
ds_read_b64_tr_b16 a[206:207], v25 offset:12288
v_mfma_f32_16x16x32_bf16 v[96:99], a[160:163], a[224:227], v[96:99]
ds_read_b64_tr_b16 a[208:209], v26 offset:8192
v_mfma_f32_16x16x32_bf16 v[100:103], a[160:163], a[228:231], v[100:103]
ds_read_b64_tr_b16 a[210:211], v26 offset:12288
v_mfma_f32_16x16x32_bf16 v[104:107], a[160:163], a[232:235], v[104:107]
ds_read_b64_tr_b16 a[212:213], v27 offset:8192
v_mfma_f32_16x16x32_bf16 v[108:111], a[164:167], a[216:219], v[108:111]
ds_read_b64_tr_b16 a[214:215], v27 offset:12288
v_mfma_f32_16x16x32_bf16 v[112:115], a[164:167], a[220:223], v[112:115]
ds_read_b128 a[236:239], v19 offset:0
v_mfma_f32_16x16x32_bf16 v[116:119], a[164:167], a[224:227], v[116:119]
ds_read_b128 a[240:243], v19 offset:4096
v_mfma_f32_16x16x32_bf16 v[120:123], a[164:167], a[228:231], v[120:123]
ds_read_b128 a[244:247], v19 offset:8192
v_mfma_f32_16x16x32_bf16 v[124:127], a[164:167], a[232:235], v[124:127]
ds_read_b128 a[248:251], v19 offset:12288
v_mfma_f32_16x16x32_bf16 v[128:131], a[168:171], a[216:219], v[128:131]
ds_read_b128 a[252:255], v19 offset:16384
v_mfma_f32_16x16x32_bf16 v[132:135], a[168:171], a[220:223], v[132:135]
v_mfma_f32_16x16x32_bf16 v[136:139], a[168:171], a[224:227], v[136:139]
v_mfma_f32_16x16x32_bf16 v[140:143], a[168:171], a[228:231], v[140:143]
v_mfma_f32_16x16x32_bf16 v[144:147], a[168:171], a[232:235], v[144:147]
s_waitcnt lgkmcnt(5)
v_mfma_f32_16x16x32_bf16 v[148:151], a[172:175], a[216:219], v[148:151]
v_mfma_f32_16x16x32_bf16 v[152:155], a[172:175], a[220:223], v[152:155]
v_mfma_f32_16x16x32_bf16 v[156:159], a[172:175], a[224:227], v[156:159]
v_mfma_f32_16x16x32_bf16 v[160:163], a[172:175], a[228:231], v[160:163]
v_mfma_f32_16x16x32_bf16 v[164:167], a[172:175], a[232:235], v[164:167]
v_mfma_f32_16x16x32_bf16 v[168:171], a[176:179], a[216:219], v[168:171]
v_mfma_f32_16x16x32_bf16 v[172:175], a[176:179], a[220:223], v[172:175]
v_mfma_f32_16x16x32_bf16 v[176:179], a[176:179], a[224:227], v[176:179]
v_mfma_f32_16x16x32_bf16 v[180:183], a[176:179], a[228:231], v[180:183]
v_mfma_f32_16x16x32_bf16 v[184:187], a[176:179], a[232:235], v[184:187]
v_mfma_f32_16x16x32_bf16 v[188:191], a[180:183], a[216:219], v[188:191]
v_mfma_f32_16x16x32_bf16 v[192:195], a[180:183], a[220:223], v[192:195]
v_mfma_f32_16x16x32_bf16 v[196:199], a[180:183], a[224:227], v[196:199]
v_mfma_f32_16x16x32_bf16 v[200:203], a[180:183], a[228:231], v[200:203]
v_mfma_f32_16x16x32_bf16 v[204:207], a[180:183], a[232:235], v[204:207]
s_waitcnt lgkmcnt(0)
s_cmp_eq_u32 s6, 1
s_cbranch_scc0 L_lastA
v_mfma_f32_16x16x32_bf16 v[48:51], a[184:187], a[236:239], v[48:51]
v_mfma_f32_16x16x32_bf16 v[52:55], a[184:187], a[240:243], v[52:55]
v_mfma_f32_16x16x32_bf16 v[56:59], a[184:187], a[244:247], v[56:59]
v_mfma_f32_16x16x32_bf16 v[60:63], a[184:187], a[248:251], v[60:63]
v_mfma_f32_16x16x32_bf16 v[64:67], a[184:187], a[252:255], v[64:67]
v_mfma_f32_16x16x32_bf16 v[68:71], a[188:191], a[236:239], v[68:71]
v_mfma_f32_16x16x32_bf16 v[72:75], a[188:191], a[240:243], v[72:75]
v_mfma_f32_16x16x32_bf16 v[76:79], a[188:191], a[244:247], v[76:79]
v_mfma_f32_16x16x32_bf16 v[80:83], a[188:191], a[248:251], v[80:83]
v_mfma_f32_16x16x32_bf16 v[84:87], a[188:191], a[252:255], v[84:87]
v_mfma_f32_16x16x32_bf16 v[88:91], a[192:195], a[236:239], v[88:91]
v_mfma_f32_16x16x32_bf16 v[92:95], a[192:195], a[240:243], v[92:95]
v_mfma_f32_16x16x32_bf16 v[96:99], a[192:195], a[244:247], v[96:99]
v_mfma_f32_16x16x32_bf16 v[100:103], a[192:195], a[248:251], v[100:103]
s_mov_b32 s100, 0
v_cvt_pk_bf16_f32 v48, v48, v49
v_cvt_pk_bf16_f32 v49, v50, v51
v_cvt_pk_bf16_f32 v50, v68, v69
v_cvt_pk_bf16_f32 v51, v70, v71
buffer_store_dwordx4 v[48:51], v4, s[24:27], s100 offen offset:0 sc1
v_mfma_f32_16x16x32_bf16 v[104:107], a[192:195], a[252:255], v[104:107]
v_mfma_f32_16x16x32_bf16 v[108:111], a[196:199], a[236:239], v[108:111]
v_cvt_pk_bf16_f32 v52, v52, v53
v_cvt_pk_bf16_f32 v53, v54, v55
v_cvt_pk_bf16_f32 v54, v72, v73
v_cvt_pk_bf16_f32 v55, v74, v75
buffer_store_dwordx4 v[52:55], v4, s[24:27], s100 offen offset:1024 sc1
v_mfma_f32_16x16x32_bf16 v[112:115], a[196:199], a[240:243], v[112:115]
v_mfma_f32_16x16x32_bf16 v[116:119], a[196:199], a[244:247], v[116:119]
v_cvt_pk_bf16_f32 v56, v56, v57
v_cvt_pk_bf16_f32 v57, v58, v59
v_cvt_pk_bf16_f32 v58, v76, v77
v_cvt_pk_bf16_f32 v59, v78, v79
buffer_store_dwordx4 v[56:59], v4, s[24:27], s100 offen offset:2048 sc1
v_mfma_f32_16x16x32_bf16 v[120:123], a[196:199], a[248:251], v[120:123]
v_mfma_f32_16x16x32_bf16 v[124:127], a[196:199], a[252:255], v[124:127]
v_cvt_pk_bf16_f32 v60, v60, v61
v_cvt_pk_bf16_f32 v61, v62, v63
v_cvt_pk_bf16_f32 v62, v80, v81
v_cvt_pk_bf16_f32 v63, v82, v83
buffer_store_dwordx4 v[60:63], v4, s[24:27], s100 offen offset:3072 sc1
v_mfma_f32_16x16x32_bf16 v[128:131], a[200:203], a[236:239], v[128:131]
s_mov_b32 s100, 4096
v_cvt_pk_bf16_f32 v64, v64, v65
v_cvt_pk_bf16_f32 v65, v66, v67
v_cvt_pk_bf16_f32 v66, v84, v85
v_cvt_pk_bf16_f32 v67, v86, v87
buffer_store_dwordx4 v[64:67], v4, s[24:27], s100 offen offset:0 sc1
v_mfma_f32_16x16x32_bf16 v[132:135], a[200:203], a[240:243], v[132:135]
v_mfma_f32_16x16x32_bf16 v[136:139], a[200:203], a[244:247], v[136:139]
v_mfma_f32_16x16x32_bf16 v[140:143], a[200:203], a[248:251], v[140:143]
v_cvt_pk_bf16_f32 v88, v88, v89
v_cvt_pk_bf16_f32 v89, v90, v91
v_cvt_pk_bf16_f32 v90, v108, v109
v_cvt_pk_bf16_f32 v91, v110, v111
buffer_store_dwordx4 v[88:91], v4, s[24:27], s100 offen offset:1024 sc1
v_mfma_f32_16x16x32_bf16 v[144:147], a[200:203], a[252:255], v[144:147]
v_mfma_f32_16x16x32_bf16 v[148:151], a[204:207], a[236:239], v[148:151]
v_cvt_pk_bf16_f32 v92, v92, v93
v_cvt_pk_bf16_f32 v93, v94, v95
v_cvt_pk_bf16_f32 v94, v112, v113
v_cvt_pk_bf16_f32 v95, v114, v115
buffer_store_dwordx4 v[92:95], v4, s[24:27], s100 offen offset:2048 sc1
v_mfma_f32_16x16x32_bf16 v[152:155], a[204:207], a[240:243], v[152:155]
v_mfma_f32_16x16x32_bf16 v[156:159], a[204:207], a[244:247], v[156:159]
v_cvt_pk_bf16_f32 v96, v96, v97
v_cvt_pk_bf16_f32 v97, v98, v99
v_cvt_pk_bf16_f32 v98, v116, v117
v_cvt_pk_bf16_f32 v99, v118, v119
buffer_store_dwordx4 v[96:99], v4, s[24:27], s100 offen offset:3072 sc1
v_mfma_f32_16x16x32_bf16 v[160:163], a[204:207], a[248:251], v[160:163]
v_mfma_f32_16x16x32_bf16 v[164:167], a[204:207], a[252:255], v[164:167]
s_mov_b32 s100, 8192
v_cvt_pk_bf16_f32 v100, v100, v101
v_cvt_pk_bf16_f32 v101, v102, v103
v_cvt_pk_bf16_f32 v102, v120, v121
v_cvt_pk_bf16_f32 v103, v122, v123
buffer_store_dwordx4 v[100:103], v4, s[24:27], s100 offen offset:0 sc1
v_mfma_f32_16x16x32_bf16 v[168:171], a[208:211], a[236:239], v[168:171]
v_cvt_pk_bf16_f32 v104, v104, v105
v_cvt_pk_bf16_f32 v105, v106, v107
v_cvt_pk_bf16_f32 v106, v124, v125
v_cvt_pk_bf16_f32 v107, v126, v127
buffer_store_dwordx4 v[104:107], v4, s[24:27], s100 offen offset:1024 sc1
v_mfma_f32_16x16x32_bf16 v[172:175], a[208:211], a[240:243], v[172:175]
v_mfma_f32_16x16x32_bf16 v[176:179], a[208:211], a[244:247], v[176:179]
v_mfma_f32_16x16x32_bf16 v[180:183], a[208:211], a[248:251], v[180:183]
v_cvt_pk_bf16_f32 v128, v128, v129
v_cvt_pk_bf16_f32 v129, v130, v131
v_cvt_pk_bf16_f32 v130, v148, v149
v_cvt_pk_bf16_f32 v131, v150, v151
buffer_store_dwordx4 v[128:131], v4, s[24:27], s100 offen offset:2048 sc1
v_mfma_f32_16x16x32_bf16 v[184:187], a[208:211], a[252:255], v[184:187]
v_mfma_f32_16x16x32_bf16 v[188:191], a[212:215], a[236:239], v[188:191]
v_cvt_pk_bf16_f32 v132, v132, v133
v_cvt_pk_bf16_f32 v133, v134, v135
v_cvt_pk_bf16_f32 v134, v152, v153
v_cvt_pk_bf16_f32 v135, v154, v155
buffer_store_dwordx4 v[132:135], v4, s[24:27], s100 offen offset:3072 sc1
v_mfma_f32_16x16x32_bf16 v[192:195], a[212:215], a[240:243], v[192:195]
v_mfma_f32_16x16x32_bf16 v[196:199], a[212:215], a[244:247], v[196:199]
s_mov_b32 s100, 12288
v_cvt_pk_bf16_f32 v136, v136, v137
v_cvt_pk_bf16_f32 v137, v138, v139
v_cvt_pk_bf16_f32 v138, v156, v157
v_cvt_pk_bf16_f32 v139, v158, v159
buffer_store_dwordx4 v[136:139], v4, s[24:27], s100 offen offset:0 sc1
v_mfma_f32_16x16x32_bf16 v[200:203], a[212:215], a[248:251], v[200:203]
v_mfma_f32_16x16x32_bf16 v[204:207], a[212:215], a[252:255], v[204:207]
v_cvt_pk_bf16_f32 v140, v140, v141
v_cvt_pk_bf16_f32 v141, v142, v143
v_cvt_pk_bf16_f32 v142, v160, v161
v_cvt_pk_bf16_f32 v143, v162, v163
buffer_store_dwordx4 v[140:143], v4, s[24:27], s100 offen offset:1024 sc1
v_cvt_pk_bf16_f32 v144, v144, v145
v_cvt_pk_bf16_f32 v145, v146, v147
v_cvt_pk_bf16_f32 v146, v164, v165
v_cvt_pk_bf16_f32 v147, v166, v167
buffer_store_dwordx4 v[144:147], v4, s[24:27], s100 offen offset:2048 sc1
s_nop 4
v_cvt_pk_bf16_f32 v168, v168, v169
v_cvt_pk_bf16_f32 v169, v170, v171
v_cvt_pk_bf16_f32 v170, v188, v189
v_cvt_pk_bf16_f32 v171, v190, v191
buffer_store_dwordx4 v[168:171], v4, s[24:27], s100 offen offset:3072 sc1
s_mov_b32 s100, 16384
v_cvt_pk_bf16_f32 v172, v172, v173
v_cvt_pk_bf16_f32 v173, v174, v175
v_cvt_pk_bf16_f32 v174, v192, v193
v_cvt_pk_bf16_f32 v175, v194, v195
buffer_store_dwordx4 v[172:175], v4, s[24:27], s100 offen offset:0 sc1
v_cvt_pk_bf16_f32 v176, v176, v177
v_cvt_pk_bf16_f32 v177, v178, v179
v_cvt_pk_bf16_f32 v178, v196, v197
v_cvt_pk_bf16_f32 v179, v198, v199
buffer_store_dwordx4 v[176:179], v4, s[24:27], s100 offen offset:1024 sc1
v_cvt_pk_bf16_f32 v180, v180, v181
v_cvt_pk_bf16_f32 v181, v182, v183
v_cvt_pk_bf16_f32 v182, v200, v201
v_cvt_pk_bf16_f32 v183, v202, v203
buffer_store_dwordx4 v[180:183], v4, s[24:27], s100 offen offset:2048 sc1
v_cvt_pk_bf16_f32 v184, v184, v185
v_cvt_pk_bf16_f32 v185, v186, v187
v_cvt_pk_bf16_f32 v186, v204, v205
v_cvt_pk_bf16_f32 v187, v206, v207
buffer_store_dwordx4 v[184:187], v4, s[24:27], s100 offen offset:3072 sc1
s_branch L_go
L_lastA:
v_mfma_f32_16x16x32_bf16 v[48:51], a[184:187], a[236:239], v[48:51]
v_mfma_f32_16x16x32_bf16 v[52:55], a[184:187], a[240:243], v[52:55]
v_mfma_f32_16x16x32_bf16 v[56:59], a[184:187], a[244:247], v[56:59]
v_mfma_f32_16x16x32_bf16 v[60:63], a[184:187], a[248:251], v[60:63]
v_mfma_f32_16x16x32_bf16 v[64:67], a[184:187], a[252:255], v[64:67]
v_mfma_f32_16x16x32_bf16 v[68:71], a[188:191], a[236:239], v[68:71]
v_mfma_f32_16x16x32_bf16 v[72:75], a[188:191], a[240:243], v[72:75]
v_mfma_f32_16x16x32_bf16 v[76:79], a[188:191], a[244:247], v[76:79]
v_mfma_f32_16x16x32_bf16 v[80:83], a[188:191], a[248:251], v[80:83]
v_mfma_f32_16x16x32_bf16 v[84:87], a[188:191], a[252:255], v[84:87]
v_mfma_f32_16x16x32_bf16 v[88:91], a[192:195], a[236:239], v[88:91]
v_mfma_f32_16x16x32_bf16 v[92:95], a[192:195], a[240:243], v[92:95]
v_mfma_f32_16x16x32_bf16 v[96:99], a[192:195], a[244:247], v[96:99]
v_mfma_f32_16x16x32_bf16 v[100:103], a[192:195], a[248:251], v[100:103]
v_mfma_f32_16x16x32_bf16 v[104:107], a[192:195], a[252:255], v[104:107]
v_mfma_f32_16x16x32_bf16 v[108:111], a[196:199], a[236:239], v[108:111]
v_mfma_f32_16x16x32_bf16 v[112:115], a[196:199], a[240:243], v[112:115]
v_mfma_f32_16x16x32_bf16 v[116:119], a[196:199], a[244:247], v[116:119]
v_mfma_f32_16x16x32_bf16 v[120:123], a[196:199], a[248:251], v[120:123]
v_mfma_f32_16x16x32_bf16 v[124:127], a[196:199], a[252:255], v[124:127]
v_mfma_f32_16x16x32_bf16 v[128:131], a[200:203], a[236:239], v[128:131]
v_mfma_f32_16x16x32_bf16 v[132:135], a[200:203], a[240:243], v[132:135]
v_mfma_f32_16x16x32_bf16 v[136:139], a[200:203], a[244:247], v[136:139]
v_mfma_f32_16x16x32_bf16 v[140:143], a[200:203], a[248:251], v[140:143]
v_mfma_f32_16x16x32_bf16 v[144:147], a[200:203], a[252:255], v[144:147]
v_mfma_f32_16x16x32_bf16 v[148:151], a[204:207], a[236:239], v[148:151]
v_mfma_f32_16x16x32_bf16 v[152:155], a[204:207], a[240:243], v[152:155]
v_mfma_f32_16x16x32_bf16 v[156:159], a[204:207], a[244:247], v[156:159]
v_mfma_f32_16x16x32_bf16 v[160:163], a[204:207], a[248:251], v[160:163]
v_mfma_f32_16x16x32_bf16 v[164:167], a[204:207], a[252:255], v[164:167]
v_mfma_f32_16x16x32_bf16 v[168:171], a[208:211], a[236:239], v[168:171]
v_mfma_f32_16x16x32_bf16 v[172:175], a[208:211], a[240:243], v[172:175]
v_mfma_f32_16x16x32_bf16 v[176:179], a[208:211], a[244:247], v[176:179]
v_mfma_f32_16x16x32_bf16 v[180:183], a[208:211], a[248:251], v[180:183]
v_mfma_f32_16x16x32_bf16 v[184:187], a[208:211], a[252:255], v[184:187]
v_mfma_f32_16x16x32_bf16 v[188:191], a[212:215], a[236:239], v[188:191]
v_mfma_f32_16x16x32_bf16 v[192:195], a[212:215], a[240:243], v[192:195]
v_mfma_f32_16x16x32_bf16 v[196:199], a[212:215], a[244:247], v[196:199]
v_mfma_f32_16x16x32_bf16 v[200:203], a[212:215], a[248:251], v[200:203]
v_mfma_f32_16x16x32_bf16 v[204:207], a[212:215], a[252:255], v[204:207]
s_add_u32 s54, s4, s3
s_add_u32 s54, s54, s5
s_cmp_eq_u32 s54, 0
s_cbranch_scc0 L_tsx
v_lshrrev_b32 v5, 3, v1
v_mul_u32_u24 v5, 4352, v5
v_and_b32 v6, 7, v1
v_lshl_add_u32 v5, v6, 2, v5
v_add_u32 v5, 0x1000800, v5
v_add_u32 v6, 34816, v5
v_add_u32 v7, 69632, v5
v_add_u32 v8, 104448, v5
s_add_u32 s55, s33, 1
s_mov_b32 s32, 65536
L_ts:
global_load_dword v36, v5, s[52:53] sc1
global_load_dword v37, v6, s[52:53] sc1
global_load_dword v38, v7, s[52:53] sc1
global_load_dword v39, v8, s[52:53] sc1
s_waitcnt vmcnt(0)
v_subrev_u32 v36, s55, v36
v_subrev_u32 v37, s55, v37
v_subrev_u32 v38, s55, v38
v_subrev_u32 v39, s55, v39
v_or_b32 v36, v36, v37
v_or3_b32 v36, v36, v38, v39
v_cmp_lt_u32 vcc, 3, v36
s_nop 1
s_cmp_eq_u64 vcc, 0
s_cbranch_scc1 L_tsd
s_sleep 16
s_sub_u32 s32, s32, 1
s_cmp_lg_u32 s32, 0
s_cbranch_scc1 L_ts
L_tsd:
v_mov_b32 v5, s33
v_mov_b32 v6, 0xf00000
s_mov_b64 exec, 1
global_store_dword v6, v5, s[52:53] sc1
s_mov_b64 exec, -1
L_tsx:
s_cmp_eq_u32 s3, 0
s_cbranch_scc0 L_wpd23
s_lshl_b32 s54, 1, 4
s_add_u32 s54, s54, s4
s_mul_i32 s54, s54, 4352
s_lshl_b32 s55, s5, 2
s_add_u32 s54, s54, s55
s_add_u32 s54, s54, 0x1000800
v_mov_b32 v6, s54
s_sub_u32 s54, s54, s55
v_and_b32 v6, 7, v1
v_lshl_add_u32 v6, v6, 2, s54
s_add_u32 s55, s33, 4
s_mov_b32 s32, 65536
L_wp23:
global_load_dword v11, v6, s[52:53] sc1
s_waitcnt vmcnt(0)
v_subrev_u32 v11, s55, v11
v_cmp_lt_u32 vcc, 0, v11
s_nop 1
s_cmp_eq_u64 vcc, 0
s_cbranch_scc1 L_wpd23
s_sleep 16
s_sub_u32 s32, s32, 1
s_cmp_lg_u32 s32, 0
s_cbranch_scc1 L_wp23
L_wpd23:
s_barrier
s_nop 4
s_mov_b32 s100, 0
v_cvt_pk_bf16_f32 v48, v48, v49
v_cvt_pk_bf16_f32 v49, v50, v51
v_cvt_pk_bf16_f32 v50, v68, v69
v_cvt_pk_bf16_f32 v51, v70, v71
buffer_store_dwordx4 v[48:51], v4, s[24:27], s100 offen offset:0 sc1
v_cvt_pk_bf16_f32 v52, v52, v53
v_cvt_pk_bf16_f32 v53, v54, v55
v_cvt_pk_bf16_f32 v54, v72, v73
v_cvt_pk_bf16_f32 v55, v74, v75
buffer_store_dwordx4 v[52:55], v4, s[24:27], s100 offen offset:1024 sc1
v_cvt_pk_bf16_f32 v56, v56, v57
v_cvt_pk_bf16_f32 v57, v58, v59
v_cvt_pk_bf16_f32 v58, v76, v77
v_cvt_pk_bf16_f32 v59, v78, v79
buffer_store_dwordx4 v[56:59], v4, s[24:27], s100 offen offset:2048 sc1
v_cvt_pk_bf16_f32 v60, v60, v61
v_cvt_pk_bf16_f32 v61, v62, v63
v_cvt_pk_bf16_f32 v62, v80, v81
v_cvt_pk_bf16_f32 v63, v82, v83
buffer_store_dwordx4 v[60:63], v4, s[24:27], s100 offen offset:3072 sc1
s_mov_b32 s100, 4096
v_cvt_pk_bf16_f32 v64, v64, v65
v_cvt_pk_bf16_f32 v65, v66, v67
v_cvt_pk_bf16_f32 v66, v84, v85
v_cvt_pk_bf16_f32 v67, v86, v87
buffer_store_dwordx4 v[64:67], v4, s[24:27], s100 offen offset:0 sc1
v_cvt_pk_bf16_f32 v88, v88, v89
v_cvt_pk_bf16_f32 v89, v90, v91
v_cvt_pk_bf16_f32 v90, v108, v109
v_cvt_pk_bf16_f32 v91, v110, v111
buffer_store_dwordx4 v[88:91], v4, s[24:27], s100 offen offset:1024 sc1
v_cvt_pk_bf16_f32 v92, v92, v93
v_cvt_pk_bf16_f32 v93, v94, v95
v_cvt_pk_bf16_f32 v94, v112, v113
v_cvt_pk_bf16_f32 v95, v114, v115
buffer_store_dwordx4 v[92:95], v4, s[24:27], s100 offen offset:2048 sc1
v_cvt_pk_bf16_f32 v96, v96, v97
v_cvt_pk_bf16_f32 v97, v98, v99
v_cvt_pk_bf16_f32 v98, v116, v117
v_cvt_pk_bf16_f32 v99, v118, v119
buffer_store_dwordx4 v[96:99], v4, s[24:27], s100 offen offset:3072 sc1
s_mov_b32 s100, 8192
v_cvt_pk_bf16_f32 v100, v100, v101
v_cvt_pk_bf16_f32 v101, v102, v103
v_cvt_pk_bf16_f32 v102, v120, v121
v_cvt_pk_bf16_f32 v103, v122, v123
buffer_store_dwordx4 v[100:103], v4, s[24:27], s100 offen offset:0 sc1
v_cvt_pk_bf16_f32 v104, v104, v105
v_cvt_pk_bf16_f32 v105, v106, v107
v_cvt_pk_bf16_f32 v106, v124, v125
v_cvt_pk_bf16_f32 v107, v126, v127
buffer_store_dwordx4 v[104:107], v4, s[24:27], s100 offen offset:1024 sc1
v_cvt_pk_bf16_f32 v128, v128, v129
v_cvt_pk_bf16_f32 v129, v130, v131
v_cvt_pk_bf16_f32 v130, v148, v149
v_cvt_pk_bf16_f32 v131, v150, v151
buffer_store_dwordx4 v[128:131], v4, s[24:27], s100 offen offset:2048 sc1
v_cvt_pk_bf16_f32 v132, v132, v133
v_cvt_pk_bf16_f32 v133, v134, v135
v_cvt_pk_bf16_f32 v134, v152, v153
v_cvt_pk_bf16_f32 v135, v154, v155
buffer_store_dwordx4 v[132:135], v4, s[24:27], s100 offen offset:3072 sc1
s_mov_b32 s100, 12288
v_cvt_pk_bf16_f32 v136, v136, v137
v_cvt_pk_bf16_f32 v137, v138, v139
v_cvt_pk_bf16_f32 v138, v156, v157
v_cvt_pk_bf16_f32 v139, v158, v159
buffer_store_dwordx4 v[136:139], v4, s[24:27], s100 offen offset:0 sc1
v_cvt_pk_bf16_f32 v140, v140, v141
v_cvt_pk_bf16_f32 v141, v142, v143
v_cvt_pk_bf16_f32 v142, v160, v161
v_cvt_pk_bf16_f32 v143, v162, v163
buffer_store_dwordx4 v[140:143], v4, s[24:27], s100 offen offset:1024 sc1
v_cvt_pk_bf16_f32 v144, v144, v145
v_cvt_pk_bf16_f32 v145, v146, v147
v_cvt_pk_bf16_f32 v146, v164, v165
v_cvt_pk_bf16_f32 v147, v166, v167
buffer_store_dwordx4 v[144:147], v4, s[24:27], s100 offen offset:2048 sc1
v_cvt_pk_bf16_f32 v168, v168, v169
v_cvt_pk_bf16_f32 v169, v170, v171
v_cvt_pk_bf16_f32 v170, v188, v189
v_cvt_pk_bf16_f32 v171, v190, v191
buffer_store_dwordx4 v[168:171], v4, s[24:27], s100 offen offset:3072 sc1
s_mov_b32 s100, 16384
v_cvt_pk_bf16_f32 v172, v172, v173
v_cvt_pk_bf16_f32 v173, v174, v175
v_cvt_pk_bf16_f32 v174, v192, v193
v_cvt_pk_bf16_f32 v175, v194, v195
buffer_store_dwordx4 v[172:175], v4, s[24:27], s100 offen offset:0 sc1
v_cvt_pk_bf16_f32 v176, v176, v177
v_cvt_pk_bf16_f32 v177, v178, v179
v_cvt_pk_bf16_f32 v178, v196, v197
v_cvt_pk_bf16_f32 v179, v198, v199
buffer_store_dwordx4 v[176:179], v4, s[24:27], s100 offen offset:1024 sc1
v_cvt_pk_bf16_f32 v180, v180, v181
v_cvt_pk_bf16_f32 v181, v182, v183
v_cvt_pk_bf16_f32 v182, v200, v201
v_cvt_pk_bf16_f32 v183, v202, v203
buffer_store_dwordx4 v[180:183], v4, s[24:27], s100 offen offset:2048 sc1
v_cvt_pk_bf16_f32 v184, v184, v185
v_cvt_pk_bf16_f32 v185, v186, v187
v_cvt_pk_bf16_f32 v186, v204, v205
v_cvt_pk_bf16_f32 v187, v206, v207
buffer_store_dwordx4 v[184:187], v4, s[24:27], s100 offen offset:3072 sc1
L_go:
s_lshl_b32 s54, s6, 4
s_add_u32 s54, s54, s4
s_mul_i32 s54, s54, 6144
s_lshl_b32 s55, s5, 2
s_add_u32 s54, s54, s55
s_add_u32 s54, s54, 0x1100000
v_mul_u32_u24 v6, 384, v1
v_add_u32 v6, s54, v6
v_mov_b32 v5, s33
s_cmp_eq_u32 s3, 0
s_waitcnt vmcnt(0)
s_barrier
s_cbranch_scc0 L_nosig
s_mov_b64 exec, 0xffff
global_store_dword v6, v5, s[52:53] sc1
s_mov_b64 exec, -1
L_nosig:
s_mul_i32 s54, s4, 163840
s_add_u32 s28, s48, s54
s_addc_u32 s29, s49, 0
s_mov_b32 s30, 0x28000
s_mov_b32 s31, 0x20000
v_lshlrev_b32 v7, 11, v3
v_lshl_add_u32 v7, v2, 4, v7
v_lshlrev_b32 v8, 2, v1
v_lshrrev_b32 v14, 2, v1
v_lshlrev_b32 v14, 11, v14
v_and_b32 v36, 12, v8
v_add_u32 v14, v14, v36
s_mul_i32 s34, s6, 3
L_red:
s_lshr_b32 s100, s34, 1
s_and_b32 s101, s34, 1
s_lshl_b32 s54, s100, 4
s_add_u32 s54, s54, s4
s_lshl_b32 s57, s54, 1
s_add_u32 s57, s57, s6
s_lshl_b32 s57, s57, 3
s_add_u32 s57, s57, s5
s_mul_i32 s57, s57, 384
s_add_u32 s57, s57, 0x1100000
s_mul_i32 s54, s54, 655360
s_add_u32 s54, s54, 0x2000000
s_add_u32 s24, s52, s54
s_addc_u32 s25, s53, 0
s_mov_b32 s26, 0xa0000
s_mov_b32 s27, 0x20000
s_lshl_b32 s54, s5, 1
s_add_u32 s54, s54, s101
s_lshl_b32 s95, s54, 6
s_mul_i32 s54, s54, 5120
s_lshl_b32 s55, s3, 10
s_add_u32 s55, s55, s54
s_lshl_b32 s56, s3, 8
s_add_u32 s56, s56, s54
s_add_u32 s56, s56, 4096
s_lshl_b32 s100, s100, 10
s_add_u32 s95, s95, s100
s_lshl_b32 s100, s3, 4
s_add_u32 s96, s95, s100
s_add_u32 s96, s96, 131072
s_lshl_b32 s100, s3, 15
s_add_u32 s95, s95, s100
s_cmp_eq_u32 s3, 0
s_cbranch_scc0 L_polld
v_and_b32 v6, 7, v1
v_lshl_add_u32 v6, v6, 2, s57
s_mov_b32 s32, 65536
L_poll:
global_load_dword v10, v6, s[52:53] sc1
s_waitcnt vmcnt(0)
v_cmp_ne_u32 vcc, s33, v10
s_nop 1
s_cmp_eq_u64 vcc, 0
s_cbranch_scc1 L_polld
s_sleep 4
s_sub_u32 s32, s32, 1
s_cmp_lg_u32 s32, 0
s_cbranch_scc1 L_poll
L_polld:
s_barrier
buffer_load_dwordx4 v[48:51], v4, s[24:27], s55 offen sc1
buffer_load_dword v80, v8, s[24:27], s56 offen sc1
s_add_u32 s55, s55, 81920
s_add_u32 s56, s56, 81920
buffer_load_dwordx4 v[52:55], v4, s[24:27], s55 offen sc1
buffer_load_dword v81, v8, s[24:27], s56 offen sc1
s_add_u32 s55, s55, 81920
s_add_u32 s56, s56, 81920
buffer_load_dwordx4 v[56:59], v4, s[24:27], s55 offen sc1
buffer_load_dword v82, v8, s[24:27], s56 offen sc1
s_add_u32 s55, s55, 81920
s_add_u32 s56, s56, 81920
buffer_load_dwordx4 v[60:63], v4, s[24:27], s55 offen sc1
buffer_load_dword v83, v8, s[24:27], s56 offen sc1
s_add_u32 s55, s55, 81920
s_add_u32 s56, s56, 81920
buffer_load_dwordx4 v[64:67], v4, s[24:27], s55 offen sc1
buffer_load_dword v84, v8, s[24:27], s56 offen sc1
s_add_u32 s55, s55, 81920
s_add_u32 s56, s56, 81920
buffer_load_dwordx4 v[68:71], v4, s[24:27], s55 offen sc1
buffer_load_dword v85, v8, s[24:27], s56 offen sc1
s_add_u32 s55, s55, 81920
s_add_u32 s56, s56, 81920
buffer_load_dwordx4 v[72:75], v4, s[24:27], s55 offen sc1
buffer_load_dword v86, v8, s[24:27], s56 offen sc1
s_add_u32 s55, s55, 81920
s_add_u32 s56, s56, 81920
buffer_load_dwordx4 v[76:79], v4, s[24:27], s55 offen sc1
buffer_load_dword v87, v8, s[24:27], s56 offen sc1
s_add_u32 s55, s55, 81920
s_add_u32 s56, s56, 81920
s_waitcnt vmcnt(12)
v_lshlrev_b32 v160, 16, v48
v_and_b32 v161, 0xffff0000, v48
v_lshlrev_b32 v162, 16, v49
v_and_b32 v163, 0xffff0000, v49
v_lshlrev_b32 v164, 16, v50
v_and_b32 v165, 0xffff0000, v50
v_lshlrev_b32 v166, 16, v51
v_and_b32 v167, 0xffff0000, v51
v_lshlrev_b32 v168, 16, v80
v_and_b32 v169, 0xffff0000, v80
v_lshlrev_b32 v36, 16, v52
v_and_b32 v37, 0xffff0000, v52
v_pk_add_f32 v[160:161], v[160:161], v[36:37]
v_lshlrev_b32 v36, 16, v53
v_and_b32 v37, 0xffff0000, v53
v_pk_add_f32 v[162:163], v[162:163], v[36:37]
v_lshlrev_b32 v36, 16, v54
v_and_b32 v37, 0xffff0000, v54
v_pk_add_f32 v[164:165], v[164:165], v[36:37]
v_lshlrev_b32 v36, 16, v55
v_and_b32 v37, 0xffff0000, v55
v_pk_add_f32 v[166:167], v[166:167], v[36:37]
v_lshlrev_b32 v36, 16, v81
v_and_b32 v37, 0xffff0000, v81
v_pk_add_f32 v[168:169], v[168:169], v[36:37]
s_waitcnt vmcnt(8)
v_lshlrev_b32 v36, 16, v56
v_and_b32 v37, 0xffff0000, v56
v_pk_add_f32 v[160:161], v[160:161], v[36:37]
v_lshlrev_b32 v36, 16, v57
v_and_b32 v37, 0xffff0000, v57
v_pk_add_f32 v[162:163], v[162:163], v[36:37]
v_lshlrev_b32 v36, 16, v58
v_and_b32 v37, 0xffff0000, v58
v_pk_add_f32 v[164:165], v[164:165], v[36:37]
v_lshlrev_b32 v36, 16, v59
v_and_b32 v37, 0xffff0000, v59
v_pk_add_f32 v[166:167], v[166:167], v[36:37]
v_lshlrev_b32 v36, 16, v82
v_and_b32 v37, 0xffff0000, v82
v_pk_add_f32 v[168:169], v[168:169], v[36:37]
v_lshlrev_b32 v36, 16, v60
v_and_b32 v37, 0xffff0000, v60
v_pk_add_f32 v[160:161], v[160:161], v[36:37]
v_lshlrev_b32 v36, 16, v61
v_and_b32 v37, 0xffff0000, v61
v_pk_add_f32 v[162:163], v[162:163], v[36:37]
v_lshlrev_b32 v36, 16, v62
v_and_b32 v37, 0xffff0000, v62
v_pk_add_f32 v[164:165], v[164:165], v[36:37]
v_lshlrev_b32 v36, 16, v63
v_and_b32 v37, 0xffff0000, v63
v_pk_add_f32 v[166:167], v[166:167], v[36:37]
v_lshlrev_b32 v36, 16, v83
v_and_b32 v37, 0xffff0000, v83
v_pk_add_f32 v[168:169], v[168:169], v[36:37]
s_waitcnt vmcnt(4)
v_lshlrev_b32 v36, 16, v64
v_and_b32 v37, 0xffff0000, v64
v_pk_add_f32 v[160:161], v[160:161], v[36:37]
v_lshlrev_b32 v36, 16, v65
v_and_b32 v37, 0xffff0000, v65
v_pk_add_f32 v[162:163], v[162:163], v[36:37]
v_lshlrev_b32 v36, 16, v66
v_and_b32 v37, 0xffff0000, v66
v_pk_add_f32 v[164:165], v[164:165], v[36:37]
v_lshlrev_b32 v36, 16, v67
v_and_b32 v37, 0xffff0000, v67
v_pk_add_f32 v[166:167], v[166:167], v[36:37]
v_lshlrev_b32 v36, 16, v84
v_and_b32 v37, 0xffff0000, v84
v_pk_add_f32 v[168:169], v[168:169], v[36:37]
v_lshlrev_b32 v36, 16, v68
v_and_b32 v37, 0xffff0000, v68
v_pk_add_f32 v[160:161], v[160:161], v[36:37]
v_lshlrev_b32 v36, 16, v69
v_and_b32 v37, 0xffff0000, v69
v_pk_add_f32 v[162:163], v[162:163], v[36:37]
v_lshlrev_b32 v36, 16, v70
v_and_b32 v37, 0xffff0000, v70
v_pk_add_f32 v[164:165], v[164:165], v[36:37]
v_lshlrev_b32 v36, 16, v71
v_and_b32 v37, 0xffff0000, v71
v_pk_add_f32 v[166:167], v[166:167], v[36:37]
v_lshlrev_b32 v36, 16, v85
v_and_b32 v37, 0xffff0000, v85
v_pk_add_f32 v[168:169], v[168:169], v[36:37]
s_waitcnt vmcnt(0)
v_lshlrev_b32 v36, 16, v72
v_and_b32 v37, 0xffff0000, v72
v_pk_add_f32 v[160:161], v[160:161], v[36:37]
v_lshlrev_b32 v36, 16, v73
v_and_b32 v37, 0xffff0000, v73
v_pk_add_f32 v[162:163], v[162:163], v[36:37]
v_lshlrev_b32 v36, 16, v74
v_and_b32 v37, 0xffff0000, v74
v_pk_add_f32 v[164:165], v[164:165], v[36:37]
v_lshlrev_b32 v36, 16, v75
v_and_b32 v37, 0xffff0000, v75
v_pk_add_f32 v[166:167], v[166:167], v[36:37]
v_lshlrev_b32 v36, 16, v86
v_and_b32 v37, 0xffff0000, v86
v_pk_add_f32 v[168:169], v[168:169], v[36:37]
v_lshlrev_b32 v36, 16, v76
v_and_b32 v37, 0xffff0000, v76
v_pk_add_f32 v[160:161], v[160:161], v[36:37]
v_lshlrev_b32 v36, 16, v77
v_and_b32 v37, 0xffff0000, v77
v_pk_add_f32 v[162:163], v[162:163], v[36:37]
v_lshlrev_b32 v36, 16, v78
v_and_b32 v37, 0xffff0000, v78
v_pk_add_f32 v[164:165], v[164:165], v[36:37]
v_lshlrev_b32 v36, 16, v79
v_and_b32 v37, 0xffff0000, v79
v_pk_add_f32 v[166:167], v[166:167], v[36:37]
v_lshlrev_b32 v36, 16, v87
v_and_b32 v37, 0xffff0000, v87
v_pk_add_f32 v[168:169], v[168:169], v[36:37]
v_cvt_pk_bf16_f32 v172, v160, v161
v_cvt_pk_bf16_f32 v173, v162, v163
v_cvt_pk_bf16_f32 v174, v164, v165
v_cvt_pk_bf16_f32 v175, v166, v167
v_cvt_pk_bf16_f32 v176, v168, v169
buffer_store_dwordx4 v[172:175], v7, s[28:31], s95 offen
buffer_store_dword v176, v14, s[28:31], s96 offen
s_add_u32 s34, s34, 1
s_cmp_lt_u32 s34, 3
s_cbranch_scc1 L_red
L_fin:
L_end:
s_endpgm
F_gemm:
s_cbranch_vccnz L_gb24
L_gb24_ret:
s_waitcnt vmcnt(8)
v_mfma_f32_16x16x32_bf16 v[48:51], a[152:155], a[216:219], v[48:51]
ds_read_b64_tr_b16 a[184:185], v20 offset:8192
v_mfma_f32_16x16x32_bf16 v[52:55], a[152:155], a[220:223], v[52:55]
ds_read_b64_tr_b16 a[186:187], v20 offset:12288
v_mfma_f32_16x16x32_bf16 v[56:59], a[152:155], a[224:227], v[56:59]
ds_read_b64_tr_b16 a[188:189], v21 offset:8192
v_mfma_f32_16x16x32_bf16 v[60:63], a[152:155], a[228:231], v[60:63]
ds_read_b64_tr_b16 a[190:191], v21 offset:12288
v_mfma_f32_16x16x32_bf16 v[64:67], a[152:155], a[232:235], v[64:67]
ds_read_b64_tr_b16 a[192:193], v22 offset:8192
v_mfma_f32_16x16x32_bf16 v[68:71], a[156:159], a[216:219], v[68:71]
ds_read_b64_tr_b16 a[194:195], v22 offset:12288
v_mfma_f32_16x16x32_bf16 v[72:75], a[156:159], a[220:223], v[72:75]
ds_read_b64_tr_b16 a[196:197], v23 offset:8192
v_mfma_f32_16x16x32_bf16 v[76:79], a[156:159], a[224:227], v[76:79]
ds_read_b64_tr_b16 a[198:199], v23 offset:12288
v_mfma_f32_16x16x32_bf16 v[80:83], a[156:159], a[228:231], v[80:83]
ds_read_b64_tr_b16 a[200:201], v24 offset:8192
v_mfma_f32_16x16x32_bf16 v[84:87], a[156:159], a[232:235], v[84:87]
ds_read_b64_tr_b16 a[202:203], v24 offset:12288
v_mfma_f32_16x16x32_bf16 v[88:91], a[160:163], a[216:219], v[88:91]
ds_read_b64_tr_b16 a[204:205], v25 offset:8192
v_mfma_f32_16x16x32_bf16 v[92:95], a[160:163], a[220:223], v[92:95]
ds_read_b64_tr_b16 a[206:207], v25 offset:12288
v_mfma_f32_16x16x32_bf16 v[96:99], a[160:163], a[224:227], v[96:99]
ds_read_b64_tr_b16 a[208:209], v26 offset:8192
v_mfma_f32_16x16x32_bf16 v[100:103], a[160:163], a[228:231], v[100:103]
ds_read_b64_tr_b16 a[210:211], v26 offset:12288
v_mfma_f32_16x16x32_bf16 v[104:107], a[160:163], a[232:235], v[104:107]
ds_read_b64_tr_b16 a[212:213], v27 offset:8192
v_mfma_f32_16x16x32_bf16 v[108:111], a[164:167], a[216:219], v[108:111]
ds_read_b64_tr_b16 a[214:215], v27 offset:12288
v_mfma_f32_16x16x32_bf16 v[112:115], a[164:167], a[220:223], v[112:115]
ds_read_b128 a[236:239], v17 offset:0
v_mfma_f32_16x16x32_bf16 v[116:119], a[164:167], a[224:227], v[116:119]
ds_read_b128 a[240:243], v17 offset:4096
v_mfma_f32_16x16x32_bf16 v[120:123], a[164:167], a[228:231], v[120:123]
ds_read_b128 a[244:247], v17 offset:8192
v_mfma_f32_16x16x32_bf16 v[124:127], a[164:167], a[232:235], v[124:127]
ds_read_b128 a[248:251], v17 offset:12288
v_mfma_f32_16x16x32_bf16 v[128:131], a[168:171], a[216:219], v[128:131]
ds_read_b128 a[252:255], v17 offset:16384
v_mfma_f32_16x16x32_bf16 v[132:135], a[168:171], a[220:223], v[132:135]
s_cmp_gt_i32 s91, 0
s_cselect_b32 s92, s88, 0x7f000000
v_mfma_f32_16x16x32_bf16 v[136:139], a[168:171], a[224:227], v[136:139]
s_sub_u32 s91, s91, 1
s_add_u32 s88, s88, s89
v_mfma_f32_16x16x32_bf16 v[140:143], a[168:171], a[228:231], v[140:143]
s_and_b32 s88, s88, s90
s_add_u32 m0, s93, 8192
v_mfma_f32_16x16x32_bf16 v[144:147], a[168:171], a[232:235], v[144:147]
s_waitcnt lgkmcnt(5)
buffer_load_dwordx4 v244, s[16:19], s92 offen offset:0 lds
v_mfma_f32_16x16x32_bf16 v[148:151], a[172:175], a[216:219], v[148:151]
v_mfma_f32_16x16x32_bf16 v[152:155], a[172:175], a[220:223], v[152:155]
buffer_load_dwordx4 v245, s[16:19], s92 offen offset:1024 lds
v_mfma_f32_16x16x32_bf16 v[156:159], a[172:175], a[224:227], v[156:159]
v_mfma_f32_16x16x32_bf16 v[160:163], a[172:175], a[228:231], v[160:163]
buffer_load_dwordx4 v246, s[16:19], s92 offen offset:2048 lds
v_mfma_f32_16x16x32_bf16 v[164:167], a[172:175], a[232:235], v[164:167]
v_mfma_f32_16x16x32_bf16 v[168:171], a[176:179], a[216:219], v[168:171]
buffer_load_dwordx4 v247, s[16:19], s92 offen offset:3072 lds
v_mfma_f32_16x16x32_bf16 v[172:175], a[176:179], a[220:223], v[172:175]
s_add_u32 m0, s93, 12288
v_mfma_f32_16x16x32_bf16 v[176:179], a[176:179], a[224:227], v[176:179]
buffer_load_dwordx4 v248, s[16:19], s92 offen offset:0 lds
v_mfma_f32_16x16x32_bf16 v[180:183], a[176:179], a[228:231], v[180:183]
v_mfma_f32_16x16x32_bf16 v[184:187], a[176:179], a[232:235], v[184:187]
buffer_load_dwordx4 v249, s[16:19], s92 offen offset:1024 lds
v_mfma_f32_16x16x32_bf16 v[188:191], a[180:183], a[216:219], v[188:191]
v_mfma_f32_16x16x32_bf16 v[192:195], a[180:183], a[220:223], v[192:195]
buffer_load_dwordx4 v250, s[16:19], s92 offen offset:2048 lds
v_mfma_f32_16x16x32_bf16 v[196:199], a[180:183], a[224:227], v[196:199]
v_mfma_f32_16x16x32_bf16 v[200:203], a[180:183], a[228:231], v[200:203]
v_mfma_f32_16x16x32_bf16 v[204:207], a[180:183], a[232:235], v[204:207]
s_waitcnt lgkmcnt(0)
buffer_load_dwordx4 v251, s[16:19], s92 offen offset:3072 lds
F_gemm1:
s_cbranch_vccnz L_gb25
L_gb25_ret:
s_waitcnt vmcnt(8)
v_mfma_f32_16x16x32_bf16 v[48:51], a[184:187], a[236:239], v[48:51]
ds_read_b64_tr_b16 a[152:153], v20 offset:0
v_mfma_f32_16x16x32_bf16 v[52:55], a[184:187], a[240:243], v[52:55]
ds_read_b64_tr_b16 a[154:155], v20 offset:4096
v_mfma_f32_16x16x32_bf16 v[56:59], a[184:187], a[244:247], v[56:59]
ds_read_b64_tr_b16 a[156:157], v21 offset:0
v_mfma_f32_16x16x32_bf16 v[60:63], a[184:187], a[248:251], v[60:63]
ds_read_b64_tr_b16 a[158:159], v21 offset:4096
v_mfma_f32_16x16x32_bf16 v[64:67], a[184:187], a[252:255], v[64:67]
ds_read_b64_tr_b16 a[160:161], v22 offset:0
v_mfma_f32_16x16x32_bf16 v[68:71], a[188:191], a[236:239], v[68:71]
ds_read_b64_tr_b16 a[162:163], v22 offset:4096
v_mfma_f32_16x16x32_bf16 v[72:75], a[188:191], a[240:243], v[72:75]
ds_read_b64_tr_b16 a[164:165], v23 offset:0
v_mfma_f32_16x16x32_bf16 v[76:79], a[188:191], a[244:247], v[76:79]
ds_read_b64_tr_b16 a[166:167], v23 offset:4096
v_mfma_f32_16x16x32_bf16 v[80:83], a[188:191], a[248:251], v[80:83]
ds_read_b64_tr_b16 a[168:169], v24 offset:0
v_mfma_f32_16x16x32_bf16 v[84:87], a[188:191], a[252:255], v[84:87]
ds_read_b64_tr_b16 a[170:171], v24 offset:4096
v_mfma_f32_16x16x32_bf16 v[88:91], a[192:195], a[236:239], v[88:91]
ds_read_b64_tr_b16 a[172:173], v25 offset:0
v_mfma_f32_16x16x32_bf16 v[92:95], a[192:195], a[240:243], v[92:95]
ds_read_b64_tr_b16 a[174:175], v25 offset:4096
v_mfma_f32_16x16x32_bf16 v[96:99], a[192:195], a[244:247], v[96:99]
ds_read_b64_tr_b16 a[176:177], v26 offset:0
v_mfma_f32_16x16x32_bf16 v[100:103], a[192:195], a[248:251], v[100:103]
ds_read_b64_tr_b16 a[178:179], v26 offset:4096
v_mfma_f32_16x16x32_bf16 v[104:107], a[192:195], a[252:255], v[104:107]
ds_read_b64_tr_b16 a[180:181], v27 offset:0
v_mfma_f32_16x16x32_bf16 v[108:111], a[196:199], a[236:239], v[108:111]
ds_read_b64_tr_b16 a[182:183], v27 offset:4096
v_mfma_f32_16x16x32_bf16 v[112:115], a[196:199], a[240:243], v[112:115]
ds_read_b128 a[216:219], v18 offset:0
v_mfma_f32_16x16x32_bf16 v[116:119], a[196:199], a[244:247], v[116:119]
ds_read_b128 a[220:223], v18 offset:4096
v_mfma_f32_16x16x32_bf16 v[120:123], a[196:199], a[248:251], v[120:123]
ds_read_b128 a[224:227], v18 offset:8192
v_mfma_f32_16x16x32_bf16 v[124:127], a[196:199], a[252:255], v[124:127]
ds_read_b128 a[228:231], v18 offset:12288
v_mfma_f32_16x16x32_bf16 v[128:131], a[200:203], a[236:239], v[128:131]
ds_read_b128 a[232:235], v18 offset:16384
v_mfma_f32_16x16x32_bf16 v[132:135], a[200:203], a[240:243], v[132:135]
s_cmp_gt_i32 s91, 0
s_cselect_b32 s92, s88, 0x7f000000
v_mfma_f32_16x16x32_bf16 v[136:139], a[200:203], a[244:247], v[136:139]
s_sub_u32 s91, s91, 1
s_add_u32 s88, s88, s89
v_mfma_f32_16x16x32_bf16 v[140:143], a[200:203], a[248:251], v[140:143]
s_and_b32 s88, s88, s90
s_add_u32 m0, s93, 0
v_mfma_f32_16x16x32_bf16 v[144:147], a[200:203], a[252:255], v[144:147]
s_waitcnt lgkmcnt(5)
buffer_load_dwordx4 v244, s[16:19], s92 offen offset:0 lds
v_mfma_f32_16x16x32_bf16 v[148:151], a[204:207], a[236:239], v[148:151]
v_mfma_f32_16x16x32_bf16 v[152:155], a[204:207], a[240:243], v[152:155]
buffer_load_dwordx4 v245, s[16:19], s92 offen offset:1024 lds
v_mfma_f32_16x16x32_bf16 v[156:159], a[204:207], a[244:247], v[156:159]
v_mfma_f32_16x16x32_bf16 v[160:163], a[204:207], a[248:251], v[160:163]
buffer_load_dwordx4 v246, s[16:19], s92 offen offset:2048 lds
v_mfma_f32_16x16x32_bf16 v[164:167], a[204:207], a[252:255], v[164:167]
v_mfma_f32_16x16x32_bf16 v[168:171], a[208:211], a[236:239], v[168:171]
buffer_load_dwordx4 v247, s[16:19], s92 offen offset:3072 lds
v_mfma_f32_16x16x32_bf16 v[172:175], a[208:211], a[240:243], v[172:175]
s_add_u32 m0, s93, 4096
v_mfma_f32_16x16x32_bf16 v[176:179], a[208:211], a[244:247], v[176:179]
buffer_load_dwordx4 v248, s[16:19], s92 offen offset:0 lds
v_mfma_f32_16x16x32_bf16 v[180:183], a[208:211], a[248:251], v[180:183]
v_mfma_f32_16x16x32_bf16 v[184:187], a[208:211], a[252:255], v[184:187]
buffer_load_dwordx4 v249, s[16:19], s92 offen offset:1024 lds
v_mfma_f32_16x16x32_bf16 v[188:191], a[212:215], a[236:239], v[188:191]
v_mfma_f32_16x16x32_bf16 v[192:195], a[212:215], a[240:243], v[192:195]
buffer_load_dwordx4 v250, s[16:19], s92 offen offset:2048 lds
v_mfma_f32_16x16x32_bf16 v[196:199], a[212:215], a[244:247], v[196:199]
v_mfma_f32_16x16x32_bf16 v[200:203], a[212:215], a[248:251], v[200:203]
v_mfma_f32_16x16x32_bf16 v[204:207], a[212:215], a[252:255], v[204:207]
s_waitcnt lgkmcnt(0)
buffer_load_dwordx4 v251, s[16:19], s92 offen offset:3072 lds
s_cbranch_vccnz L_gb26
L_gb26_ret:
s_waitcnt vmcnt(8)
v_mfma_f32_16x16x32_bf16 v[48:51], a[152:155], a[216:219], v[48:51]
ds_read_b64_tr_b16 a[184:185], v20 offset:8192
v_mfma_f32_16x16x32_bf16 v[52:55], a[152:155], a[220:223], v[52:55]
ds_read_b64_tr_b16 a[186:187], v20 offset:12288
v_mfma_f32_16x16x32_bf16 v[56:59], a[152:155], a[224:227], v[56:59]
ds_read_b64_tr_b16 a[188:189], v21 offset:8192
v_mfma_f32_16x16x32_bf16 v[60:63], a[152:155], a[228:231], v[60:63]
ds_read_b64_tr_b16 a[190:191], v21 offset:12288
v_mfma_f32_16x16x32_bf16 v[64:67], a[152:155], a[232:235], v[64:67]
ds_read_b64_tr_b16 a[192:193], v22 offset:8192
v_mfma_f32_16x16x32_bf16 v[68:71], a[156:159], a[216:219], v[68:71]
ds_read_b64_tr_b16 a[194:195], v22 offset:12288
v_mfma_f32_16x16x32_bf16 v[72:75], a[156:159], a[220:223], v[72:75]
ds_read_b64_tr_b16 a[196:197], v23 offset:8192
v_mfma_f32_16x16x32_bf16 v[76:79], a[156:159], a[224:227], v[76:79]
ds_read_b64_tr_b16 a[198:199], v23 offset:12288
v_mfma_f32_16x16x32_bf16 v[80:83], a[156:159], a[228:231], v[80:83]
ds_read_b64_tr_b16 a[200:201], v24 offset:8192
v_mfma_f32_16x16x32_bf16 v[84:87], a[156:159], a[232:235], v[84:87]
ds_read_b64_tr_b16 a[202:203], v24 offset:12288
v_mfma_f32_16x16x32_bf16 v[88:91], a[160:163], a[216:219], v[88:91]
ds_read_b64_tr_b16 a[204:205], v25 offset:8192
v_mfma_f32_16x16x32_bf16 v[92:95], a[160:163], a[220:223], v[92:95]
ds_read_b64_tr_b16 a[206:207], v25 offset:12288
v_mfma_f32_16x16x32_bf16 v[96:99], a[160:163], a[224:227], v[96:99]
ds_read_b64_tr_b16 a[208:209], v26 offset:8192
v_mfma_f32_16x16x32_bf16 v[100:103], a[160:163], a[228:231], v[100:103]
ds_read_b64_tr_b16 a[210:211], v26 offset:12288
v_mfma_f32_16x16x32_bf16 v[104:107], a[160:163], a[232:235], v[104:107]
ds_read_b64_tr_b16 a[212:213], v27 offset:8192
v_mfma_f32_16x16x32_bf16 v[108:111], a[164:167], a[216:219], v[108:111]
ds_read_b64_tr_b16 a[214:215], v27 offset:12288
v_mfma_f32_16x16x32_bf16 v[112:115], a[164:167], a[220:223], v[112:115]
ds_read_b128 a[236:239], v19 offset:0
v_mfma_f32_16x16x32_bf16 v[116:119], a[164:167], a[224:227], v[116:119]
ds_read_b128 a[240:243], v19 offset:4096
v_mfma_f32_16x16x32_bf16 v[120:123], a[164:167], a[228:231], v[120:123]
ds_read_b128 a[244:247], v19 offset:8192
v_mfma_f32_16x16x32_bf16 v[124:127], a[164:167], a[232:235], v[124:127]
ds_read_b128 a[248:251], v19 offset:12288
v_mfma_f32_16x16x32_bf16 v[128:131], a[168:171], a[216:219], v[128:131]
ds_read_b128 a[252:255], v19 offset:16384
v_mfma_f32_16x16x32_bf16 v[132:135], a[168:171], a[220:223], v[132:135]
s_cmp_gt_i32 s91, 0
s_cselect_b32 s92, s88, 0x7f000000
v_mfma_f32_16x16x32_bf16 v[136:139], a[168:171], a[224:227], v[136:139]
s_sub_u32 s91, s91, 1
s_add_u32 s88, s88, s89
v_mfma_f32_16x16x32_bf16 v[140:143], a[168:171], a[228:231], v[140:143]
s_and_b32 s88, s88, s90
s_add_u32 m0, s93, 8192
v_mfma_f32_16x16x32_bf16 v[144:147], a[168:171], a[232:235], v[144:147]
s_waitcnt lgkmcnt(5)
buffer_load_dwordx4 v244, s[16:19], s92 offen offset:0 lds
v_mfma_f32_16x16x32_bf16 v[148:151], a[172:175], a[216:219], v[148:151]
v_mfma_f32_16x16x32_bf16 v[152:155], a[172:175], a[220:223], v[152:155]
buffer_load_dwordx4 v245, s[16:19], s92 offen offset:1024 lds
v_mfma_f32_16x16x32_bf16 v[156:159], a[172:175], a[224:227], v[156:159]
v_mfma_f32_16x16x32_bf16 v[160:163], a[172:175], a[228:231], v[160:163]
buffer_load_dwordx4 v246, s[16:19], s92 offen offset:2048 lds
v_mfma_f32_16x16x32_bf16 v[164:167], a[172:175], a[232:235], v[164:167]
v_mfma_f32_16x16x32_bf16 v[168:171], a[176:179], a[216:219], v[168:171]
buffer_load_dwordx4 v247, s[16:19], s92 offen offset:3072 lds
v_mfma_f32_16x16x32_bf16 v[172:175], a[176:179], a[220:223], v[172:175]
s_add_u32 m0, s93, 12288
v_mfma_f32_16x16x32_bf16 v[176:179], a[176:179], a[224:227], v[176:179]
buffer_load_dwordx4 v248, s[16:19], s92 offen offset:0 lds
v_mfma_f32_16x16x32_bf16 v[180:183], a[176:179], a[228:231], v[180:183]
v_mfma_f32_16x16x32_bf16 v[184:187], a[176:179], a[232:235], v[184:187]
buffer_load_dwordx4 v249, s[16:19], s92 offen offset:1024 lds
v_mfma_f32_16x16x32_bf16 v[188:191], a[180:183], a[216:219], v[188:191]
v_mfma_f32_16x16x32_bf16 v[192:195], a[180:183], a[220:223], v[192:195]
buffer_load_dwordx4 v250, s[16:19], s92 offen offset:2048 lds
v_mfma_f32_16x16x32_bf16 v[196:199], a[180:183], a[224:227], v[196:199]
v_mfma_f32_16x16x32_bf16 v[200:203], a[180:183], a[228:231], v[200:203]
v_mfma_f32_16x16x32_bf16 v[204:207], a[180:183], a[232:235], v[204:207]
s_waitcnt lgkmcnt(0)
buffer_load_dwordx4 v251, s[16:19], s92 offen offset:3072 lds
s_cbranch_vccnz L_gb27
L_gb27_ret:
s_waitcnt vmcnt(8)
v_add_u32 v16, 20480, v16
v_add_u32 v17, 20480, v17
v_add_u32 v18, 20480, v18
v_add_u32 v19, 20480, v19
v_mfma_f32_16x16x32_bf16 v[48:51], a[184:187], a[236:239], v[48:51]
ds_read_b64_tr_b16 a[152:153], v20 offset:0
v_mfma_f32_16x16x32_bf16 v[52:55], a[184:187], a[240:243], v[52:55]
ds_read_b64_tr_b16 a[154:155], v20 offset:4096
v_mfma_f32_16x16x32_bf16 v[56:59], a[184:187], a[244:247], v[56:59]
ds_read_b64_tr_b16 a[156:157], v21 offset:0
v_mfma_f32_16x16x32_bf16 v[60:63], a[184:187], a[248:251], v[60:63]
ds_read_b64_tr_b16 a[158:159], v21 offset:4096
v_mfma_f32_16x16x32_bf16 v[64:67], a[184:187], a[252:255], v[64:67]
ds_read_b64_tr_b16 a[160:161], v22 offset:0
v_mfma_f32_16x16x32_bf16 v[68:71], a[188:191], a[236:239], v[68:71]
ds_read_b64_tr_b16 a[162:163], v22 offset:4096
v_mfma_f32_16x16x32_bf16 v[72:75], a[188:191], a[240:243], v[72:75]
ds_read_b64_tr_b16 a[164:165], v23 offset:0
v_mfma_f32_16x16x32_bf16 v[76:79], a[188:191], a[244:247], v[76:79]
ds_read_b64_tr_b16 a[166:167], v23 offset:4096
v_mfma_f32_16x16x32_bf16 v[80:83], a[188:191], a[248:251], v[80:83]
ds_read_b64_tr_b16 a[168:169], v24 offset:0
v_mfma_f32_16x16x32_bf16 v[84:87], a[188:191], a[252:255], v[84:87]
ds_read_b64_tr_b16 a[170:171], v24 offset:4096
v_mfma_f32_16x16x32_bf16 v[88:91], a[192:195], a[236:239], v[88:91]
ds_read_b64_tr_b16 a[172:173], v25 offset:0
v_mfma_f32_16x16x32_bf16 v[92:95], a[192:195], a[240:243], v[92:95]
ds_read_b64_tr_b16 a[174:175], v25 offset:4096
v_mfma_f32_16x16x32_bf16 v[96:99], a[192:195], a[244:247], v[96:99]
ds_read_b64_tr_b16 a[176:177], v26 offset:0
v_mfma_f32_16x16x32_bf16 v[100:103], a[192:195], a[248:251], v[100:103]
ds_read_b64_tr_b16 a[178:179], v26 offset:4096
v_mfma_f32_16x16x32_bf16 v[104:107], a[192:195], a[252:255], v[104:107]
ds_read_b64_tr_b16 a[180:181], v27 offset:0
v_mfma_f32_16x16x32_bf16 v[108:111], a[196:199], a[236:239], v[108:111]
ds_read_b64_tr_b16 a[182:183], v27 offset:4096
v_mfma_f32_16x16x32_bf16 v[112:115], a[196:199], a[240:243], v[112:115]
ds_read_b128 a[216:219], v16 offset:0
v_mfma_f32_16x16x32_bf16 v[116:119], a[196:199], a[244:247], v[116:119]
ds_read_b128 a[220:223], v16 offset:4096
v_mfma_f32_16x16x32_bf16 v[120:123], a[196:199], a[248:251], v[120:123]
ds_read_b128 a[224:227], v16 offset:8192
v_mfma_f32_16x16x32_bf16 v[124:127], a[196:199], a[252:255], v[124:127]
ds_read_b128 a[228:231], v16 offset:12288
v_mfma_f32_16x16x32_bf16 v[128:131], a[200:203], a[236:239], v[128:131]
ds_read_b128 a[232:235], v16 offset:16384
v_mfma_f32_16x16x32_bf16 v[132:135], a[200:203], a[240:243], v[132:135]
s_cmp_gt_i32 s91, 0
s_cselect_b32 s92, s88, 0x7f000000
v_mfma_f32_16x16x32_bf16 v[136:139], a[200:203], a[244:247], v[136:139]
s_sub_u32 s91, s91, 1
s_add_u32 s88, s88, s89
v_mfma_f32_16x16x32_bf16 v[140:143], a[200:203], a[248:251], v[140:143]
s_and_b32 s88, s88, s90
s_add_u32 m0, s93, 0
v_mfma_f32_16x16x32_bf16 v[144:147], a[200:203], a[252:255], v[144:147]
s_waitcnt lgkmcnt(5)
buffer_load_dwordx4 v244, s[16:19], s92 offen offset:0 lds
v_mfma_f32_16x16x32_bf16 v[148:151], a[204:207], a[236:239], v[148:151]
v_mfma_f32_16x16x32_bf16 v[152:155], a[204:207], a[240:243], v[152:155]
buffer_load_dwordx4 v245, s[16:19], s92 offen offset:1024 lds
v_mfma_f32_16x16x32_bf16 v[156:159], a[204:207], a[244:247], v[156:159]
v_mfma_f32_16x16x32_bf16 v[160:163], a[204:207], a[248:251], v[160:163]
buffer_load_dwordx4 v246, s[16:19], s92 offen offset:2048 lds
v_mfma_f32_16x16x32_bf16 v[164:167], a[204:207], a[252:255], v[164:167]
v_mfma_f32_16x16x32_bf16 v[168:171], a[208:211], a[236:239], v[168:171]
buffer_load_dwordx4 v247, s[16:19], s92 offen offset:3072 lds
v_mfma_f32_16x16x32_bf16 v[172:175], a[208:211], a[240:243], v[172:175]
s_add_u32 m0, s93, 4096
v_mfma_f32_16x16x32_bf16 v[176:179], a[208:211], a[244:247], v[176:179]
buffer_load_dwordx4 v248, s[16:19], s92 offen offset:0 lds
v_mfma_f32_16x16x32_bf16 v[180:183], a[208:211], a[248:251], v[180:183]
v_mfma_f32_16x16x32_bf16 v[184:187], a[208:211], a[252:255], v[184:187]
buffer_load_dwordx4 v249, s[16:19], s92 offen offset:1024 lds
v_mfma_f32_16x16x32_bf16 v[188:191], a[212:215], a[236:239], v[188:191]
v_mfma_f32_16x16x32_bf16 v[192:195], a[212:215], a[240:243], v[192:195]
buffer_load_dwordx4 v250, s[16:19], s92 offen offset:2048 lds
v_mfma_f32_16x16x32_bf16 v[196:199], a[212:215], a[244:247], v[196:199]
v_mfma_f32_16x16x32_bf16 v[200:203], a[212:215], a[248:251], v[200:203]
v_mfma_f32_16x16x32_bf16 v[204:207], a[212:215], a[252:255], v[204:207]
s_waitcnt lgkmcnt(0)
buffer_load_dwordx4 v251, s[16:19], s92 offen offset:3072 lds
s_sub_u32 s94, s94, 1
s_cmp_lg_u32 s94, 0
s_cbranch_scc1 F_gemm
s_setpc_b64 s[60:61]
L_gb24:
s_waitcnt vmcnt(0)
s_branch L_gb24_ret
L_gb25:
s_waitcnt vmcnt(0)
s_branch L_gb25_ret
L_gb26:
s_waitcnt vmcnt(0)
s_branch L_gb26_ret
L_gb27:
s_waitcnt vmcnt(0)
s_branch L_gb27_ret
L_rare_5:
s_call_b64 s[58:59], F_rare0
s_branch L_rare_5_ret
L_rare_6:
s_call_b64 s[58:59], F_rare1
s_branch L_rare_6_ret
L_rare_7:
s_call_b64 s[58:59], F_rare0
s_branch L_rare_7_ret
L_rare_8:
s_call_b64 s[58:59], F_rare1
s_branch L_rare_8_ret
L_rare_9:
s_call_b64 s[58:59], F_rare0
s_branch L_rare_9_ret
L_rare_10:
s_call_b64 s[58:59], F_rare1
s_branch L_rare_10_ret
L_rare_14:
s_call_b64 s[58:59], F_rare0
s_branch L_rare_14_ret
L_rare_15:
s_call_b64 s[58:59], F_rare1
s_branch L_rare_15_ret
L_rare_16:
s_call_b64 s[58:59], F_rare0
s_branch L_rare_16_ret
L_rare_17:
s_call_b64 s[58:59], F_rare1
s_branch L_rare_17_ret
L_rare_18:
s_call_b64 s[58:59], F_rare0
s_branch L_rare_18_ret
L_rare_19:
s_call_b64 s[58:59], F_rare1
s_branch L_rare_19_ret
L_rare_20:
s_call_b64 s[58:59], F_rare0
s_branch L_rare_20_ret
L_rare_21:
s_call_b64 s[58:59], F_rare1
s_branch L_rare_21_ret
F_rare0:
s_nop 7
v_max3_f32 v36, v48, v49, v50
v_max3_f32 v36, v36, v51, v68
v_max3_f32 v36, v36, v69, v70
v_max_f32 v36, v36, v71
v_mov_b32 v37, v36
s_nop 1
v_permlane32_swap_b32 v36, v37
s_nop 1
v_max_f32 v36, v36, v37
v_mov_b32 v37, v36
s_nop 1
v_permlane16_swap_b32 v36, v37
s_nop 1
v_max_f32 v36, v36, v37
v_add_f32 v36, 0x41000000, v36
v_max_f32 v36, 0, v36
v_sub_f32 v37, 0, v36
v_exp_f32 v37, v37
v_sub_f32 v48, v48, v36
v_sub_f32 v49, v49, v36
v_sub_f32 v50, v50, v36
v_sub_f32 v51, v51, v36
v_sub_f32 v68, v68, v36
v_sub_f32 v69, v69, v36
v_sub_f32 v70, v70, v36
v_sub_f32 v71, v71, v36
v_sub_f32 v88, v88, v36
v_sub_f32 v89, v89, v36
v_sub_f32 v90, v90, v36
v_sub_f32 v91, v91, v36
v_sub_f32 v108, v108, v36
v_sub_f32 v109, v109, v36
v_sub_f32 v110, v110, v36
v_sub_f32 v111, v111, v36
v_sub_f32 v168, v168, v36
v_mul_f32 v220, v220, v37
v_sub_f32 v169, v169, v36
v_mul_f32 v221, v221, v37
v_sub_f32 v170, v170, v36
v_mul_f32 v222, v222, v37
v_sub_f32 v171, v171, v36
v_mul_f32 v223, v223, v37
v_accvgpr_read_b32 v40, a0
v_accvgpr_read_b32 v41, a1
v_accvgpr_read_b32 v42, a2
v_accvgpr_read_b32 v43, a3
v_mul_f32 v40, v40, v37
v_mul_f32 v41, v41, v37
v_mul_f32 v42, v42, v37
v_mul_f32 v43, v43, v37
v_accvgpr_write_b32 a0, v40
v_accvgpr_write_b32 a1, v41
v_accvgpr_write_b32 a2, v42
v_accvgpr_write_b32 a3, v43
v_accvgpr_read_b32 v40, a20
v_accvgpr_read_b32 v41, a21
v_accvgpr_read_b32 v42, a22
v_accvgpr_read_b32 v43, a23
v_mul_f32 v40, v40, v37
v_mul_f32 v41, v41, v37
v_mul_f32 v42, v42, v37
v_mul_f32 v43, v43, v37
v_accvgpr_write_b32 a20, v40
v_accvgpr_write_b32 a21, v41
v_accvgpr_write_b32 a22, v42
v_accvgpr_write_b32 a23, v43
v_accvgpr_read_b32 v40, a40
v_accvgpr_read_b32 v41, a41
v_accvgpr_read_b32 v42, a42
v_accvgpr_read_b32 v43, a43
v_mul_f32 v40, v40, v37
v_mul_f32 v41, v41, v37
v_mul_f32 v42, v42, v37
v_mul_f32 v43, v43, v37
v_accvgpr_write_b32 a40, v40
v_accvgpr_write_b32 a41, v41
v_accvgpr_write_b32 a42, v42
v_accvgpr_write_b32 a43, v43
v_accvgpr_read_b32 v40, a60
v_accvgpr_read_b32 v41, a61
v_accvgpr_read_b32 v42, a62
v_accvgpr_read_b32 v43, a63
v_mul_f32 v40, v40, v37
v_mul_f32 v41, v41, v37
v_mul_f32 v42, v42, v37
v_mul_f32 v43, v43, v37
v_accvgpr_write_b32 a60, v40
v_accvgpr_write_b32 a61, v41
v_accvgpr_write_b32 a62, v42
v_accvgpr_write_b32 a63, v43
v_accvgpr_read_b32 v40, a80
v_accvgpr_read_b32 v41, a81
v_accvgpr_read_b32 v42, a82
v_accvgpr_read_b32 v43, a83
v_mul_f32 v40, v40, v37
v_mul_f32 v41, v41, v37
v_mul_f32 v42, v42, v37
v_mul_f32 v43, v43, v37
v_accvgpr_write_b32 a80, v40
v_accvgpr_write_b32 a81, v41
v_accvgpr_write_b32 a82, v42
v_accvgpr_write_b32 a83, v43
v_accvgpr_read_b32 v40, a100
v_accvgpr_read_b32 v41, a101
v_accvgpr_read_b32 v42, a102
v_accvgpr_read_b32 v43, a103
v_mul_f32 v40, v40, v37
v_mul_f32 v41, v41, v37
v_mul_f32 v42, v42, v37
v_mul_f32 v43, v43, v37
v_accvgpr_write_b32 a100, v40
v_accvgpr_write_b32 a101, v41
v_accvgpr_write_b32 a102, v42
v_accvgpr_write_b32 a103, v43
v_accvgpr_read_b32 v40, a120
v_accvgpr_read_b32 v41, a121
v_accvgpr_read_b32 v42, a122
v_accvgpr_read_b32 v43, a123
v_mul_f32 v40, v40, v37
v_mul_f32 v41, v41, v37
v_mul_f32 v42, v42, v37
v_mul_f32 v43, v43, v37
v_accvgpr_write_b32 a120, v40
v_accvgpr_write_b32 a121, v41
v_accvgpr_write_b32 a122, v42
v_accvgpr_write_b32 a123, v43
v_accvgpr_read_b32 v40, a140
v_accvgpr_read_b32 v41, a141
v_accvgpr_read_b32 v42, a142
v_accvgpr_read_b32 v43, a143
v_mul_f32 v40, v40, v37
v_mul_f32 v41, v41, v37
v_mul_f32 v42, v42, v37
v_mul_f32 v43, v43, v37
v_accvgpr_write_b32 a140, v40
v_accvgpr_write_b32 a141, v41
v_accvgpr_write_b32 a142, v42
v_accvgpr_write_b32 a143, v43
v_exp_f32 v40, v48
v_exp_f32 v41, v49
v_exp_f32 v42, v50
v_exp_f32 v43, v51
s_nop 0
v_cvt_pk_bf16_f32 v128, v40, v41
v_cvt_pk_bf16_f32 v129, v42, v43
v_exp_f32 v40, v68
v_exp_f32 v41, v69
v_exp_f32 v42, v70
v_exp_f32 v43, v71
s_nop 0
v_cvt_pk_bf16_f32 v130, v40, v41
v_cvt_pk_bf16_f32 v131, v42, v43
v_max3_f32 v36, v52, v53, v54
v_max3_f32 v36, v36, v55, v72
v_max3_f32 v36, v36, v73, v74
v_max_f32 v36, v36, v75
v_mov_b32 v37, v36
s_nop 1
v_permlane32_swap_b32 v36, v37
s_nop 1
v_max_f32 v36, v36, v37
v_mov_b32 v37, v36
s_nop 1
v_permlane16_swap_b32 v36, v37
s_nop 1
v_max_f32 v36, v36, v37
v_add_f32 v36, 0x41000000, v36
v_max_f32 v36, 0, v36
v_sub_f32 v37, 0, v36
v_exp_f32 v37, v37
v_sub_f32 v52, v52, v36
v_sub_f32 v53, v53, v36
v_sub_f32 v54, v54, v36
v_sub_f32 v55, v55, v36
v_sub_f32 v72, v72, v36
v_sub_f32 v73, v73, v36
v_sub_f32 v74, v74, v36
v_sub_f32 v75, v75, v36
v_sub_f32 v92, v92, v36
v_sub_f32 v93, v93, v36
v_sub_f32 v94, v94, v36
v_sub_f32 v95, v95, v36
v_sub_f32 v112, v112, v36
v_sub_f32 v113, v113, v36
v_sub_f32 v114, v114, v36
v_sub_f32 v115, v115, v36
v_sub_f32 v172, v172, v36
v_mul_f32 v224, v224, v37
v_sub_f32 v173, v173, v36
v_mul_f32 v225, v225, v37
v_sub_f32 v174, v174, v36
v_mul_f32 v226, v226, v37
v_sub_f32 v175, v175, v36
v_mul_f32 v227, v227, v37
v_accvgpr_read_b32 v40, a4
v_accvgpr_read_b32 v41, a5
v_accvgpr_read_b32 v42, a6
v_accvgpr_read_b32 v43, a7
v_mul_f32 v40, v40, v37
v_mul_f32 v41, v41, v37
v_mul_f32 v42, v42, v37
v_mul_f32 v43, v43, v37
v_accvgpr_write_b32 a4, v40
v_accvgpr_write_b32 a5, v41
v_accvgpr_write_b32 a6, v42
v_accvgpr_write_b32 a7, v43
v_accvgpr_read_b32 v40, a24
v_accvgpr_read_b32 v41, a25
v_accvgpr_read_b32 v42, a26
v_accvgpr_read_b32 v43, a27
v_mul_f32 v40, v40, v37
v_mul_f32 v41, v41, v37
v_mul_f32 v42, v42, v37
v_mul_f32 v43, v43, v37
v_accvgpr_write_b32 a24, v40
v_accvgpr_write_b32 a25, v41
v_accvgpr_write_b32 a26, v42
v_accvgpr_write_b32 a27, v43
v_accvgpr_read_b32 v40, a44
v_accvgpr_read_b32 v41, a45
v_accvgpr_read_b32 v42, a46
v_accvgpr_read_b32 v43, a47
v_mul_f32 v40, v40, v37
v_mul_f32 v41, v41, v37
v_mul_f32 v42, v42, v37
v_mul_f32 v43, v43, v37
v_accvgpr_write_b32 a44, v40
v_accvgpr_write_b32 a45, v41
v_accvgpr_write_b32 a46, v42
v_accvgpr_write_b32 a47, v43
v_accvgpr_read_b32 v40, a64
v_accvgpr_read_b32 v41, a65
v_accvgpr_read_b32 v42, a66
v_accvgpr_read_b32 v43, a67
v_mul_f32 v40, v40, v37
v_mul_f32 v41, v41, v37
v_mul_f32 v42, v42, v37
v_mul_f32 v43, v43, v37
v_accvgpr_write_b32 a64, v40
v_accvgpr_write_b32 a65, v41
v_accvgpr_write_b32 a66, v42
v_accvgpr_write_b32 a67, v43
v_accvgpr_read_b32 v40, a84
v_accvgpr_read_b32 v41, a85
v_accvgpr_read_b32 v42, a86
v_accvgpr_read_b32 v43, a87
v_mul_f32 v40, v40, v37
v_mul_f32 v41, v41, v37
v_mul_f32 v42, v42, v37
v_mul_f32 v43, v43, v37
v_accvgpr_write_b32 a84, v40
v_accvgpr_write_b32 a85, v41
v_accvgpr_write_b32 a86, v42
v_accvgpr_write_b32 a87, v43
v_accvgpr_read_b32 v40, a104
v_accvgpr_read_b32 v41, a105
v_accvgpr_read_b32 v42, a106
v_accvgpr_read_b32 v43, a107
v_mul_f32 v40, v40, v37
v_mul_f32 v41, v41, v37
v_mul_f32 v42, v42, v37
v_mul_f32 v43, v43, v37
v_accvgpr_write_b32 a104, v40
v_accvgpr_write_b32 a105, v41
v_accvgpr_write_b32 a106, v42
v_accvgpr_write_b32 a107, v43
v_accvgpr_read_b32 v40, a124
v_accvgpr_read_b32 v41, a125
v_accvgpr_read_b32 v42, a126
v_accvgpr_read_b32 v43, a127
v_mul_f32 v40, v40, v37
v_mul_f32 v41, v41, v37
v_mul_f32 v42, v42, v37
v_mul_f32 v43, v43, v37
v_accvgpr_write_b32 a124, v40
v_accvgpr_write_b32 a125, v41
v_accvgpr_write_b32 a126, v42
v_accvgpr_write_b32 a127, v43
v_accvgpr_read_b32 v40, a144
v_accvgpr_read_b32 v41, a145
v_accvgpr_read_b32 v42, a146
v_accvgpr_read_b32 v43, a147
v_mul_f32 v40, v40, v37
v_mul_f32 v41, v41, v37
v_mul_f32 v42, v42, v37
v_mul_f32 v43, v43, v37
v_accvgpr_write_b32 a144, v40
v_accvgpr_write_b32 a145, v41
v_accvgpr_write_b32 a146, v42
v_accvgpr_write_b32 a147, v43
v_exp_f32 v40, v52
v_exp_f32 v41, v53
v_exp_f32 v42, v54
v_exp_f32 v43, v55
s_nop 0
v_cvt_pk_bf16_f32 v132, v40, v41
v_cvt_pk_bf16_f32 v133, v42, v43
v_exp_f32 v40, v72
v_exp_f32 v41, v73
v_exp_f32 v42, v74
v_exp_f32 v43, v75
s_nop 0
v_cvt_pk_bf16_f32 v134, v40, v41
v_cvt_pk_bf16_f32 v135, v42, v43
v_max3_f32 v36, v56, v57, v58
v_max3_f32 v36, v36, v59, v76
v_max3_f32 v36, v36, v77, v78
v_max_f32 v36, v36, v79
v_mov_b32 v37, v36
s_nop 1
v_permlane32_swap_b32 v36, v37
s_nop 1
v_max_f32 v36, v36, v37
v_mov_b32 v37, v36
s_nop 1
v_permlane16_swap_b32 v36, v37
s_nop 1
v_max_f32 v36, v36, v37
v_add_f32 v36, 0x41000000, v36
v_max_f32 v36, 0, v36
v_sub_f32 v37, 0, v36
v_exp_f32 v37, v37
v_sub_f32 v56, v56, v36
v_sub_f32 v57, v57, v36
v_sub_f32 v58, v58, v36
v_sub_f32 v59, v59, v36
v_sub_f32 v76, v76, v36
v_sub_f32 v77, v77, v36
v_sub_f32 v78, v78, v36
v_sub_f32 v79, v79, v36
v_sub_f32 v96, v96, v36
v_sub_f32 v97, v97, v36
v_sub_f32 v98, v98, v36
v_sub_f32 v99, v99, v36
v_sub_f32 v116, v116, v36
v_sub_f32 v117, v117, v36
v_sub_f32 v118, v118, v36
v_sub_f32 v119, v119, v36
v_sub_f32 v176, v176, v36
v_mul_f32 v228, v228, v37
v_sub_f32 v177, v177, v36
v_mul_f32 v229, v229, v37
v_sub_f32 v178, v178, v36
v_mul_f32 v230, v230, v37
v_sub_f32 v179, v179, v36
v_mul_f32 v231, v231, v37
v_accvgpr_read_b32 v40, a8
v_accvgpr_read_b32 v41, a9
v_accvgpr_read_b32 v42, a10
v_accvgpr_read_b32 v43, a11
v_mul_f32 v40, v40, v37
v_mul_f32 v41, v41, v37
v_mul_f32 v42, v42, v37
v_mul_f32 v43, v43, v37
v_accvgpr_write_b32 a8, v40
v_accvgpr_write_b32 a9, v41
v_accvgpr_write_b32 a10, v42
v_accvgpr_write_b32 a11, v43
v_accvgpr_read_b32 v40, a28
v_accvgpr_read_b32 v41, a29
v_accvgpr_read_b32 v42, a30
v_accvgpr_read_b32 v43, a31
v_mul_f32 v40, v40, v37
v_mul_f32 v41, v41, v37
v_mul_f32 v42, v42, v37
v_mul_f32 v43, v43, v37
v_accvgpr_write_b32 a28, v40
v_accvgpr_write_b32 a29, v41
v_accvgpr_write_b32 a30, v42
v_accvgpr_write_b32 a31, v43
v_accvgpr_read_b32 v40, a48
v_accvgpr_read_b32 v41, a49
v_accvgpr_read_b32 v42, a50
v_accvgpr_read_b32 v43, a51
v_mul_f32 v40, v40, v37
v_mul_f32 v41, v41, v37
v_mul_f32 v42, v42, v37
v_mul_f32 v43, v43, v37
v_accvgpr_write_b32 a48, v40
v_accvgpr_write_b32 a49, v41
v_accvgpr_write_b32 a50, v42
v_accvgpr_write_b32 a51, v43
v_accvgpr_read_b32 v40, a68
v_accvgpr_read_b32 v41, a69
v_accvgpr_read_b32 v42, a70
v_accvgpr_read_b32 v43, a71
v_mul_f32 v40, v40, v37
v_mul_f32 v41, v41, v37
v_mul_f32 v42, v42, v37
v_mul_f32 v43, v43, v37
v_accvgpr_write_b32 a68, v40
v_accvgpr_write_b32 a69, v41
v_accvgpr_write_b32 a70, v42
v_accvgpr_write_b32 a71, v43
v_accvgpr_read_b32 v40, a88
v_accvgpr_read_b32 v41, a89
v_accvgpr_read_b32 v42, a90
v_accvgpr_read_b32 v43, a91
v_mul_f32 v40, v40, v37
v_mul_f32 v41, v41, v37
v_mul_f32 v42, v42, v37
v_mul_f32 v43, v43, v37
v_accvgpr_write_b32 a88, v40
v_accvgpr_write_b32 a89, v41
v_accvgpr_write_b32 a90, v42
v_accvgpr_write_b32 a91, v43
v_accvgpr_read_b32 v40, a108
v_accvgpr_read_b32 v41, a109
v_accvgpr_read_b32 v42, a110
v_accvgpr_read_b32 v43, a111
v_mul_f32 v40, v40, v37
v_mul_f32 v41, v41, v37
v_mul_f32 v42, v42, v37
v_mul_f32 v43, v43, v37
v_accvgpr_write_b32 a108, v40
v_accvgpr_write_b32 a109, v41
v_accvgpr_write_b32 a110, v42
v_accvgpr_write_b32 a111, v43
v_accvgpr_read_b32 v40, a128
v_accvgpr_read_b32 v41, a129
v_accvgpr_read_b32 v42, a130
v_accvgpr_read_b32 v43, a131
v_mul_f32 v40, v40, v37
v_mul_f32 v41, v41, v37
v_mul_f32 v42, v42, v37
v_mul_f32 v43, v43, v37
v_accvgpr_write_b32 a128, v40
v_accvgpr_write_b32 a129, v41
v_accvgpr_write_b32 a130, v42
v_accvgpr_write_b32 a131, v43
v_accvgpr_read_b32 v40, a148
v_accvgpr_read_b32 v41, a149
v_accvgpr_read_b32 v42, a150
v_accvgpr_read_b32 v43, a151
v_mul_f32 v40, v40, v37
v_mul_f32 v41, v41, v37
v_mul_f32 v42, v42, v37
v_mul_f32 v43, v43, v37
v_accvgpr_write_b32 a148, v40
v_accvgpr_write_b32 a149, v41
v_accvgpr_write_b32 a150, v42
v_accvgpr_write_b32 a151, v43
v_exp_f32 v40, v56
v_exp_f32 v41, v57
v_exp_f32 v42, v58
v_exp_f32 v43, v59
s_nop 0
v_cvt_pk_bf16_f32 v136, v40, v41
v_cvt_pk_bf16_f32 v137, v42, v43
v_exp_f32 v40, v76
v_exp_f32 v41, v77
v_exp_f32 v42, v78
v_exp_f32 v43, v79
s_nop 0
v_cvt_pk_bf16_f32 v138, v40, v41
v_cvt_pk_bf16_f32 v139, v42, v43
v_max3_f32 v36, v60, v61, v62
v_max3_f32 v36, v36, v63, v80
v_max3_f32 v36, v36, v81, v82
v_max_f32 v36, v36, v83
v_mov_b32 v37, v36
s_nop 1
v_permlane32_swap_b32 v36, v37
s_nop 1
v_max_f32 v36, v36, v37
v_mov_b32 v37, v36
s_nop 1
v_permlane16_swap_b32 v36, v37
s_nop 1
v_max_f32 v36, v36, v37
v_add_f32 v36, 0x41000000, v36
v_max_f32 v36, 0, v36
v_sub_f32 v37, 0, v36
v_exp_f32 v37, v37
v_sub_f32 v60, v60, v36
v_sub_f32 v61, v61, v36
v_sub_f32 v62, v62, v36
v_sub_f32 v63, v63, v36
v_sub_f32 v80, v80, v36
v_sub_f32 v81, v81, v36
v_sub_f32 v82, v82, v36
v_sub_f32 v83, v83, v36
v_sub_f32 v100, v100, v36
v_sub_f32 v101, v101, v36
v_sub_f32 v102, v102, v36
v_sub_f32 v103, v103, v36
v_sub_f32 v120, v120, v36
v_sub_f32 v121, v121, v36
v_sub_f32 v122, v122, v36
v_sub_f32 v123, v123, v36
v_sub_f32 v180, v180, v36
v_mul_f32 v232, v232, v37
v_sub_f32 v181, v181, v36
v_mul_f32 v233, v233, v37
v_sub_f32 v182, v182, v36
v_mul_f32 v234, v234, v37
v_sub_f32 v183, v183, v36
v_mul_f32 v235, v235, v37
v_accvgpr_read_b32 v40, a12
v_accvgpr_read_b32 v41, a13
v_accvgpr_read_b32 v42, a14
v_accvgpr_read_b32 v43, a15
v_mul_f32 v40, v40, v37
v_mul_f32 v41, v41, v37
v_mul_f32 v42, v42, v37
v_mul_f32 v43, v43, v37
v_accvgpr_write_b32 a12, v40
v_accvgpr_write_b32 a13, v41
v_accvgpr_write_b32 a14, v42
v_accvgpr_write_b32 a15, v43
v_accvgpr_read_b32 v40, a32
v_accvgpr_read_b32 v41, a33
v_accvgpr_read_b32 v42, a34
v_accvgpr_read_b32 v43, a35
v_mul_f32 v40, v40, v37
v_mul_f32 v41, v41, v37
v_mul_f32 v42, v42, v37
v_mul_f32 v43, v43, v37
v_accvgpr_write_b32 a32, v40
v_accvgpr_write_b32 a33, v41
v_accvgpr_write_b32 a34, v42
v_accvgpr_write_b32 a35, v43
v_accvgpr_read_b32 v40, a52
v_accvgpr_read_b32 v41, a53
v_accvgpr_read_b32 v42, a54
v_accvgpr_read_b32 v43, a55
v_mul_f32 v40, v40, v37
v_mul_f32 v41, v41, v37
v_mul_f32 v42, v42, v37
v_mul_f32 v43, v43, v37
v_accvgpr_write_b32 a52, v40
v_accvgpr_write_b32 a53, v41
v_accvgpr_write_b32 a54, v42
v_accvgpr_write_b32 a55, v43
v_accvgpr_read_b32 v40, a72
v_accvgpr_read_b32 v41, a73
v_accvgpr_read_b32 v42, a74
v_accvgpr_read_b32 v43, a75
v_mul_f32 v40, v40, v37
v_mul_f32 v41, v41, v37
v_mul_f32 v42, v42, v37
v_mul_f32 v43, v43, v37
v_accvgpr_write_b32 a72, v40
v_accvgpr_write_b32 a73, v41
v_accvgpr_write_b32 a74, v42
v_accvgpr_write_b32 a75, v43
v_accvgpr_read_b32 v40, a92
v_accvgpr_read_b32 v41, a93
v_accvgpr_read_b32 v42, a94
v_accvgpr_read_b32 v43, a95
v_mul_f32 v40, v40, v37
v_mul_f32 v41, v41, v37
v_mul_f32 v42, v42, v37
v_mul_f32 v43, v43, v37
v_accvgpr_write_b32 a92, v40
v_accvgpr_write_b32 a93, v41
v_accvgpr_write_b32 a94, v42
v_accvgpr_write_b32 a95, v43
v_accvgpr_read_b32 v40, a112
v_accvgpr_read_b32 v41, a113
v_accvgpr_read_b32 v42, a114
v_accvgpr_read_b32 v43, a115
v_mul_f32 v40, v40, v37
v_mul_f32 v41, v41, v37
v_mul_f32 v42, v42, v37
v_mul_f32 v43, v43, v37
v_accvgpr_write_b32 a112, v40
v_accvgpr_write_b32 a113, v41
v_accvgpr_write_b32 a114, v42
v_accvgpr_write_b32 a115, v43
v_accvgpr_read_b32 v40, a132
v_accvgpr_read_b32 v41, a133
v_accvgpr_read_b32 v42, a134
v_accvgpr_read_b32 v43, a135
v_mul_f32 v40, v40, v37
v_mul_f32 v41, v41, v37
v_mul_f32 v42, v42, v37
v_mul_f32 v43, v43, v37
v_accvgpr_write_b32 a132, v40
v_accvgpr_write_b32 a133, v41
v_accvgpr_write_b32 a134, v42
v_accvgpr_write_b32 a135, v43
v_accvgpr_read_b32 v40, a152
v_accvgpr_read_b32 v41, a153
v_accvgpr_read_b32 v42, a154
v_accvgpr_read_b32 v43, a155
v_mul_f32 v40, v40, v37
v_mul_f32 v41, v41, v37
v_mul_f32 v42, v42, v37
v_mul_f32 v43, v43, v37
v_accvgpr_write_b32 a152, v40
v_accvgpr_write_b32 a153, v41
v_accvgpr_write_b32 a154, v42
v_accvgpr_write_b32 a155, v43
v_exp_f32 v40, v60
v_exp_f32 v41, v61
v_exp_f32 v42, v62
v_exp_f32 v43, v63
s_nop 0
v_cvt_pk_bf16_f32 v140, v40, v41
v_cvt_pk_bf16_f32 v141, v42, v43
v_exp_f32 v40, v80
v_exp_f32 v41, v81
v_exp_f32 v42, v82
v_exp_f32 v43, v83
s_nop 0
v_cvt_pk_bf16_f32 v142, v40, v41
v_cvt_pk_bf16_f32 v143, v42, v43
v_max3_f32 v36, v64, v65, v66
v_max3_f32 v36, v36, v67, v84
v_max3_f32 v36, v36, v85, v86
v_max_f32 v36, v36, v87
v_mov_b32 v37, v36
s_nop 1
v_permlane32_swap_b32 v36, v37
s_nop 1
v_max_f32 v36, v36, v37
v_mov_b32 v37, v36
s_nop 1
v_permlane16_swap_b32 v36, v37
s_nop 1
v_max_f32 v36, v36, v37
v_add_f32 v36, 0x41000000, v36
v_max_f32 v36, 0, v36
v_sub_f32 v37, 0, v36
v_exp_f32 v37, v37
v_sub_f32 v64, v64, v36
v_sub_f32 v65, v65, v36
v_sub_f32 v66, v66, v36
v_sub_f32 v67, v67, v36
v_sub_f32 v84, v84, v36
v_sub_f32 v85, v85, v36
v_sub_f32 v86, v86, v36
v_sub_f32 v87, v87, v36
v_sub_f32 v104, v104, v36
v_sub_f32 v105, v105, v36
v_sub_f32 v106, v106, v36
v_sub_f32 v107, v107, v36
v_sub_f32 v124, v124, v36
v_sub_f32 v125, v125, v36
v_sub_f32 v126, v126, v36
v_sub_f32 v127, v127, v36
v_sub_f32 v184, v184, v36
v_mul_f32 v236, v236, v37
v_sub_f32 v185, v185, v36
v_mul_f32 v237, v237, v37
v_sub_f32 v186, v186, v36
v_mul_f32 v238, v238, v37
v_sub_f32 v187, v187, v36
v_mul_f32 v239, v239, v37
v_accvgpr_read_b32 v40, a16
v_accvgpr_read_b32 v41, a17
v_accvgpr_read_b32 v42, a18
v_accvgpr_read_b32 v43, a19
v_mul_f32 v40, v40, v37
v_mul_f32 v41, v41, v37
v_mul_f32 v42, v42, v37
v_mul_f32 v43, v43, v37
v_accvgpr_write_b32 a16, v40
v_accvgpr_write_b32 a17, v41
v_accvgpr_write_b32 a18, v42
v_accvgpr_write_b32 a19, v43
v_accvgpr_read_b32 v40, a36
v_accvgpr_read_b32 v41, a37
v_accvgpr_read_b32 v42, a38
v_accvgpr_read_b32 v43, a39
v_mul_f32 v40, v40, v37
v_mul_f32 v41, v41, v37
v_mul_f32 v42, v42, v37
v_mul_f32 v43, v43, v37
v_accvgpr_write_b32 a36, v40
v_accvgpr_write_b32 a37, v41
v_accvgpr_write_b32 a38, v42
v_accvgpr_write_b32 a39, v43
v_accvgpr_read_b32 v40, a56
v_accvgpr_read_b32 v41, a57
v_accvgpr_read_b32 v42, a58
v_accvgpr_read_b32 v43, a59
v_mul_f32 v40, v40, v37
v_mul_f32 v41, v41, v37
v_mul_f32 v42, v42, v37
v_mul_f32 v43, v43, v37
v_accvgpr_write_b32 a56, v40
v_accvgpr_write_b32 a57, v41
v_accvgpr_write_b32 a58, v42
v_accvgpr_write_b32 a59, v43
v_accvgpr_read_b32 v40, a76
v_accvgpr_read_b32 v41, a77
v_accvgpr_read_b32 v42, a78
v_accvgpr_read_b32 v43, a79
v_mul_f32 v40, v40, v37
v_mul_f32 v41, v41, v37
v_mul_f32 v42, v42, v37
v_mul_f32 v43, v43, v37
v_accvgpr_write_b32 a76, v40
v_accvgpr_write_b32 a77, v41
v_accvgpr_write_b32 a78, v42
v_accvgpr_write_b32 a79, v43
v_accvgpr_read_b32 v40, a96
v_accvgpr_read_b32 v41, a97
v_accvgpr_read_b32 v42, a98
v_accvgpr_read_b32 v43, a99
v_mul_f32 v40, v40, v37
v_mul_f32 v41, v41, v37
v_mul_f32 v42, v42, v37
v_mul_f32 v43, v43, v37
v_accvgpr_write_b32 a96, v40
v_accvgpr_write_b32 a97, v41
v_accvgpr_write_b32 a98, v42
v_accvgpr_write_b32 a99, v43
v_accvgpr_read_b32 v40, a116
v_accvgpr_read_b32 v41, a117
v_accvgpr_read_b32 v42, a118
v_accvgpr_read_b32 v43, a119
v_mul_f32 v40, v40, v37
v_mul_f32 v41, v41, v37
v_mul_f32 v42, v42, v37
v_mul_f32 v43, v43, v37
v_accvgpr_write_b32 a116, v40
v_accvgpr_write_b32 a117, v41
v_accvgpr_write_b32 a118, v42
v_accvgpr_write_b32 a119, v43
v_accvgpr_read_b32 v40, a136
v_accvgpr_read_b32 v41, a137
v_accvgpr_read_b32 v42, a138
v_accvgpr_read_b32 v43, a139
v_mul_f32 v40, v40, v37
v_mul_f32 v41, v41, v37
v_mul_f32 v42, v42, v37
v_mul_f32 v43, v43, v37
v_accvgpr_write_b32 a136, v40
v_accvgpr_write_b32 a137, v41
v_accvgpr_write_b32 a138, v42
v_accvgpr_write_b32 a139, v43
v_accvgpr_read_b32 v40, a156
v_accvgpr_read_b32 v41, a157
v_accvgpr_read_b32 v42, a158
v_accvgpr_read_b32 v43, a159
v_mul_f32 v40, v40, v37
v_mul_f32 v41, v41, v37
v_mul_f32 v42, v42, v37
v_mul_f32 v43, v43, v37
v_accvgpr_write_b32 a156, v40
v_accvgpr_write_b32 a157, v41
v_accvgpr_write_b32 a158, v42
v_accvgpr_write_b32 a159, v43
v_exp_f32 v40, v64
v_exp_f32 v41, v65
v_exp_f32 v42, v66
v_exp_f32 v43, v67
s_nop 0
v_cvt_pk_bf16_f32 v144, v40, v41
v_cvt_pk_bf16_f32 v145, v42, v43
v_exp_f32 v40, v84
v_exp_f32 v41, v85
v_exp_f32 v42, v86
v_exp_f32 v43, v87
s_nop 0
v_cvt_pk_bf16_f32 v146, v40, v41
v_cvt_pk_bf16_f32 v147, v42, v43
s_nop 1
s_setpc_b64 s[58:59]
F_rare1:
s_nop 7
v_max3_f32 v36, v88, v89, v90
v_max3_f32 v36, v36, v91, v108
v_max3_f32 v36, v36, v109, v110
v_max_f32 v36, v36, v111
v_mov_b32 v37, v36
s_nop 1
v_permlane32_swap_b32 v36, v37
s_nop 1
v_max_f32 v36, v36, v37
v_mov_b32 v37, v36
s_nop 1
v_permlane16_swap_b32 v36, v37
s_nop 1
v_max_f32 v36, v36, v37
v_add_f32 v36, 0x41000000, v36
v_max_f32 v36, 0, v36
v_sub_f32 v37, 0, v36
v_exp_f32 v37, v37
v_sub_f32 v88, v88, v36
v_sub_f32 v89, v89, v36
v_sub_f32 v90, v90, v36
v_sub_f32 v91, v91, v36
v_sub_f32 v108, v108, v36
v_sub_f32 v109, v109, v36
v_sub_f32 v110, v110, v36
v_sub_f32 v111, v111, v36
v_sub_f32 v48, v48, v36
v_sub_f32 v49, v49, v36
v_sub_f32 v50, v50, v36
v_sub_f32 v51, v51, v36
v_sub_f32 v68, v68, v36
v_sub_f32 v69, v69, v36
v_sub_f32 v70, v70, v36
v_sub_f32 v71, v71, v36
v_sub_f32 v168, v168, v36
v_mul_f32 v220, v220, v37
v_sub_f32 v169, v169, v36
v_mul_f32 v221, v221, v37
v_sub_f32 v170, v170, v36
v_mul_f32 v222, v222, v37
v_sub_f32 v171, v171, v36
v_mul_f32 v223, v223, v37
v_accvgpr_read_b32 v40, a0
v_accvgpr_read_b32 v41, a1
v_accvgpr_read_b32 v42, a2
v_accvgpr_read_b32 v43, a3
v_mul_f32 v40, v40, v37
v_mul_f32 v41, v41, v37
v_mul_f32 v42, v42, v37
v_mul_f32 v43, v43, v37
v_accvgpr_write_b32 a0, v40
v_accvgpr_write_b32 a1, v41
v_accvgpr_write_b32 a2, v42
v_accvgpr_write_b32 a3, v43
v_accvgpr_read_b32 v40, a20
v_accvgpr_read_b32 v41, a21
v_accvgpr_read_b32 v42, a22
v_accvgpr_read_b32 v43, a23
v_mul_f32 v40, v40, v37
v_mul_f32 v41, v41, v37
v_mul_f32 v42, v42, v37
v_mul_f32 v43, v43, v37
v_accvgpr_write_b32 a20, v40
v_accvgpr_write_b32 a21, v41
v_accvgpr_write_b32 a22, v42
v_accvgpr_write_b32 a23, v43
v_accvgpr_read_b32 v40, a40
v_accvgpr_read_b32 v41, a41
v_accvgpr_read_b32 v42, a42
v_accvgpr_read_b32 v43, a43
v_mul_f32 v40, v40, v37
v_mul_f32 v41, v41, v37
v_mul_f32 v42, v42, v37
v_mul_f32 v43, v43, v37
v_accvgpr_write_b32 a40, v40
v_accvgpr_write_b32 a41, v41
v_accvgpr_write_b32 a42, v42
v_accvgpr_write_b32 a43, v43
v_accvgpr_read_b32 v40, a60
v_accvgpr_read_b32 v41, a61
v_accvgpr_read_b32 v42, a62
v_accvgpr_read_b32 v43, a63
v_mul_f32 v40, v40, v37
v_mul_f32 v41, v41, v37
v_mul_f32 v42, v42, v37
v_mul_f32 v43, v43, v37
v_accvgpr_write_b32 a60, v40
v_accvgpr_write_b32 a61, v41
v_accvgpr_write_b32 a62, v42
v_accvgpr_write_b32 a63, v43
v_accvgpr_read_b32 v40, a80
v_accvgpr_read_b32 v41, a81
v_accvgpr_read_b32 v42, a82
v_accvgpr_read_b32 v43, a83
v_mul_f32 v40, v40, v37
v_mul_f32 v41, v41, v37
v_mul_f32 v42, v42, v37
v_mul_f32 v43, v43, v37
v_accvgpr_write_b32 a80, v40
v_accvgpr_write_b32 a81, v41
v_accvgpr_write_b32 a82, v42
v_accvgpr_write_b32 a83, v43
v_accvgpr_read_b32 v40, a100
v_accvgpr_read_b32 v41, a101
v_accvgpr_read_b32 v42, a102
v_accvgpr_read_b32 v43, a103
v_mul_f32 v40, v40, v37
v_mul_f32 v41, v41, v37
v_mul_f32 v42, v42, v37
v_mul_f32 v43, v43, v37
v_accvgpr_write_b32 a100, v40
v_accvgpr_write_b32 a101, v41
v_accvgpr_write_b32 a102, v42
v_accvgpr_write_b32 a103, v43
v_accvgpr_read_b32 v40, a120
v_accvgpr_read_b32 v41, a121
v_accvgpr_read_b32 v42, a122
v_accvgpr_read_b32 v43, a123
v_mul_f32 v40, v40, v37
v_mul_f32 v41, v41, v37
v_mul_f32 v42, v42, v37
v_mul_f32 v43, v43, v37
v_accvgpr_write_b32 a120, v40
v_accvgpr_write_b32 a121, v41
v_accvgpr_write_b32 a122, v42
v_accvgpr_write_b32 a123, v43
v_accvgpr_read_b32 v40, a140
v_accvgpr_read_b32 v41, a141
v_accvgpr_read_b32 v42, a142
v_accvgpr_read_b32 v43, a143
v_mul_f32 v40, v40, v37
v_mul_f32 v41, v41, v37
v_mul_f32 v42, v42, v37
v_mul_f32 v43, v43, v37
v_accvgpr_write_b32 a140, v40
v_accvgpr_write_b32 a141, v41
v_accvgpr_write_b32 a142, v42
v_accvgpr_write_b32 a143, v43
v_exp_f32 v40, v88
v_exp_f32 v41, v89
v_exp_f32 v42, v90
v_exp_f32 v43, v91
s_nop 0
v_cvt_pk_bf16_f32 v148, v40, v41
v_cvt_pk_bf16_f32 v149, v42, v43
v_exp_f32 v40, v108
v_exp_f32 v41, v109
v_exp_f32 v42, v110
v_exp_f32 v43, v111
s_nop 0
v_cvt_pk_bf16_f32 v150, v40, v41
v_cvt_pk_bf16_f32 v151, v42, v43
v_max3_f32 v36, v92, v93, v94
v_max3_f32 v36, v36, v95, v112
v_max3_f32 v36, v36, v113, v114
v_max_f32 v36, v36, v115
v_mov_b32 v37, v36
s_nop 1
v_permlane32_swap_b32 v36, v37
s_nop 1
v_max_f32 v36, v36, v37
v_mov_b32 v37, v36
s_nop 1
v_permlane16_swap_b32 v36, v37
s_nop 1
v_max_f32 v36, v36, v37
v_add_f32 v36, 0x41000000, v36
v_max_f32 v36, 0, v36
v_sub_f32 v37, 0, v36
v_exp_f32 v37, v37
v_sub_f32 v92, v92, v36
v_sub_f32 v93, v93, v36
v_sub_f32 v94, v94, v36
v_sub_f32 v95, v95, v36
v_sub_f32 v112, v112, v36
v_sub_f32 v113, v113, v36
v_sub_f32 v114, v114, v36
v_sub_f32 v115, v115, v36
v_sub_f32 v52, v52, v36
v_sub_f32 v53, v53, v36
v_sub_f32 v54, v54, v36
v_sub_f32 v55, v55, v36
v_sub_f32 v72, v72, v36
v_sub_f32 v73, v73, v36
v_sub_f32 v74, v74, v36
v_sub_f32 v75, v75, v36
v_sub_f32 v172, v172, v36
v_mul_f32 v224, v224, v37
v_sub_f32 v173, v173, v36
v_mul_f32 v225, v225, v37
v_sub_f32 v174, v174, v36
v_mul_f32 v226, v226, v37
v_sub_f32 v175, v175, v36
v_mul_f32 v227, v227, v37
v_accvgpr_read_b32 v40, a4
v_accvgpr_read_b32 v41, a5
v_accvgpr_read_b32 v42, a6
v_accvgpr_read_b32 v43, a7
v_mul_f32 v40, v40, v37
v_mul_f32 v41, v41, v37
v_mul_f32 v42, v42, v37
v_mul_f32 v43, v43, v37
v_accvgpr_write_b32 a4, v40
v_accvgpr_write_b32 a5, v41
v_accvgpr_write_b32 a6, v42
v_accvgpr_write_b32 a7, v43
v_accvgpr_read_b32 v40, a24
v_accvgpr_read_b32 v41, a25
v_accvgpr_read_b32 v42, a26
v_accvgpr_read_b32 v43, a27
v_mul_f32 v40, v40, v37
v_mul_f32 v41, v41, v37
v_mul_f32 v42, v42, v37
v_mul_f32 v43, v43, v37
v_accvgpr_write_b32 a24, v40
v_accvgpr_write_b32 a25, v41
v_accvgpr_write_b32 a26, v42
v_accvgpr_write_b32 a27, v43
v_accvgpr_read_b32 v40, a44
v_accvgpr_read_b32 v41, a45
v_accvgpr_read_b32 v42, a46
v_accvgpr_read_b32 v43, a47
v_mul_f32 v40, v40, v37
v_mul_f32 v41, v41, v37
v_mul_f32 v42, v42, v37
v_mul_f32 v43, v43, v37
v_accvgpr_write_b32 a44, v40
v_accvgpr_write_b32 a45, v41
v_accvgpr_write_b32 a46, v42
v_accvgpr_write_b32 a47, v43
v_accvgpr_read_b32 v40, a64
v_accvgpr_read_b32 v41, a65
v_accvgpr_read_b32 v42, a66
v_accvgpr_read_b32 v43, a67
v_mul_f32 v40, v40, v37
v_mul_f32 v41, v41, v37
v_mul_f32 v42, v42, v37
v_mul_f32 v43, v43, v37
v_accvgpr_write_b32 a64, v40
v_accvgpr_write_b32 a65, v41
v_accvgpr_write_b32 a66, v42
v_accvgpr_write_b32 a67, v43
v_accvgpr_read_b32 v40, a84
v_accvgpr_read_b32 v41, a85
v_accvgpr_read_b32 v42, a86
v_accvgpr_read_b32 v43, a87
v_mul_f32 v40, v40, v37
v_mul_f32 v41, v41, v37
v_mul_f32 v42, v42, v37
v_mul_f32 v43, v43, v37
v_accvgpr_write_b32 a84, v40
v_accvgpr_write_b32 a85, v41
v_accvgpr_write_b32 a86, v42
v_accvgpr_write_b32 a87, v43
v_accvgpr_read_b32 v40, a104
v_accvgpr_read_b32 v41, a105
v_accvgpr_read_b32 v42, a106
v_accvgpr_read_b32 v43, a107
v_mul_f32 v40, v40, v37
v_mul_f32 v41, v41, v37
v_mul_f32 v42, v42, v37
v_mul_f32 v43, v43, v37
v_accvgpr_write_b32 a104, v40
v_accvgpr_write_b32 a105, v41
v_accvgpr_write_b32 a106, v42
v_accvgpr_write_b32 a107, v43
v_accvgpr_read_b32 v40, a124
v_accvgpr_read_b32 v41, a125
v_accvgpr_read_b32 v42, a126
v_accvgpr_read_b32 v43, a127
v_mul_f32 v40, v40, v37
v_mul_f32 v41, v41, v37
v_mul_f32 v42, v42, v37
v_mul_f32 v43, v43, v37
v_accvgpr_write_b32 a124, v40
v_accvgpr_write_b32 a125, v41
v_accvgpr_write_b32 a126, v42
v_accvgpr_write_b32 a127, v43
v_accvgpr_read_b32 v40, a144
v_accvgpr_read_b32 v41, a145
v_accvgpr_read_b32 v42, a146
v_accvgpr_read_b32 v43, a147
v_mul_f32 v40, v40, v37
v_mul_f32 v41, v41, v37
v_mul_f32 v42, v42, v37
v_mul_f32 v43, v43, v37
v_accvgpr_write_b32 a144, v40
v_accvgpr_write_b32 a145, v41
v_accvgpr_write_b32 a146, v42
v_accvgpr_write_b32 a147, v43
v_exp_f32 v40, v92
v_exp_f32 v41, v93
v_exp_f32 v42, v94
v_exp_f32 v43, v95
s_nop 0
v_cvt_pk_bf16_f32 v152, v40, v41
v_cvt_pk_bf16_f32 v153, v42, v43
v_exp_f32 v40, v112
v_exp_f32 v41, v113
v_exp_f32 v42, v114
v_exp_f32 v43, v115
s_nop 0
v_cvt_pk_bf16_f32 v154, v40, v41
v_cvt_pk_bf16_f32 v155, v42, v43
v_max3_f32 v36, v96, v97, v98
v_max3_f32 v36, v36, v99, v116
v_max3_f32 v36, v36, v117, v118
v_max_f32 v36, v36, v119
v_mov_b32 v37, v36
s_nop 1
v_permlane32_swap_b32 v36, v37
s_nop 1
v_max_f32 v36, v36, v37
v_mov_b32 v37, v36
s_nop 1
v_permlane16_swap_b32 v36, v37
s_nop 1
v_max_f32 v36, v36, v37
v_add_f32 v36, 0x41000000, v36
v_max_f32 v36, 0, v36
v_sub_f32 v37, 0, v36
v_exp_f32 v37, v37
v_sub_f32 v96, v96, v36
v_sub_f32 v97, v97, v36
v_sub_f32 v98, v98, v36
v_sub_f32 v99, v99, v36
v_sub_f32 v116, v116, v36
v_sub_f32 v117, v117, v36
v_sub_f32 v118, v118, v36
v_sub_f32 v119, v119, v36
v_sub_f32 v56, v56, v36
v_sub_f32 v57, v57, v36
v_sub_f32 v58, v58, v36
v_sub_f32 v59, v59, v36
v_sub_f32 v76, v76, v36
v_sub_f32 v77, v77, v36
v_sub_f32 v78, v78, v36
v_sub_f32 v79, v79, v36
v_sub_f32 v176, v176, v36
v_mul_f32 v228, v228, v37
v_sub_f32 v177, v177, v36
v_mul_f32 v229, v229, v37
v_sub_f32 v178, v178, v36
v_mul_f32 v230, v230, v37
v_sub_f32 v179, v179, v36
v_mul_f32 v231, v231, v37
v_accvgpr_read_b32 v40, a8
v_accvgpr_read_b32 v41, a9
v_accvgpr_read_b32 v42, a10
v_accvgpr_read_b32 v43, a11
v_mul_f32 v40, v40, v37
v_mul_f32 v41, v41, v37
v_mul_f32 v42, v42, v37
v_mul_f32 v43, v43, v37
v_accvgpr_write_b32 a8, v40
v_accvgpr_write_b32 a9, v41
v_accvgpr_write_b32 a10, v42
v_accvgpr_write_b32 a11, v43
v_accvgpr_read_b32 v40, a28
v_accvgpr_read_b32 v41, a29
v_accvgpr_read_b32 v42, a30
v_accvgpr_read_b32 v43, a31
v_mul_f32 v40, v40, v37
v_mul_f32 v41, v41, v37
v_mul_f32 v42, v42, v37
v_mul_f32 v43, v43, v37
v_accvgpr_write_b32 a28, v40
v_accvgpr_write_b32 a29, v41
v_accvgpr_write_b32 a30, v42
v_accvgpr_write_b32 a31, v43
v_accvgpr_read_b32 v40, a48
v_accvgpr_read_b32 v41, a49
v_accvgpr_read_b32 v42, a50
v_accvgpr_read_b32 v43, a51
v_mul_f32 v40, v40, v37
v_mul_f32 v41, v41, v37
v_mul_f32 v42, v42, v37
v_mul_f32 v43, v43, v37
v_accvgpr_write_b32 a48, v40
v_accvgpr_write_b32 a49, v41
v_accvgpr_write_b32 a50, v42
v_accvgpr_write_b32 a51, v43
v_accvgpr_read_b32 v40, a68
v_accvgpr_read_b32 v41, a69
v_accvgpr_read_b32 v42, a70
v_accvgpr_read_b32 v43, a71
v_mul_f32 v40, v40, v37
v_mul_f32 v41, v41, v37
v_mul_f32 v42, v42, v37
v_mul_f32 v43, v43, v37
v_accvgpr_write_b32 a68, v40
v_accvgpr_write_b32 a69, v41
v_accvgpr_write_b32 a70, v42
v_accvgpr_write_b32 a71, v43
v_accvgpr_read_b32 v40, a88
v_accvgpr_read_b32 v41, a89
v_accvgpr_read_b32 v42, a90
v_accvgpr_read_b32 v43, a91
v_mul_f32 v40, v40, v37
v_mul_f32 v41, v41, v37
v_mul_f32 v42, v42, v37
v_mul_f32 v43, v43, v37
v_accvgpr_write_b32 a88, v40
v_accvgpr_write_b32 a89, v41
v_accvgpr_write_b32 a90, v42
v_accvgpr_write_b32 a91, v43
v_accvgpr_read_b32 v40, a108
v_accvgpr_read_b32 v41, a109
v_accvgpr_read_b32 v42, a110
v_accvgpr_read_b32 v43, a111
v_mul_f32 v40, v40, v37
v_mul_f32 v41, v41, v37
v_mul_f32 v42, v42, v37
v_mul_f32 v43, v43, v37
v_accvgpr_write_b32 a108, v40
v_accvgpr_write_b32 a109, v41
v_accvgpr_write_b32 a110, v42
v_accvgpr_write_b32 a111, v43
v_accvgpr_read_b32 v40, a128
v_accvgpr_read_b32 v41, a129
v_accvgpr_read_b32 v42, a130
v_accvgpr_read_b32 v43, a131
v_mul_f32 v40, v40, v37
v_mul_f32 v41, v41, v37
v_mul_f32 v42, v42, v37
v_mul_f32 v43, v43, v37
v_accvgpr_write_b32 a128, v40
v_accvgpr_write_b32 a129, v41
v_accvgpr_write_b32 a130, v42
v_accvgpr_write_b32 a131, v43
v_accvgpr_read_b32 v40, a148
v_accvgpr_read_b32 v41, a149
v_accvgpr_read_b32 v42, a150
v_accvgpr_read_b32 v43, a151
v_mul_f32 v40, v40, v37
v_mul_f32 v41, v41, v37
v_mul_f32 v42, v42, v37
v_mul_f32 v43, v43, v37
v_accvgpr_write_b32 a148, v40
v_accvgpr_write_b32 a149, v41
v_accvgpr_write_b32 a150, v42
v_accvgpr_write_b32 a151, v43
v_exp_f32 v40, v96
v_exp_f32 v41, v97
v_exp_f32 v42, v98
v_exp_f32 v43, v99
s_nop 0
v_cvt_pk_bf16_f32 v156, v40, v41
v_cvt_pk_bf16_f32 v157, v42, v43
v_exp_f32 v40, v116
v_exp_f32 v41, v117
v_exp_f32 v42, v118
v_exp_f32 v43, v119
s_nop 0
v_cvt_pk_bf16_f32 v158, v40, v41
v_cvt_pk_bf16_f32 v159, v42, v43
v_max3_f32 v36, v100, v101, v102
v_max3_f32 v36, v36, v103, v120
v_max3_f32 v36, v36, v121, v122
v_max_f32 v36, v36, v123
v_mov_b32 v37, v36
s_nop 1
v_permlane32_swap_b32 v36, v37
s_nop 1
v_max_f32 v36, v36, v37
v_mov_b32 v37, v36
s_nop 1
v_permlane16_swap_b32 v36, v37
s_nop 1
v_max_f32 v36, v36, v37
v_add_f32 v36, 0x41000000, v36
v_max_f32 v36, 0, v36
v_sub_f32 v37, 0, v36
v_exp_f32 v37, v37
v_sub_f32 v100, v100, v36
v_sub_f32 v101, v101, v36
v_sub_f32 v102, v102, v36
v_sub_f32 v103, v103, v36
v_sub_f32 v120, v120, v36
v_sub_f32 v121, v121, v36
v_sub_f32 v122, v122, v36
v_sub_f32 v123, v123, v36
v_sub_f32 v60, v60, v36
v_sub_f32 v61, v61, v36
v_sub_f32 v62, v62, v36
v_sub_f32 v63, v63, v36
v_sub_f32 v80, v80, v36
v_sub_f32 v81, v81, v36
v_sub_f32 v82, v82, v36
v_sub_f32 v83, v83, v36
v_sub_f32 v180, v180, v36
v_mul_f32 v232, v232, v37
v_sub_f32 v181, v181, v36
v_mul_f32 v233, v233, v37
v_sub_f32 v182, v182, v36
v_mul_f32 v234, v234, v37
v_sub_f32 v183, v183, v36
v_mul_f32 v235, v235, v37
v_accvgpr_read_b32 v40, a12
v_accvgpr_read_b32 v41, a13
v_accvgpr_read_b32 v42, a14
v_accvgpr_read_b32 v43, a15
v_mul_f32 v40, v40, v37
v_mul_f32 v41, v41, v37
v_mul_f32 v42, v42, v37
v_mul_f32 v43, v43, v37
v_accvgpr_write_b32 a12, v40
v_accvgpr_write_b32 a13, v41
v_accvgpr_write_b32 a14, v42
v_accvgpr_write_b32 a15, v43
v_accvgpr_read_b32 v40, a32
v_accvgpr_read_b32 v41, a33
v_accvgpr_read_b32 v42, a34
v_accvgpr_read_b32 v43, a35
v_mul_f32 v40, v40, v37
v_mul_f32 v41, v41, v37
v_mul_f32 v42, v42, v37
v_mul_f32 v43, v43, v37
v_accvgpr_write_b32 a32, v40
v_accvgpr_write_b32 a33, v41
v_accvgpr_write_b32 a34, v42
v_accvgpr_write_b32 a35, v43
v_accvgpr_read_b32 v40, a52
v_accvgpr_read_b32 v41, a53
v_accvgpr_read_b32 v42, a54
v_accvgpr_read_b32 v43, a55
v_mul_f32 v40, v40, v37
v_mul_f32 v41, v41, v37
v_mul_f32 v42, v42, v37
v_mul_f32 v43, v43, v37
v_accvgpr_write_b32 a52, v40
v_accvgpr_write_b32 a53, v41
v_accvgpr_write_b32 a54, v42
v_accvgpr_write_b32 a55, v43
v_accvgpr_read_b32 v40, a72
v_accvgpr_read_b32 v41, a73
v_accvgpr_read_b32 v42, a74
v_accvgpr_read_b32 v43, a75
v_mul_f32 v40, v40, v37
v_mul_f32 v41, v41, v37
v_mul_f32 v42, v42, v37
v_mul_f32 v43, v43, v37
v_accvgpr_write_b32 a72, v40
v_accvgpr_write_b32 a73, v41
v_accvgpr_write_b32 a74, v42
v_accvgpr_write_b32 a75, v43
v_accvgpr_read_b32 v40, a92
v_accvgpr_read_b32 v41, a93
v_accvgpr_read_b32 v42, a94
v_accvgpr_read_b32 v43, a95
v_mul_f32 v40, v40, v37
v_mul_f32 v41, v41, v37
v_mul_f32 v42, v42, v37
v_mul_f32 v43, v43, v37
v_accvgpr_write_b32 a92, v40
v_accvgpr_write_b32 a93, v41
v_accvgpr_write_b32 a94, v42
v_accvgpr_write_b32 a95, v43
v_accvgpr_read_b32 v40, a112
v_accvgpr_read_b32 v41, a113
v_accvgpr_read_b32 v42, a114
v_accvgpr_read_b32 v43, a115
v_mul_f32 v40, v40, v37
v_mul_f32 v41, v41, v37
v_mul_f32 v42, v42, v37
v_mul_f32 v43, v43, v37
v_accvgpr_write_b32 a112, v40
v_accvgpr_write_b32 a113, v41
v_accvgpr_write_b32 a114, v42
v_accvgpr_write_b32 a115, v43
v_accvgpr_read_b32 v40, a132
v_accvgpr_read_b32 v41, a133
v_accvgpr_read_b32 v42, a134
v_accvgpr_read_b32 v43, a135
v_mul_f32 v40, v40, v37
v_mul_f32 v41, v41, v37
v_mul_f32 v42, v42, v37
v_mul_f32 v43, v43, v37
v_accvgpr_write_b32 a132, v40
v_accvgpr_write_b32 a133, v41
v_accvgpr_write_b32 a134, v42
v_accvgpr_write_b32 a135, v43
v_accvgpr_read_b32 v40, a152
v_accvgpr_read_b32 v41, a153
v_accvgpr_read_b32 v42, a154
v_accvgpr_read_b32 v43, a155
v_mul_f32 v40, v40, v37
v_mul_f32 v41, v41, v37
v_mul_f32 v42, v42, v37
v_mul_f32 v43, v43, v37
v_accvgpr_write_b32 a152, v40
v_accvgpr_write_b32 a153, v41
v_accvgpr_write_b32 a154, v42
v_accvgpr_write_b32 a155, v43
v_exp_f32 v40, v100
v_exp_f32 v41, v101
v_exp_f32 v42, v102
v_exp_f32 v43, v103
s_nop 0
v_cvt_pk_bf16_f32 v160, v40, v41
v_cvt_pk_bf16_f32 v161, v42, v43
v_exp_f32 v40, v120
v_exp_f32 v41, v121
v_exp_f32 v42, v122
v_exp_f32 v43, v123
s_nop 0
v_cvt_pk_bf16_f32 v162, v40, v41
v_cvt_pk_bf16_f32 v163, v42, v43
v_max3_f32 v36, v104, v105, v106
v_max3_f32 v36, v36, v107, v124
v_max3_f32 v36, v36, v125, v126
v_max_f32 v36, v36, v127
v_mov_b32 v37, v36
s_nop 1
v_permlane32_swap_b32 v36, v37
s_nop 1
v_max_f32 v36, v36, v37
v_mov_b32 v37, v36
s_nop 1
v_permlane16_swap_b32 v36, v37
s_nop 1
v_max_f32 v36, v36, v37
v_add_f32 v36, 0x41000000, v36
v_max_f32 v36, 0, v36
v_sub_f32 v37, 0, v36
v_exp_f32 v37, v37
v_sub_f32 v104, v104, v36
v_sub_f32 v105, v105, v36
v_sub_f32 v106, v106, v36
v_sub_f32 v107, v107, v36
v_sub_f32 v124, v124, v36
v_sub_f32 v125, v125, v36
v_sub_f32 v126, v126, v36
v_sub_f32 v127, v127, v36
v_sub_f32 v64, v64, v36
v_sub_f32 v65, v65, v36
v_sub_f32 v66, v66, v36
v_sub_f32 v67, v67, v36
v_sub_f32 v84, v84, v36
v_sub_f32 v85, v85, v36
v_sub_f32 v86, v86, v36
v_sub_f32 v87, v87, v36
v_sub_f32 v184, v184, v36
v_mul_f32 v236, v236, v37
v_sub_f32 v185, v185, v36
v_mul_f32 v237, v237, v37
v_sub_f32 v186, v186, v36
v_mul_f32 v238, v238, v37
v_sub_f32 v187, v187, v36
v_mul_f32 v239, v239, v37
v_accvgpr_read_b32 v40, a16
v_accvgpr_read_b32 v41, a17
v_accvgpr_read_b32 v42, a18
v_accvgpr_read_b32 v43, a19
v_mul_f32 v40, v40, v37
v_mul_f32 v41, v41, v37
v_mul_f32 v42, v42, v37
v_mul_f32 v43, v43, v37
v_accvgpr_write_b32 a16, v40
v_accvgpr_write_b32 a17, v41
v_accvgpr_write_b32 a18, v42
v_accvgpr_write_b32 a19, v43
v_accvgpr_read_b32 v40, a36
v_accvgpr_read_b32 v41, a37
v_accvgpr_read_b32 v42, a38
v_accvgpr_read_b32 v43, a39
v_mul_f32 v40, v40, v37
v_mul_f32 v41, v41, v37
v_mul_f32 v42, v42, v37
v_mul_f32 v43, v43, v37
v_accvgpr_write_b32 a36, v40
v_accvgpr_write_b32 a37, v41
v_accvgpr_write_b32 a38, v42
v_accvgpr_write_b32 a39, v43
v_accvgpr_read_b32 v40, a56
v_accvgpr_read_b32 v41, a57
v_accvgpr_read_b32 v42, a58
v_accvgpr_read_b32 v43, a59
v_mul_f32 v40, v40, v37
v_mul_f32 v41, v41, v37
v_mul_f32 v42, v42, v37
v_mul_f32 v43, v43, v37
v_accvgpr_write_b32 a56, v40
v_accvgpr_write_b32 a57, v41
v_accvgpr_write_b32 a58, v42
v_accvgpr_write_b32 a59, v43
v_accvgpr_read_b32 v40, a76
v_accvgpr_read_b32 v41, a77
v_accvgpr_read_b32 v42, a78
v_accvgpr_read_b32 v43, a79
v_mul_f32 v40, v40, v37
v_mul_f32 v41, v41, v37
v_mul_f32 v42, v42, v37
v_mul_f32 v43, v43, v37
v_accvgpr_write_b32 a76, v40
v_accvgpr_write_b32 a77, v41
v_accvgpr_write_b32 a78, v42
v_accvgpr_write_b32 a79, v43
v_accvgpr_read_b32 v40, a96
v_accvgpr_read_b32 v41, a97
v_accvgpr_read_b32 v42, a98
v_accvgpr_read_b32 v43, a99
v_mul_f32 v40, v40, v37
v_mul_f32 v41, v41, v37
v_mul_f32 v42, v42, v37
v_mul_f32 v43, v43, v37
v_accvgpr_write_b32 a96, v40
v_accvgpr_write_b32 a97, v41
v_accvgpr_write_b32 a98, v42
v_accvgpr_write_b32 a99, v43
v_accvgpr_read_b32 v40, a116
v_accvgpr_read_b32 v41, a117
v_accvgpr_read_b32 v42, a118
v_accvgpr_read_b32 v43, a119
v_mul_f32 v40, v40, v37
v_mul_f32 v41, v41, v37
v_mul_f32 v42, v42, v37
v_mul_f32 v43, v43, v37
v_accvgpr_write_b32 a116, v40
v_accvgpr_write_b32 a117, v41
v_accvgpr_write_b32 a118, v42
v_accvgpr_write_b32 a119, v43
v_accvgpr_read_b32 v40, a136
v_accvgpr_read_b32 v41, a137
v_accvgpr_read_b32 v42, a138
v_accvgpr_read_b32 v43, a139
v_mul_f32 v40, v40, v37
v_mul_f32 v41, v41, v37
v_mul_f32 v42, v42, v37
v_mul_f32 v43, v43, v37
v_accvgpr_write_b32 a136, v40
v_accvgpr_write_b32 a137, v41
v_accvgpr_write_b32 a138, v42
v_accvgpr_write_b32 a139, v43
v_accvgpr_read_b32 v40, a156
v_accvgpr_read_b32 v41, a157
v_accvgpr_read_b32 v42, a158
v_accvgpr_read_b32 v43, a159
v_mul_f32 v40, v40, v37
v_mul_f32 v41, v41, v37
v_mul_f32 v42, v42, v37
v_mul_f32 v43, v43, v37
v_accvgpr_write_b32 a156, v40
v_accvgpr_write_b32 a157, v41
v_accvgpr_write_b32 a158, v42
v_accvgpr_write_b32 a159, v43
v_exp_f32 v40, v104
v_exp_f32 v41, v105
v_exp_f32 v42, v106
v_exp_f32 v43, v107
s_nop 0
v_cvt_pk_bf16_f32 v164, v40, v41
v_cvt_pk_bf16_f32 v165, v42, v43
v_exp_f32 v40, v124
v_exp_f32 v41, v125
v_exp_f32 v42, v126
v_exp_f32 v43, v127
s_nop 0
v_cvt_pk_bf16_f32 v166, v40, v41
v_cvt_pk_bf16_f32 v167, v42, v43
s_nop 1
s_setpc_b64 s[58:59]
L_code_end:
.section .rodata,"a"
.p2align 6
.amdhsa_kernel concat_heads__gqa_block_cached__mha_block_cached__near_ridge_kernel
  .amdhsa_next_free_vgpr 512
  .amdhsa_next_free_sgpr 102
  .amdhsa_accum_offset 256
  .amdhsa_group_segment_fixed_size 0
  .amdhsa_kernarg_size 104
  .amdhsa_user_sgpr_count 2
  .amdhsa_user_sgpr_kernarg_segment_ptr 1
  .amdhsa_system_sgpr_workgroup_id_x 1
.end_amdhsa_kernel
```
